```python
import torch

def _softmax(x, axis=-1):
    return torch.softmax(x, dim=axis)
def _gelu(x):
    return torch.nn.functional.gelu(x, approximate="tanh")
def _silu(x):
    return torch.nn.functional.silu(x)
def _sigmoid(x):
    return torch.sigmoid(x)
def _layernorm(x, axis=-1, eps=1e-5):
    m = x.mean(dim=axis, keepdim=True)
    v = x.var(dim=axis, keepdim=True, unbiased=False)
    return (x - m) / torch.sqrt(v + eps)
def _scatter_add(tgt, idx, src, axis=0):
    return tgt.clone().index_add_(axis, idx, src)
def _segment_sum(src, seg, n):
    out = torch.zeros((n,) + src.shape[1:], dtype=src.dtype)
    return out.index_add_(0, seg, src)
def _pad(x, pw):
    flat = tuple(v for pair in reversed(pw) for v in pair)
    return torch.nn.functional.pad(x, flat)

kernel_name = 'standalone__mha_block_cached__near_ridge'

def setup_inputs():

    _w = (lambda a: (lambda t: t.to(torch.bfloat16) if t.is_floating_point() else t)(torch.as_tensor(a)))
    B, Sq, D = 8, 128, 512
    H, Sk, Dh = 32, 1024, 128
    return {
        "x": _w((lambda *s: torch.randn(*s, dtype=torch.bfloat16) * 0.8)(B, Sq, D)),
        "k_cache": _w((lambda *s: torch.randn(*s, dtype=torch.bfloat16) * 0.8)(B, H, Sk, Dh)),
        "v_cache": _w((lambda *s: torch.randn(*s, dtype=torch.bfloat16) * 0.05)(B, H, Sk, Dh)),
        "wq": _w((lambda *s: torch.randn(*s, dtype=torch.bfloat16) * 0.8)(D, H * Dh) * (D ** -0.5)),
        "wo": _w((lambda *s: torch.randn(*s, dtype=torch.bfloat16) * 0.05)(H * Dh, D) * ((H * Dh) ** -0.5)),
    }

def reference(x, k_cache, v_cache, wq, wo):
    B, Sq, D = x.shape
    H, Dh = 32, 128
    q = (lambda x, *d: x.permute(*d))((x @ wq).reshape(B, Sq, H, Dh), 0, 2, 1, 3)
    scores = torch.einsum("bhqd,bhkd->bhqk", q, k_cache) * (Dh ** -0.5)
    p = _softmax(scores, axis=-1)
    o = torch.einsum("bhqk,bhkd->bhqd", p, v_cache)
    return (lambda x, *d: x.permute(*d))(o, 0, 2, 1, 3).reshape(B, Sq, H * Dh) @ wo
```

```asm
; @launch grid=(256,1,1) block=(512,1,1) lds=163840
.amdgcn_target "amdgcn-amd-amdhsa--gfx950"
.text
.globl standalone__mha_block_cached__near_ridge_kernel
.p2align 8
.type standalone__mha_block_cached__near_ridge_kernel,@function
standalone__mha_block_cached__near_ridge_kernel:
    s_cmp_ge_u32 s2, 256
    s_cbranch_scc1 L_end
    s_load_dwordx8 s[48:55], s[0:1], 0
    s_load_dwordx2 s[56:57], s[0:1], 32
    s_load_dwordx2 s[58:59], s[0:1], 56
    s_load_dwordx4 s[76:79], s[0:1], 40
    v_lshrrev_b32 v1, 6, v0
    v_and_b32 v0, 63, v0
    v_readfirstlane_b32 s4, v1
    s_and_b32 s60, s2, 7
    s_lshr_b32 s61, s2, 3
    s_and_b32 s62, s61, 7
    s_lshr_b32 s69, s61, 3
    s_lshl_b32 s65, s69, 1
    s_add_u32 s65, s65, s62
    s_lshl_b32 s63, s69, 3
    s_add_u32 s63, s63, s60
    s_cmp_lt_u32 s4, 4
    s_cbranch_scc1 L_attn
    s_sub_u32 s4, s4, 4
    s_lshl_b32 s5, s4, 12
    v_lshrrev_b32 v1, 4, v0
    v_and_b32 v2, 15, v0
    v_lshlrev_b32 v4, 8, v1
    v_add_u32 v4, s5, v4
    v_lshlrev_b32 v3, 1, v1
    v_xor_b32 v3, v3, v2
    v_lshlrev_b32 v3, 4, v3
    v_lshlrev_b32 v7, 5, v4
    v_add_u32 v20, v7, v3
    v_add_u32 v21, 0x7c00, v20
    v_xor_b32 v22, 0x80, v20
    v_add_u32 v23, 0x17400, v22
    v_add_u32 v22, 0xf800, v22
    v_add_u32 v18, v4, v3
    v_xor_b32 v19, 0x80, v18
    v_lshrrev_b32 v5, 3, v0
    v_and_b32 v6, 7, v0
    v_xor_b32 v6, v6, v1
    v_lshlrev_b32 v6, 4, v6
    v_lshlrev_b32 v5, 10, v5
    s_lshl_b32 s6, s4, 15
    v_add_u32 v5, s6, v5
    v_add_u32 v24, v5, v6
    v_xor_b32 v25, 64, v24
    v_add_u32 v26, 0x3800, v24
    v_add_u32 v27, 0x5400, v25
    v_add_u32 v25, 0x1c00, v25
    s_lshl_b32 s64, s63, 8
    s_lshl_b32 s6, s62, 17
    s_mov_b32 s18, 0x20000
    s_mov_b32 s19, 0x20000
    s_mov_b32 s22, 0x400000
    s_mov_b32 s23, 0x20000
    s_waitcnt lgkmcnt(0)
    s_mov_b32 s20, s54
    s_mov_b32 s21, s55
    s_add_u32 s16, s48, s6
    s_addc_u32 s17, s49, 0
    s_add_u32 m0, s5, 65536
    s_add_u32 s7, s65, 0
    s_and_b32 s7, s7, 7
    s_lshl_b32 s7, s7, 19
    s_add_u32 s7, s7, s64
    buffer_load_dwordx4 v20, s[20:23], s7 offen offset:0 lds
    buffer_load_dwordx4 v21, s[20:23], s7 offen offset:1024 lds
    buffer_load_dwordx4 v22, s[20:23], s7 offen offset:2048 lds
    buffer_load_dwordx4 v23, s[20:23], s7 offen offset:3072 lds
    s_add_u32 m0, s5, 114688
    s_add_u32 s7, s65, 0
    s_and_b32 s7, s7, 7
    s_lshl_b32 s7, s7, 7
    buffer_load_dwordx4 v24, s[16:19], s7 offen offset:0 lds
    buffer_load_dwordx4 v25, s[16:19], s7 offen offset:1024 lds
    buffer_load_dwordx4 v26, s[16:19], s7 offen offset:2048 lds
    buffer_load_dwordx4 v27, s[16:19], s7 offen offset:3072 lds
    s_add_u32 m0, s5, 81920
    s_add_u32 s7, s65, 1
    s_and_b32 s7, s7, 7
    s_lshl_b32 s7, s7, 19
    s_add_u32 s7, s7, s64
    buffer_load_dwordx4 v20, s[20:23], s7 offen offset:0 lds
    buffer_load_dwordx4 v21, s[20:23], s7 offen offset:1024 lds
    buffer_load_dwordx4 v22, s[20:23], s7 offen offset:2048 lds
    buffer_load_dwordx4 v23, s[20:23], s7 offen offset:3072 lds
    s_add_u32 m0, s5, 131072
    s_add_u32 s7, s65, 1
    s_and_b32 s7, s7, 7
    s_lshl_b32 s7, s7, 7
    buffer_load_dwordx4 v24, s[16:19], s7 offen offset:0 lds
    buffer_load_dwordx4 v25, s[16:19], s7 offen offset:1024 lds
    buffer_load_dwordx4 v26, s[16:19], s7 offen offset:2048 lds
    buffer_load_dwordx4 v27, s[16:19], s7 offen offset:3072 lds
    v_xor_b32 v3, v1, v2
    s_and_b32 s6, s4, 1
    s_lshl_b32 s6, s6, 3
    v_xor_b32 v3, s6, v3
    v_lshlrev_b32 v3, 4, v3
    v_add_u32 v16, v4, v3
    v_xor_b32 v17, 64, v16
    s_lshl_b32 s3, s62, 5
    s_add_u32 s3, s3, s63
    s_lshl_b32 s3, s3, 18
    s_add_u32 s8, s50, s3
    s_addc_u32 s9, s51, 0
    s_mov_b32 s10, 0x40000
    s_mov_b32 s11, 0x20000
    s_add_u32 s12, s52, s3
    s_addc_u32 s13, s53, 0
    s_mov_b32 s14, 0x40000
    s_mov_b32 s15, 0x20000
    s_lshr_b32 s3, s4, 1
    s_lshl_b32 s3, s3, 15
    s_and_b32 s6, s4, 1
    s_lshl_b32 s6, s6, 13
    s_add_u32 s3, s3, s6
    v_lshlrev_b32 v4, 10, v1
    v_add_u32 v4, s3, v4
    v_lshlrev_b32 v3, 1, v1
    v_xor_b32 v3, v3, v2
    v_lshlrev_b32 v3, 4, v3
    v_add_u32 v28, v4, v3
    v_add_u32 v29, 15360, v28
    v_xor_b32 v30, 0x80, v28
    v_add_u32 v31, 17408, v30
    v_add_u32 v30, 2048, v30
    s_lshl_b32 s66, s60, 17
    s_lshl_b32 s3, s69, 8
    s_add_u32 s66, s66, s3
    s_lshl_b32 s67, s63, 17
    s_lshl_b32 s3, s62, 14
    s_add_u32 s67, s67, s3
    s_add_u32 s67, s67, s5
    v_lshlrev_b32 v10, 7, v0
    s_mov_b32 s24, s56
    s_mov_b32 s25, s57
    s_mov_b32 s26, 0x400000
    s_mov_b32 s27, 0x20000
    s_mov_b32 s32, s76
    s_mov_b32 s33, s77
    s_mov_b32 s34, 0x100000
    s_mov_b32 s35, 0x20000
    s_mul_i32 s80, s69, 16
    s_add_u32 s80, s80, s60
    s_add_u32 s80, s80, 8
    s_mul_i32 s80, s80, 256
    s_lshr_b32 s85, s60, 1
    s_mul_i32 s85, s85, 16
    s_and_b32 s6, s60, 1
    s_lshl_b32 s6, s6, 2
    s_add_u32 s85, s85, s6
    s_mul_i32 s85, s85, 256
    s_lshl_b32 s3, s69, 3
    s_add_u32 s3, s3, s60
    s_lshl_b32 s6, s62, 5
    s_add_u32 s3, s3, s6
    s_lshl_b32 s3, s3, 15
    s_add_u32 s3, s3, 33554432
    s_add_u32 s44, s58, s3
    s_addc_u32 s45, s59, 0
    s_mov_b32 s46, 0x8000
    s_mov_b32 s47, 0x20000
    s_mul_i32 s3, s62, 16384
    s_add_u32 s3, s3, 16777216
    s_add_u32 s40, s58, s3
    s_addc_u32 s41, s59, 0
    s_mov_b32 s42, 16384
    s_mov_b32 s43, 0x20000
    s_lshl_b32 s3, s4, 10
    v_lshlrev_b32 v12, 4, v0
    v_add_u32 v12, s3, v12
    s_lshl_b32 s37, s62, 3
    s_add_u32 s37, s37, s60
    s_lshl_b32 s37, s37, 14
    s_lshl_b32 s3, s69, 8
    s_add_u32 s37, s37, s3
    s_lshl_b32 s3, s4, 6
    s_add_u32 s37, s37, s3
    v_lshlrev_b32 v11, 10, v2
    v_lshlrev_b32 v3, 4, v1
    v_add_u32 v11, v11, v3
    v_lshlrev_b32 v34, 4, v0
    v_add_u32 v34, s5, v34
    v_add_u32 v35, 0x10000, v34
    s_and_b32 s3, s61, 1
    s_cmp_eq_u32 s3, 1
    s_cbranch_scc1 L_qv1
L_qv0:
    s_waitcnt vmcnt(8)
    s_barrier
    s_add_u32 m0, s5, 98304
    s_add_u32 s7, s65, 2
    s_and_b32 s7, s7, 7
    s_lshl_b32 s7, s7, 19
    s_add_u32 s7, s7, s64
    buffer_load_dwordx4 v20, s[20:23], s7 offen offset:0 lds
    buffer_load_dwordx4 v21, s[20:23], s7 offen offset:1024 lds
    buffer_load_dwordx4 v22, s[20:23], s7 offen offset:2048 lds
    buffer_load_dwordx4 v23, s[20:23], s7 offen offset:3072 lds
    s_add_u32 m0, s5, 147456
    s_add_u32 s7, s65, 2
    s_and_b32 s7, s7, 7
    s_lshl_b32 s7, s7, 7
    buffer_load_dwordx4 v24, s[16:19], s7 offen offset:0 lds
    buffer_load_dwordx4 v25, s[16:19], s7 offen offset:1024 lds
    buffer_load_dwordx4 v26, s[16:19], s7 offen offset:2048 lds
    buffer_load_dwordx4 v27, s[16:19], s7 offen offset:3072 lds
    s_add_u32 m0, s5, 0
    s_mov_b32 s7, 0
    buffer_load_dwordx4 v16, s[8:11], s7 offen offset:0 nt lds
    buffer_load_dwordx4 v16, s[8:11], s7 offen offset:1024 nt lds
    buffer_load_dwordx4 v17, s[8:11], s7 offen offset:2048 nt lds
    buffer_load_dwordx4 v17, s[8:11], s7 offen offset:3072 nt lds
    s_add_u32 m0, s5, 16384
    s_mov_b32 s7, 65536
    buffer_load_dwordx4 v16, s[8:11], s7 offen offset:0 nt lds
    buffer_load_dwordx4 v16, s[8:11], s7 offen offset:1024 nt lds
    buffer_load_dwordx4 v17, s[8:11], s7 offen offset:2048 nt lds
    buffer_load_dwordx4 v17, s[8:11], s7 offen offset:3072 nt lds
    s_add_u32 m0, s5, 32768
    s_mov_b32 s7, 32768
    buffer_load_dwordx4 v16, s[8:11], s7 offen offset:0 nt lds
    buffer_load_dwordx4 v16, s[8:11], s7 offen offset:1024 nt lds
    buffer_load_dwordx4 v17, s[8:11], s7 offen offset:2048 nt lds
    buffer_load_dwordx4 v17, s[8:11], s7 offen offset:3072 nt lds
    s_add_u32 m0, s5, 49152
    s_mov_b32 s7, 98304
    buffer_load_dwordx4 v16, s[8:11], s7 offen offset:0 nt lds
    buffer_load_dwordx4 v16, s[8:11], s7 offen offset:1024 nt lds
    buffer_load_dwordx4 v17, s[8:11], s7 offen offset:2048 nt lds
    buffer_load_dwordx4 v17, s[8:11], s7 offen offset:3072 nt lds
    s_mov_b32 s6, 0
    buffer_load_dwordx4 v[64:67], v18, s[12:15], s6 offen offset:0 nt
    s_mov_b32 s6, 0
    buffer_load_dwordx4 v[68:71], v18, s[12:15], s6 offen offset:1024 nt
    s_mov_b32 s6, 0
    buffer_load_dwordx4 v[72:75], v19, s[12:15], s6 offen offset:2048 nt
    s_mov_b32 s6, 0
    buffer_load_dwordx4 v[76:79], v19, s[12:15], s6 offen offset:3072 nt
    s_waitcnt vmcnt(28)
    s_barrier
    s_add_u32 m0, s5, 65536
    s_add_u32 s7, s65, 3
    s_and_b32 s7, s7, 7
    s_lshl_b32 s7, s7, 19
    s_add_u32 s7, s7, s64
    buffer_load_dwordx4 v20, s[20:23], s7 offen offset:0 lds
    buffer_load_dwordx4 v21, s[20:23], s7 offen offset:1024 lds
    buffer_load_dwordx4 v22, s[20:23], s7 offen offset:2048 lds
    buffer_load_dwordx4 v23, s[20:23], s7 offen offset:3072 lds
    s_add_u32 m0, s5, 114688
    s_add_u32 s7, s65, 3
    s_and_b32 s7, s7, 7
    s_lshl_b32 s7, s7, 7
    buffer_load_dwordx4 v24, s[16:19], s7 offen offset:0 lds
    buffer_load_dwordx4 v25, s[16:19], s7 offen offset:1024 lds
    buffer_load_dwordx4 v26, s[16:19], s7 offen offset:2048 lds
    buffer_load_dwordx4 v27, s[16:19], s7 offen offset:3072 lds
    s_waitcnt vmcnt(28)
    s_barrier
    s_add_u32 m0, s5, 81920
    s_add_u32 s7, s65, 4
    s_and_b32 s7, s7, 7
    s_lshl_b32 s7, s7, 19
    s_add_u32 s7, s7, s64
    buffer_load_dwordx4 v20, s[20:23], s7 offen offset:0 lds
    buffer_load_dwordx4 v21, s[20:23], s7 offen offset:1024 lds
    buffer_load_dwordx4 v22, s[20:23], s7 offen offset:2048 lds
    buffer_load_dwordx4 v23, s[20:23], s7 offen offset:3072 lds
    s_add_u32 m0, s5, 131072
    s_add_u32 s7, s65, 4
    s_and_b32 s7, s7, 7
    s_lshl_b32 s7, s7, 7
    buffer_load_dwordx4 v24, s[16:19], s7 offen offset:0 lds
    buffer_load_dwordx4 v25, s[16:19], s7 offen offset:1024 lds
    buffer_load_dwordx4 v26, s[16:19], s7 offen offset:2048 lds
    buffer_load_dwordx4 v27, s[16:19], s7 offen offset:3072 lds
    s_waitcnt vmcnt(8)
    s_barrier
    s_add_u32 m0, s5, 98304
    s_add_u32 s7, s65, 5
    s_and_b32 s7, s7, 7
    s_lshl_b32 s7, s7, 19
    s_add_u32 s7, s7, s64
    buffer_load_dwordx4 v20, s[20:23], s7 offen offset:0 lds
    buffer_load_dwordx4 v21, s[20:23], s7 offen offset:1024 lds
    buffer_load_dwordx4 v22, s[20:23], s7 offen offset:2048 lds
    buffer_load_dwordx4 v23, s[20:23], s7 offen offset:3072 lds
    s_add_u32 m0, s5, 147456
    s_add_u32 s7, s65, 5
    s_and_b32 s7, s7, 7
    s_lshl_b32 s7, s7, 7
    buffer_load_dwordx4 v24, s[16:19], s7 offen offset:0 lds
    buffer_load_dwordx4 v25, s[16:19], s7 offen offset:1024 lds
    buffer_load_dwordx4 v26, s[16:19], s7 offen offset:2048 lds
    buffer_load_dwordx4 v27, s[16:19], s7 offen offset:3072 lds
    s_waitcnt vmcnt(8)
    s_barrier
    s_add_u32 m0, s5, 65536
    s_add_u32 s7, s65, 6
    s_and_b32 s7, s7, 7
    s_lshl_b32 s7, s7, 19
    s_add_u32 s7, s7, s64
    buffer_load_dwordx4 v20, s[20:23], s7 offen offset:0 lds
    buffer_load_dwordx4 v21, s[20:23], s7 offen offset:1024 lds
    buffer_load_dwordx4 v22, s[20:23], s7 offen offset:2048 lds
    buffer_load_dwordx4 v23, s[20:23], s7 offen offset:3072 lds
    s_add_u32 m0, s5, 114688
    s_add_u32 s7, s65, 6
    s_and_b32 s7, s7, 7
    s_lshl_b32 s7, s7, 7
    buffer_load_dwordx4 v24, s[16:19], s7 offen offset:0 lds
    buffer_load_dwordx4 v25, s[16:19], s7 offen offset:1024 lds
    buffer_load_dwordx4 v26, s[16:19], s7 offen offset:2048 lds
    buffer_load_dwordx4 v27, s[16:19], s7 offen offset:3072 lds
    s_waitcnt vmcnt(8)
    s_barrier
    s_add_u32 m0, s5, 81920
    s_add_u32 s7, s65, 7
    s_and_b32 s7, s7, 7
    s_lshl_b32 s7, s7, 19
    s_add_u32 s7, s7, s64
    buffer_load_dwordx4 v20, s[20:23], s7 offen offset:0 lds
    buffer_load_dwordx4 v21, s[20:23], s7 offen offset:1024 lds
    buffer_load_dwordx4 v22, s[20:23], s7 offen offset:2048 lds
    buffer_load_dwordx4 v23, s[20:23], s7 offen offset:3072 lds
    s_add_u32 m0, s5, 131072
    s_add_u32 s7, s65, 7
    s_and_b32 s7, s7, 7
    s_lshl_b32 s7, s7, 7
    buffer_load_dwordx4 v24, s[16:19], s7 offen offset:0 lds
    buffer_load_dwordx4 v25, s[16:19], s7 offen offset:1024 lds
    buffer_load_dwordx4 v26, s[16:19], s7 offen offset:2048 lds
    buffer_load_dwordx4 v27, s[16:19], s7 offen offset:3072 lds
    s_waitcnt vmcnt(8)
    s_barrier
    s_mov_b32 s6, 65536
    buffer_load_dwordx4 v[80:83], v18, s[12:15], s6 offen offset:0 nt
    s_mov_b32 s6, 65536
    buffer_load_dwordx4 v[84:87], v18, s[12:15], s6 offen offset:1024 nt
    s_mov_b32 s6, 65536
    buffer_load_dwordx4 v[88:91], v19, s[12:15], s6 offen offset:2048 nt
    s_mov_b32 s6, 65536
    buffer_load_dwordx4 v[92:95], v19, s[12:15], s6 offen offset:3072 nt
    s_waitcnt vmcnt(47)
    ds_write_b128 v35, v[64:67] offset:32768
    s_waitcnt vmcnt(46)
    ds_write_b128 v35, v[68:71] offset:33792
    s_waitcnt vmcnt(45)
    ds_write_b128 v35, v[72:75] offset:34816
    s_waitcnt vmcnt(44)
    ds_write_b128 v35, v[76:79] offset:35840
    s_waitcnt lgkmcnt(0)
    s_waitcnt vmcnt(4)
    s_barrier
    s_add_u32 m0, s5, 114688
    s_mov_b32 s7, 32768
    buffer_load_dwordx4 v18, s[12:15], s7 offen offset:0 nt lds
    buffer_load_dwordx4 v18, s[12:15], s7 offen offset:1024 nt lds
    buffer_load_dwordx4 v19, s[12:15], s7 offen offset:2048 nt lds
    buffer_load_dwordx4 v19, s[12:15], s7 offen offset:3072 nt lds
    s_waitcnt vmcnt(7)
    ds_write_b128 v35, v[80:83] offset:0
    s_waitcnt vmcnt(6)
    ds_write_b128 v35, v[84:87] offset:1024
    s_waitcnt vmcnt(5)
    ds_write_b128 v35, v[88:91] offset:2048
    s_branch L_qjoin
L_qv1:
    s_waitcnt vmcnt(8)
    s_barrier
    s_add_u32 m0, s5, 98304
    s_add_u32 s7, s65, 2
    s_and_b32 s7, s7, 7
    s_lshl_b32 s7, s7, 19
    s_add_u32 s7, s7, s64
    buffer_load_dwordx4 v20, s[20:23], s7 offen offset:0 lds
    buffer_load_dwordx4 v21, s[20:23], s7 offen offset:1024 lds
    buffer_load_dwordx4 v22, s[20:23], s7 offen offset:2048 lds
    buffer_load_dwordx4 v23, s[20:23], s7 offen offset:3072 lds
    s_add_u32 m0, s5, 147456
    s_add_u32 s7, s65, 2
    s_and_b32 s7, s7, 7
    s_lshl_b32 s7, s7, 7
    buffer_load_dwordx4 v24, s[16:19], s7 offen offset:0 lds
    buffer_load_dwordx4 v25, s[16:19], s7 offen offset:1024 lds
    buffer_load_dwordx4 v26, s[16:19], s7 offen offset:2048 lds
    buffer_load_dwordx4 v27, s[16:19], s7 offen offset:3072 lds
    s_waitcnt vmcnt(8)
    s_barrier
    s_add_u32 m0, s5, 65536
    s_add_u32 s7, s65, 3
    s_and_b32 s7, s7, 7
    s_lshl_b32 s7, s7, 19
    s_add_u32 s7, s7, s64
    buffer_load_dwordx4 v20, s[20:23], s7 offen offset:0 lds
    buffer_load_dwordx4 v21, s[20:23], s7 offen offset:1024 lds
    buffer_load_dwordx4 v22, s[20:23], s7 offen offset:2048 lds
    buffer_load_dwordx4 v23, s[20:23], s7 offen offset:3072 lds
    s_add_u32 m0, s5, 114688
    s_add_u32 s7, s65, 3
    s_and_b32 s7, s7, 7
    s_lshl_b32 s7, s7, 7
    buffer_load_dwordx4 v24, s[16:19], s7 offen offset:0 lds
    buffer_load_dwordx4 v25, s[16:19], s7 offen offset:1024 lds
    buffer_load_dwordx4 v26, s[16:19], s7 offen offset:2048 lds
    buffer_load_dwordx4 v27, s[16:19], s7 offen offset:3072 lds
    s_waitcnt vmcnt(8)
    s_barrier
    s_add_u32 m0, s5, 81920
    s_add_u32 s7, s65, 4
    s_and_b32 s7, s7, 7
    s_lshl_b32 s7, s7, 19
    s_add_u32 s7, s7, s64
    buffer_load_dwordx4 v20, s[20:23], s7 offen offset:0 lds
    buffer_load_dwordx4 v21, s[20:23], s7 offen offset:1024 lds
    buffer_load_dwordx4 v22, s[20:23], s7 offen offset:2048 lds
    buffer_load_dwordx4 v23, s[20:23], s7 offen offset:3072 lds
    s_add_u32 m0, s5, 131072
    s_add_u32 s7, s65, 4
    s_and_b32 s7, s7, 7
    s_lshl_b32 s7, s7, 7
    buffer_load_dwordx4 v24, s[16:19], s7 offen offset:0 lds
    buffer_load_dwordx4 v25, s[16:19], s7 offen offset:1024 lds
    buffer_load_dwordx4 v26, s[16:19], s7 offen offset:2048 lds
    buffer_load_dwordx4 v27, s[16:19], s7 offen offset:3072 lds
    s_add_u32 m0, s5, 0
    s_mov_b32 s7, 0
    buffer_load_dwordx4 v16, s[8:11], s7 offen offset:0 nt lds
    buffer_load_dwordx4 v16, s[8:11], s7 offen offset:1024 nt lds
    buffer_load_dwordx4 v17, s[8:11], s7 offen offset:2048 nt lds
    buffer_load_dwordx4 v17, s[8:11], s7 offen offset:3072 nt lds
    s_waitcnt vmcnt(12)
    s_barrier
    s_add_u32 m0, s5, 98304
    s_add_u32 s7, s65, 5
    s_and_b32 s7, s7, 7
    s_lshl_b32 s7, s7, 19
    s_add_u32 s7, s7, s64
    buffer_load_dwordx4 v20, s[20:23], s7 offen offset:0 lds
    buffer_load_dwordx4 v21, s[20:23], s7 offen offset:1024 lds
    buffer_load_dwordx4 v22, s[20:23], s7 offen offset:2048 lds
    buffer_load_dwordx4 v23, s[20:23], s7 offen offset:3072 lds
    s_add_u32 m0, s5, 147456
    s_add_u32 s7, s65, 5
    s_and_b32 s7, s7, 7
    s_lshl_b32 s7, s7, 7
    buffer_load_dwordx4 v24, s[16:19], s7 offen offset:0 lds
    buffer_load_dwordx4 v25, s[16:19], s7 offen offset:1024 lds
    buffer_load_dwordx4 v26, s[16:19], s7 offen offset:2048 lds
    buffer_load_dwordx4 v27, s[16:19], s7 offen offset:3072 lds
    s_waitcnt vmcnt(12)
    s_barrier
    s_add_u32 m0, s5, 65536
    s_add_u32 s7, s65, 6
    s_and_b32 s7, s7, 7
    s_lshl_b32 s7, s7, 19
    s_add_u32 s7, s7, s64
    buffer_load_dwordx4 v20, s[20:23], s7 offen offset:0 lds
    buffer_load_dwordx4 v21, s[20:23], s7 offen offset:1024 lds
    buffer_load_dwordx4 v22, s[20:23], s7 offen offset:2048 lds
    buffer_load_dwordx4 v23, s[20:23], s7 offen offset:3072 lds
    s_add_u32 m0, s5, 114688
    s_add_u32 s7, s65, 6
    s_and_b32 s7, s7, 7
    s_lshl_b32 s7, s7, 7
    buffer_load_dwordx4 v24, s[16:19], s7 offen offset:0 lds
    buffer_load_dwordx4 v25, s[16:19], s7 offen offset:1024 lds
    buffer_load_dwordx4 v26, s[16:19], s7 offen offset:2048 lds
    buffer_load_dwordx4 v27, s[16:19], s7 offen offset:3072 lds
    s_add_u32 m0, s5, 16384
    s_mov_b32 s7, 65536
    buffer_load_dwordx4 v16, s[8:11], s7 offen offset:0 nt lds
    buffer_load_dwordx4 v16, s[8:11], s7 offen offset:1024 nt lds
    buffer_load_dwordx4 v17, s[8:11], s7 offen offset:2048 nt lds
    buffer_load_dwordx4 v17, s[8:11], s7 offen offset:3072 nt lds
    s_add_u32 m0, s5, 32768
    s_mov_b32 s7, 32768
    buffer_load_dwordx4 v16, s[8:11], s7 offen offset:0 nt lds
    buffer_load_dwordx4 v16, s[8:11], s7 offen offset:1024 nt lds
    buffer_load_dwordx4 v17, s[8:11], s7 offen offset:2048 nt lds
    buffer_load_dwordx4 v17, s[8:11], s7 offen offset:3072 nt lds
    s_add_u32 m0, s5, 49152
    s_mov_b32 s7, 98304
    buffer_load_dwordx4 v16, s[8:11], s7 offen offset:0 nt lds
    buffer_load_dwordx4 v16, s[8:11], s7 offen offset:1024 nt lds
    buffer_load_dwordx4 v17, s[8:11], s7 offen offset:2048 nt lds
    buffer_load_dwordx4 v17, s[8:11], s7 offen offset:3072 nt lds
    s_mov_b32 s6, 0
    buffer_load_dwordx4 v[64:67], v18, s[12:15], s6 offen offset:0 nt
    s_mov_b32 s6, 0
    buffer_load_dwordx4 v[68:71], v18, s[12:15], s6 offen offset:1024 nt
    s_mov_b32 s6, 0
    buffer_load_dwordx4 v[72:75], v19, s[12:15], s6 offen offset:2048 nt
    s_mov_b32 s6, 0
    buffer_load_dwordx4 v[76:79], v19, s[12:15], s6 offen offset:3072 nt
    s_waitcnt vmcnt(24)
    s_barrier
    s_add_u32 m0, s5, 81920
    s_add_u32 s7, s65, 7
    s_and_b32 s7, s7, 7
    s_lshl_b32 s7, s7, 19
    s_add_u32 s7, s7, s64
    buffer_load_dwordx4 v20, s[20:23], s7 offen offset:0 lds
    buffer_load_dwordx4 v21, s[20:23], s7 offen offset:1024 lds
    buffer_load_dwordx4 v22, s[20:23], s7 offen offset:2048 lds
    buffer_load_dwordx4 v23, s[20:23], s7 offen offset:3072 lds
    s_add_u32 m0, s5, 131072
    s_add_u32 s7, s65, 7
    s_and_b32 s7, s7, 7
    s_lshl_b32 s7, s7, 7
    buffer_load_dwordx4 v24, s[16:19], s7 offen offset:0 lds
    buffer_load_dwordx4 v25, s[16:19], s7 offen offset:1024 lds
    buffer_load_dwordx4 v26, s[16:19], s7 offen offset:2048 lds
    buffer_load_dwordx4 v27, s[16:19], s7 offen offset:3072 lds
    s_waitcnt vmcnt(24)
    s_barrier
    s_mov_b32 s6, 65536
    buffer_load_dwordx4 v[80:83], v18, s[12:15], s6 offen offset:0 nt
    s_mov_b32 s6, 65536
    buffer_load_dwordx4 v[84:87], v18, s[12:15], s6 offen offset:1024 nt
    s_mov_b32 s6, 65536
    buffer_load_dwordx4 v[88:91], v19, s[12:15], s6 offen offset:2048 nt
    s_mov_b32 s6, 65536
    buffer_load_dwordx4 v[92:95], v19, s[12:15], s6 offen offset:3072 nt
    s_waitcnt vmcnt(15)
    ds_write_b128 v35, v[64:67] offset:32768
    s_waitcnt vmcnt(14)
    ds_write_b128 v35, v[68:71] offset:33792
    s_waitcnt vmcnt(13)
    ds_write_b128 v35, v[72:75] offset:34816
    s_waitcnt vmcnt(12)
    ds_write_b128 v35, v[76:79] offset:35840
    s_waitcnt lgkmcnt(0)
    s_waitcnt vmcnt(4)
    s_barrier
    s_add_u32 m0, s5, 114688
    s_mov_b32 s7, 32768
    buffer_load_dwordx4 v18, s[12:15], s7 offen offset:0 nt lds
    buffer_load_dwordx4 v18, s[12:15], s7 offen offset:1024 nt lds
    buffer_load_dwordx4 v19, s[12:15], s7 offen offset:2048 nt lds
    buffer_load_dwordx4 v19, s[12:15], s7 offen offset:3072 nt lds
    s_waitcnt vmcnt(7)
    ds_write_b128 v35, v[80:83] offset:0
    s_waitcnt vmcnt(6)
    ds_write_b128 v35, v[84:87] offset:1024
    s_waitcnt vmcnt(5)
    ds_write_b128 v35, v[88:91] offset:2048
L_qjoin:
    s_waitcnt lgkmcnt(0)
    s_waitcnt vmcnt(48)
    s_barrier
    s_waitcnt vmcnt(4)
    s_mov_b32 s6, 131072
    buffer_load_dwordx4 v[96:99], v16, s[8:11], s6 offen offset:0 nt
    s_waitcnt vmcnt(4)
    s_mov_b32 s6, 131072
    buffer_load_dwordx4 v[100:103], v16, s[8:11], s6 offen offset:1024 nt
    s_waitcnt vmcnt(4)
    s_mov_b32 s6, 131072
    buffer_load_dwordx4 v[104:107], v17, s[8:11], s6 offen offset:2048 nt
    s_waitcnt vmcnt(4)
    s_mov_b32 s6, 131072
    buffer_load_dwordx4 v[108:111], v17, s[8:11], s6 offen offset:3072 nt
    s_waitcnt vmcnt(8)
    ds_write_b128 v35, v[92:95] offset:3072
    s_mov_b64 exec, 0xff
    buffer_load_dword v9, v10, s[24:27], s67 offen offset:0
    s_mov_b64 exec, -1
    s_waitcnt lgkmcnt(0)
    s_waitcnt vmcnt(33)
    s_barrier
    s_add_u32 m0, s5, 81920
    s_mov_b32 s7, 98304
    s_waitcnt vmcnt(5)
    buffer_load_dwordx4 v18, s[12:15], s7 offen offset:0 nt lds
    s_waitcnt vmcnt(5)
    buffer_load_dwordx4 v18, s[12:15], s7 offen offset:1024 nt lds
    s_waitcnt vmcnt(5)
    buffer_load_dwordx4 v19, s[12:15], s7 offen offset:2048 nt lds
    s_waitcnt vmcnt(7)
    ds_write_b128 v34, v[96:99] offset:0
    s_waitcnt vmcnt(6)
    ds_write_b128 v34, v[100:103] offset:1024
    s_mov_b64 exec, 0xff
    buffer_load_dword v9, v10, s[24:27], s67 offen offset:1024
    s_mov_b64 exec, -1
    s_waitcnt lgkmcnt(0)
    s_waitcnt vmcnt(63)
    s_barrier
    s_waitcnt vmcnt(6)
    buffer_load_dwordx4 v19, s[12:15], s7 offen offset:3072 nt lds
    s_add_u32 m0, s5, 16384
    s_mov_b32 s7, 196608
    s_waitcnt vmcnt(6)
    buffer_load_dwordx4 v16, s[8:11], s7 offen offset:0 nt lds
    s_waitcnt vmcnt(5)
    buffer_load_dwordx4 v16, s[8:11], s7 offen offset:1024 nt lds
    s_waitcnt vmcnt(9)
    ds_write_b128 v34, v[104:107] offset:2048
    s_waitcnt vmcnt(8)
    ds_write_b128 v34, v[108:111] offset:3072
    s_mov_b64 exec, 0xff
    buffer_load_dword v9, v10, s[24:27], s67 offen offset:2048
    s_mov_b64 exec, -1
    s_waitcnt lgkmcnt(0)
    s_waitcnt vmcnt(37)
    s_barrier
    s_waitcnt vmcnt(6)
    buffer_load_dwordx4 v17, s[8:11], s7 offen offset:2048 nt lds
    s_waitcnt vmcnt(6)
    buffer_load_dwordx4 v17, s[8:11], s7 offen offset:3072 nt lds
    s_add_u32 m0, s5, 98304
    s_mov_b32 s7, 131072
    s_waitcnt vmcnt(5)
    buffer_load_dwordx4 v18, s[12:15], s7 offen offset:0 nt lds
    s_waitcnt vmcnt(5)
    buffer_load_dwordx4 v18, s[12:15], s7 offen offset:1024 nt lds
    s_mov_b64 exec, 0xff
    buffer_load_dword v9, v10, s[24:27], s67 offen offset:3072
    s_mov_b64 exec, -1
    s_waitcnt vmcnt(63)
    s_barrier
    s_waitcnt vmcnt(6)
    buffer_load_dwordx4 v19, s[12:15], s7 offen offset:2048 nt lds
    s_waitcnt vmcnt(5)
    buffer_load_dwordx4 v19, s[12:15], s7 offen offset:3072 nt lds
    s_add_u32 m0, s5, 32768
    s_mov_b32 s7, 163840
    s_waitcnt vmcnt(5)
    buffer_load_dwordx4 v16, s[8:11], s7 offen offset:0 nt lds
    s_waitcnt vmcnt(41)
    s_barrier
    s_waitcnt vmcnt(5)
    buffer_load_dwordx4 v16, s[8:11], s7 offen offset:1024 nt lds
    s_waitcnt vmcnt(5)
    buffer_load_dwordx4 v17, s[8:11], s7 offen offset:2048 nt lds
    s_waitcnt vmcnt(4)
    buffer_load_dwordx4 v17, s[8:11], s7 offen offset:3072 nt lds
    s_waitcnt vmcnt(24)
    s_barrier
    s_add_u32 m0, s5, 65536
    s_mov_b32 s7, 196608
    s_waitcnt vmcnt(4)
    buffer_load_dwordx4 v18, s[12:15], s7 offen offset:0 nt lds
    s_waitcnt vmcnt(4)
    buffer_load_dwordx4 v18, s[12:15], s7 offen offset:1024 nt lds
    s_waitcnt vmcnt(4)
    buffer_load_dwordx4 v19, s[12:15], s7 offen offset:2048 nt lds
    s_waitcnt vmcnt(4)
    buffer_load_dwordx4 v19, s[12:15], s7 offen offset:3072 nt lds
    s_add_u32 m0, s5, 131072
    s_add_u32 s7, s69, 0
    s_and_b32 s7, s7, 3
    s_lshl_b32 s7, s7, 20
    s_add_u32 s7, s7, s66
    buffer_load_dwordx4 v28, s[24:27], s7 offen offset:0 lds
    s_waitcnt vmcnt(63)
    s_barrier
    s_add_u32 m0, s5, 49152
    s_mov_b32 s7, 229376
    s_waitcnt vmcnt(5)
    buffer_load_dwordx4 v16, s[8:11], s7 offen offset:0 nt lds
    s_waitcnt vmcnt(5)
    buffer_load_dwordx4 v16, s[8:11], s7 offen offset:1024 nt lds
    s_waitcnt vmcnt(5)
    buffer_load_dwordx4 v17, s[8:11], s7 offen offset:2048 nt lds
    s_add_u32 m0, s5, 131072
    s_add_u32 s7, s69, 0
    s_and_b32 s7, s7, 3
    s_lshl_b32 s7, s7, 20
    s_add_u32 s7, s7, s66
    buffer_load_dwordx4 v29, s[24:27], s7 offen offset:1024 lds
    s_lshl_b32 s68, s62, 4
    s_mov_b64 s[92:93], -1
    s_mov_b64 s[94:95], -1
    s_cmp_lg_u32 s4, 0
    s_cbranch_scc1 L_nomark
    s_load_dwordx4 s[92:95], s[78:79], s68
L_nomark:
    s_waitcnt vmcnt(23)
    s_barrier
    s_add_u32 m0, s5, 49152
    s_mov_b32 s7, 229376
    s_waitcnt vmcnt(6)
    buffer_load_dwordx4 v17, s[8:11], s7 offen offset:3072 nt lds
    s_add_u32 m0, s5, 114688
    s_mov_b32 s7, 163840
    s_waitcnt vmcnt(6)
    buffer_load_dwordx4 v18, s[12:15], s7 offen offset:0 nt lds
    s_waitcnt vmcnt(5)
    buffer_load_dwordx4 v18, s[12:15], s7 offen offset:1024 nt lds
    s_add_u32 m0, s5, 131072
    s_add_u32 s7, s69, 0
    s_and_b32 s7, s7, 3
    s_lshl_b32 s7, s7, 20
    s_add_u32 s7, s7, s66
    buffer_load_dwordx4 v30, s[24:27], s7 offen offset:2048 lds
    s_waitcnt vmcnt(22)
    s_barrier
    s_add_u32 m0, s5, 114688
    s_mov_b32 s7, 163840
    s_waitcnt vmcnt(6)
    buffer_load_dwordx4 v19, s[12:15], s7 offen offset:2048 nt lds
    s_waitcnt vmcnt(6)
    buffer_load_dwordx4 v19, s[12:15], s7 offen offset:3072 nt lds
    s_add_u32 m0, s5, 0
    s_mov_b32 s7, 16384
    s_waitcnt vmcnt(5)
    buffer_load_dwordx4 v16, s[8:11], s7 offen offset:0 nt lds
    s_waitcnt vmcnt(5)
    buffer_load_dwordx4 v16, s[8:11], s7 offen offset:1024 nt lds
    s_add_u32 m0, s5, 131072
    s_add_u32 s7, s69, 0
    s_and_b32 s7, s7, 3
    s_lshl_b32 s7, s7, 20
    s_add_u32 s7, s7, s66
    buffer_load_dwordx4 v31, s[24:27], s7 offen offset:3072 lds
    s_waitcnt vmcnt(22)
    s_barrier
    s_add_u32 m0, s5, 0
    s_mov_b32 s7, 16384
    s_waitcnt vmcnt(6)
    buffer_load_dwordx4 v17, s[8:11], s7 offen offset:2048 nt lds
    s_waitcnt vmcnt(5)
    buffer_load_dwordx4 v17, s[8:11], s7 offen offset:3072 nt lds
    s_add_u32 m0, s5, 81920
    s_mov_b32 s7, 229376
    s_waitcnt vmcnt(5)
    buffer_load_dwordx4 v18, s[12:15], s7 offen offset:0 nt lds
    s_add_u32 m0, s5, 147456
    s_add_u32 s7, s69, 0
    s_and_b32 s7, s7, 3
    s_lshl_b32 s7, s7, 20
    s_add_u32 s7, s7, s66
    s_add_u32 s7, s7, 0x10000
    buffer_load_dwordx4 v28, s[24:27], s7 offen offset:0 lds
    s_waitcnt vmcnt(22)
    s_barrier
    s_add_u32 m0, s5, 81920
    s_mov_b32 s7, 229376
    s_waitcnt vmcnt(6)
    buffer_load_dwordx4 v18, s[12:15], s7 offen offset:1024 nt lds
    s_waitcnt vmcnt(6)
    buffer_load_dwordx4 v19, s[12:15], s7 offen offset:2048 nt lds
    s_waitcnt vmcnt(5)
    buffer_load_dwordx4 v19, s[12:15], s7 offen offset:3072 nt lds
    s_add_u32 m0, s5, 147456
    s_add_u32 s7, s69, 0
    s_and_b32 s7, s7, 3
    s_lshl_b32 s7, s7, 20
    s_add_u32 s7, s7, s66
    s_add_u32 s7, s7, 0x10000
    buffer_load_dwordx4 v29, s[24:27], s7 offen offset:1024 lds
    s_waitcnt vmcnt(22)
    s_barrier
    s_add_u32 m0, s5, 32768
    s_mov_b32 s7, 81920
    s_waitcnt vmcnt(6)
    buffer_load_dwordx4 v16, s[8:11], s7 offen offset:0 nt lds
    s_waitcnt vmcnt(6)
    buffer_load_dwordx4 v16, s[8:11], s7 offen offset:1024 nt lds
    s_waitcnt vmcnt(5)
    buffer_load_dwordx4 v17, s[8:11], s7 offen offset:2048 nt lds
    s_waitcnt vmcnt(5)
    buffer_load_dwordx4 v17, s[8:11], s7 offen offset:3072 nt lds
    s_add_u32 m0, s5, 147456
    s_add_u32 s7, s69, 0
    s_and_b32 s7, s7, 3
    s_lshl_b32 s7, s7, 20
    s_add_u32 s7, s7, s66
    s_add_u32 s7, s7, 0x10000
    buffer_load_dwordx4 v30, s[24:27], s7 offen offset:2048 lds
    s_waitcnt vmcnt(21)
    s_barrier
    s_add_u32 m0, s5, 65536
    s_mov_b32 s7, 16384
    s_waitcnt vmcnt(6)
    buffer_load_dwordx4 v18, s[12:15], s7 offen offset:0 nt lds
    s_waitcnt vmcnt(5)
    buffer_load_dwordx4 v18, s[12:15], s7 offen offset:1024 nt lds
    s_waitcnt vmcnt(5)
    buffer_load_dwordx4 v19, s[12:15], s7 offen offset:2048 nt lds
    s_add_u32 m0, s5, 147456
    s_add_u32 s7, s69, 0
    s_and_b32 s7, s7, 3
    s_lshl_b32 s7, s7, 20
    s_add_u32 s7, s7, s66
    s_add_u32 s7, s7, 0x10000
    buffer_load_dwordx4 v31, s[24:27], s7 offen offset:3072 lds
    s_waitcnt lgkmcnt(0)
    s_and_b64 s[92:93], s[92:93], s[94:95]
    s_and_b32 s92, s92, s93
    s_cbranch_scc0 L_iwait
L_iok:
    s_waitcnt vmcnt(20)
    s_barrier
    s_add_u32 m0, s5, 65536
    s_mov_b32 s7, 16384
    s_waitcnt vmcnt(6)
    buffer_load_dwordx4 v19, s[12:15], s7 offen offset:3072 nt lds
    s_add_u32 m0, s5, 49152
    s_mov_b32 s7, 49152
    s_waitcnt vmcnt(6)
    buffer_load_dwordx4 v16, s[8:11], s7 offen offset:0 nt lds
    s_waitcnt vmcnt(5)
    buffer_load_dwordx4 v16, s[8:11], s7 offen offset:1024 nt lds
    s_waitcnt vmcnt(18)
    s_barrier
    s_waitcnt vmcnt(5)
    buffer_load_dwordx4 v17, s[8:11], s7 offen offset:2048 nt lds
    s_waitcnt vmcnt(5)
    buffer_load_dwordx4 v17, s[8:11], s7 offen offset:3072 nt lds
    s_add_u32 m0, s5, 98304
    s_mov_b32 s7, 81920
    s_waitcnt vmcnt(4)
    buffer_load_dwordx4 v18, s[12:15], s7 offen offset:0 nt lds
    s_waitcnt vmcnt(4)
    buffer_load_dwordx4 v18, s[12:15], s7 offen offset:1024 nt lds
    s_add_u32 m0, s5, 114688
    s_add_u32 s7, s69, 1
    s_and_b32 s7, s7, 3
    s_lshl_b32 s7, s7, 20
    s_add_u32 s7, s7, s66
    buffer_load_dwordx4 v28, s[24:27], s7 offen offset:0 lds
    s_waitcnt vmcnt(18)
    s_barrier
    s_add_u32 m0, s5, 98304
    s_mov_b32 s7, 81920
    s_waitcnt vmcnt(5)
    buffer_load_dwordx4 v19, s[12:15], s7 offen offset:2048 nt lds
    s_waitcnt vmcnt(5)
    buffer_load_dwordx4 v19, s[12:15], s7 offen offset:3072 nt lds
    s_add_u32 m0, s5, 16384
    s_mov_b32 s7, 114688
    s_waitcnt vmcnt(5)
    buffer_load_dwordx4 v16, s[8:11], s7 offen offset:0 nt lds
    s_add_u32 m0, s5, 114688
    s_add_u32 s7, s69, 1
    s_and_b32 s7, s7, 3
    s_lshl_b32 s7, s7, 20
    s_add_u32 s7, s7, s66
    buffer_load_dwordx4 v29, s[24:27], s7 offen offset:1024 lds
    s_waitcnt vmcnt(17)
    s_barrier
    s_add_u32 m0, s5, 16384
    s_mov_b32 s7, 114688
    s_waitcnt vmcnt(6)
    buffer_load_dwordx4 v16, s[8:11], s7 offen offset:1024 nt lds
    s_waitcnt vmcnt(6)
    buffer_load_dwordx4 v17, s[8:11], s7 offen offset:2048 nt lds
    s_waitcnt vmcnt(5)
    buffer_load_dwordx4 v17, s[8:11], s7 offen offset:3072 nt lds
    s_add_u32 m0, s5, 114688
    s_add_u32 s7, s69, 1
    s_and_b32 s7, s7, 3
    s_lshl_b32 s7, s7, 20
    s_add_u32 s7, s7, s66
    buffer_load_dwordx4 v30, s[24:27], s7 offen offset:2048 lds
    s_waitcnt vmcnt(15)
    s_barrier
    s_add_u32 m0, s5, 81920
    s_mov_b32 s7, 49152
    s_waitcnt vmcnt(6)
    buffer_load_dwordx4 v18, s[12:15], s7 offen offset:0 nt lds
    s_waitcnt vmcnt(6)
    buffer_load_dwordx4 v18, s[12:15], s7 offen offset:1024 nt lds
    s_waitcnt vmcnt(5)
    buffer_load_dwordx4 v19, s[12:15], s7 offen offset:2048 nt lds
    s_waitcnt vmcnt(5)
    buffer_load_dwordx4 v19, s[12:15], s7 offen offset:3072 nt lds
    s_add_u32 m0, s5, 114688
    s_add_u32 s7, s69, 1
    s_and_b32 s7, s7, 3
    s_lshl_b32 s7, s7, 20
    s_add_u32 s7, s7, s66
    buffer_load_dwordx4 v31, s[24:27], s7 offen offset:3072 lds
    s_waitcnt vmcnt(16)
    s_barrier
    s_add_u32 m0, s5, 32768
    s_mov_b32 s7, 147456
    s_waitcnt vmcnt(6)
    buffer_load_dwordx4 v16, s[8:11], s7 offen offset:0 nt lds
    s_waitcnt vmcnt(5)
    buffer_load_dwordx4 v16, s[8:11], s7 offen offset:1024 nt lds
    s_waitcnt vmcnt(5)
    buffer_load_dwordx4 v17, s[8:11], s7 offen offset:2048 nt lds
    s_add_u32 m0, s5, 0
    s_add_u32 s7, s69, 2
    s_and_b32 s7, s7, 3
    s_lshl_b32 s7, s7, 20
    s_add_u32 s7, s7, s66
    buffer_load_dwordx4 v28, s[24:27], s7 offen offset:0 lds
    s_waitcnt vmcnt(15)
    s_barrier
    s_add_u32 m0, s5, 32768
    s_mov_b32 s7, 147456
    s_waitcnt vmcnt(6)
    buffer_load_dwordx4 v17, s[8:11], s7 offen offset:3072 nt lds
    s_add_u32 m0, s5, 65536
    s_mov_b32 s7, 114688
    s_waitcnt vmcnt(6)
    buffer_load_dwordx4 v18, s[12:15], s7 offen offset:0 nt lds
    s_waitcnt vmcnt(5)
    buffer_load_dwordx4 v18, s[12:15], s7 offen offset:1024 nt lds
    s_add_u32 m0, s5, 0
    s_add_u32 s7, s69, 2
    s_and_b32 s7, s7, 3
    s_lshl_b32 s7, s7, 20
    s_add_u32 s7, s7, s66
    buffer_load_dwordx4 v29, s[24:27], s7 offen offset:1024 lds
    s_waitcnt vmcnt(14)
    s_barrier
    s_add_u32 m0, s5, 65536
    s_mov_b32 s7, 114688
    s_waitcnt vmcnt(6)
    buffer_load_dwordx4 v19, s[12:15], s7 offen offset:2048 nt lds
    s_waitcnt vmcnt(6)
    buffer_load_dwordx4 v19, s[12:15], s7 offen offset:3072 nt lds
    s_add_u32 m0, s5, 49152
    s_mov_b32 s7, 212992
    s_waitcnt vmcnt(5)
    buffer_load_dwordx4 v16, s[8:11], s7 offen offset:0 nt lds
    s_waitcnt vmcnt(5)
    buffer_load_dwordx4 v16, s[8:11], s7 offen offset:1024 nt lds
    s_add_u32 m0, s5, 0
    s_add_u32 s7, s69, 2
    s_and_b32 s7, s7, 3
    s_lshl_b32 s7, s7, 20
    s_add_u32 s7, s7, s66
    buffer_load_dwordx4 v30, s[24:27], s7 offen offset:2048 lds
    s_waitcnt vmcnt(14)
    s_barrier
    s_add_u32 m0, s5, 49152
    s_mov_b32 s7, 212992
    s_waitcnt vmcnt(6)
    buffer_load_dwordx4 v17, s[8:11], s7 offen offset:2048 nt lds
    s_waitcnt vmcnt(5)
    buffer_load_dwordx4 v17, s[8:11], s7 offen offset:3072 nt lds
    s_add_u32 m0, s5, 98304
    s_mov_b32 s7, 147456
    s_waitcnt vmcnt(5)
    buffer_load_dwordx4 v18, s[12:15], s7 offen offset:0 nt lds
    s_add_u32 m0, s5, 0
    s_add_u32 s7, s69, 2
    s_and_b32 s7, s7, 3
    s_lshl_b32 s7, s7, 20
    s_add_u32 s7, s7, s66
    buffer_load_dwordx4 v31, s[24:27], s7 offen offset:3072 lds
    s_waitcnt vmcnt(12)
    s_barrier
    s_add_u32 m0, s5, 98304
    s_mov_b32 s7, 147456
    s_waitcnt vmcnt(6)
    buffer_load_dwordx4 v18, s[12:15], s7 offen offset:1024 nt lds
    s_waitcnt vmcnt(6)
    buffer_load_dwordx4 v19, s[12:15], s7 offen offset:2048 nt lds
    s_waitcnt vmcnt(5)
    buffer_load_dwordx4 v19, s[12:15], s7 offen offset:3072 nt lds
    s_add_u32 m0, s5, 16384
    s_add_u32 s7, s69, 2
    s_and_b32 s7, s7, 3
    s_lshl_b32 s7, s7, 20
    s_add_u32 s7, s7, s66
    s_add_u32 s7, s7, 0x10000
    buffer_load_dwordx4 v28, s[24:27], s7 offen offset:0 lds
    s_waitcnt vmcnt(11)
    s_barrier
    s_add_u32 m0, s5, 32768
    s_mov_b32 s7, 180224
    s_waitcnt vmcnt(6)
    buffer_load_dwordx4 v16, s[8:11], s7 offen offset:0 nt lds
    s_waitcnt vmcnt(6)
    buffer_load_dwordx4 v16, s[8:11], s7 offen offset:1024 nt lds
    s_waitcnt vmcnt(5)
    buffer_load_dwordx4 v17, s[8:11], s7 offen offset:2048 nt lds
    s_waitcnt vmcnt(5)
    buffer_load_dwordx4 v17, s[8:11], s7 offen offset:3072 nt lds
    s_add_u32 m0, s5, 16384
    s_add_u32 s7, s69, 2
    s_and_b32 s7, s7, 3
    s_lshl_b32 s7, s7, 20
    s_add_u32 s7, s7, s66
    s_add_u32 s7, s7, 0x10000
    buffer_load_dwordx4 v29, s[24:27], s7 offen offset:1024 lds
    s_waitcnt vmcnt(11)
    s_barrier
    s_add_u32 m0, s5, 81920
    s_mov_b32 s7, 212992
    s_waitcnt vmcnt(6)
    buffer_load_dwordx4 v18, s[12:15], s7 offen offset:0 nt lds
    s_waitcnt vmcnt(5)
    buffer_load_dwordx4 v18, s[12:15], s7 offen offset:1024 nt lds
    s_waitcnt vmcnt(5)
    buffer_load_dwordx4 v19, s[12:15], s7 offen offset:2048 nt lds
    s_add_u32 m0, s5, 16384
    s_add_u32 s7, s69, 2
    s_and_b32 s7, s7, 3
    s_lshl_b32 s7, s7, 20
    s_add_u32 s7, s7, s66
    s_add_u32 s7, s7, 0x10000
    buffer_load_dwordx4 v30, s[24:27], s7 offen offset:2048 lds
    s_waitcnt vmcnt(10)
    s_barrier
    s_add_u32 m0, s5, 81920
    s_mov_b32 s7, 212992
    buffer_load_dwordx4 v19, s[12:15], s7 offen offset:3072 nt lds
    s_add_u32 m0, s5, 49152
    s_mov_b32 s7, 245760
    buffer_load_dwordx4 v16, s[8:11], s7 offen offset:0 nt lds
    buffer_load_dwordx4 v16, s[8:11], s7 offen offset:1024 nt lds
    buffer_load_dwordx4 v17, s[8:11], s7 offen offset:2048 nt lds
    buffer_load_dwordx4 v17, s[8:11], s7 offen offset:3072 nt lds
    s_add_u32 m0, s5, 65536
    s_mov_b32 s7, 180224
    buffer_load_dwordx4 v18, s[12:15], s7 offen offset:0 nt lds
    buffer_load_dwordx4 v18, s[12:15], s7 offen offset:1024 nt lds
    buffer_load_dwordx4 v19, s[12:15], s7 offen offset:2048 nt lds
    buffer_load_dwordx4 v19, s[12:15], s7 offen offset:3072 nt lds
    s_add_u32 m0, s5, 16384
    s_add_u32 s7, s69, 2
    s_and_b32 s7, s7, 3
    s_lshl_b32 s7, s7, 20
    s_add_u32 s7, s7, s66
    s_add_u32 s7, s7, 0x10000
    buffer_load_dwordx4 v31, s[24:27], s7 offen offset:3072 lds
    s_waitcnt vmcnt(15)
    s_barrier
    s_add_u32 m0, s5, 98304
    s_add_u32 s7, s69, 1
    s_and_b32 s7, s7, 3
    s_lshl_b32 s7, s7, 20
    s_add_u32 s7, s7, s66
    s_add_u32 s7, s7, 0x10000
    buffer_load_dwordx4 v28, s[24:27], s7 offen offset:0 lds
    s_waitcnt vmcnt(10)
    s_barrier
    s_add_u32 m0, s5, 32768
    s_mov_b32 s7, 245760
    buffer_load_dwordx4 v18, s[12:15], s7 offen offset:0 nt lds
    buffer_load_dwordx4 v18, s[12:15], s7 offen offset:1024 nt lds
    buffer_load_dwordx4 v19, s[12:15], s7 offen offset:2048 nt lds
    buffer_load_dwordx4 v19, s[12:15], s7 offen offset:3072 nt lds
    s_add_u32 m0, s5, 98304
    s_add_u32 s7, s69, 1
    s_and_b32 s7, s7, 3
    s_lshl_b32 s7, s7, 20
    s_add_u32 s7, s7, s66
    s_add_u32 s7, s7, 0x10000
    buffer_load_dwordx4 v29, s[24:27], s7 offen offset:1024 lds
    buffer_load_dwordx4 v30, s[24:27], s7 offen offset:2048 lds
    buffer_load_dwordx4 v31, s[24:27], s7 offen offset:3072 lds
    s_waitcnt vmcnt(13)
    s_barrier
    s_add_u32 m0, s5, 81920
    s_add_u32 s7, s69, 3
    s_and_b32 s7, s7, 3
    s_lshl_b32 s7, s7, 20
    s_add_u32 s7, s7, s66
    buffer_load_dwordx4 v28, s[24:27], s7 offen offset:0 lds
    buffer_load_dwordx4 v29, s[24:27], s7 offen offset:1024 lds
    buffer_load_dwordx4 v30, s[24:27], s7 offen offset:2048 lds
    buffer_load_dwordx4 v31, s[24:27], s7 offen offset:3072 lds
    s_waitcnt vmcnt(13)
    s_barrier
    s_add_u32 m0, s5, 49152
    s_add_u32 s7, s69, 3
    s_and_b32 s7, s7, 3
    s_lshl_b32 s7, s7, 20
    s_add_u32 s7, s7, s66
    s_add_u32 s7, s7, 0x10000
    buffer_load_dwordx4 v28, s[24:27], s7 offen offset:0 lds
    buffer_load_dwordx4 v29, s[24:27], s7 offen offset:1024 lds
    buffer_load_dwordx4 v30, s[24:27], s7 offen offset:2048 lds
    buffer_load_dwordx4 v31, s[24:27], s7 offen offset:3072 lds
    s_waitcnt vmcnt(11)
    s_barrier
    v_and_b32 v3, 1, v2
    v_lshlrev_b32 v3, 4, v3
    v_mov_b32 v4, 0x3f80
    v_lshlrev_b32 v4, v3, v4
    v_lshrrev_b32 v5, 3, v2
    v_lshlrev_b32 v5, 1, v5
    v_bfe_u32 v6, v2, 1, 1
    v_add_u32 v5, v5, v6
    v_bfe_u32 v6, v2, 2, 1
    v_lshlrev_b32 v6, 1, v6
    v_sub_u32 v6, v1, v6
    v_lshlrev_b32 v6, 2, v6
    v_add_u32 v5, v5, v6
    v_cmp_eq_u32 vcc, 0, v5
    s_nop 1
    v_cndmask_b32 v80, 0, v4, vcc
    v_cmp_eq_u32 vcc, 1, v5
    s_nop 1
    v_cndmask_b32 v81, 0, v4, vcc
    v_cmp_eq_u32 vcc, 2, v5
    s_nop 1
    v_cndmask_b32 v82, 0, v4, vcc
    v_cmp_eq_u32 vcc, 3, v5
    s_nop 1
    v_cndmask_b32 v83, 0, v4, vcc
    v_cmp_eq_u32 vcc, 4, v5
    s_nop 1
    v_cndmask_b32 v84, 0, v4, vcc
    v_cmp_eq_u32 vcc, 5, v5
    s_nop 1
    v_cndmask_b32 v85, 0, v4, vcc
    v_cmp_eq_u32 vcc, 6, v5
    s_nop 1
    v_cndmask_b32 v86, 0, v4, vcc
    v_cmp_eq_u32 vcc, 7, v5
    s_nop 1
    v_cndmask_b32 v87, 0, v4, vcc
    v_mov_b32 v36, 1
    v_mov_b32 v37, 1
    v_mov_b32 v38, 1
    v_mov_b32 v39, 1
    v_lshlrev_b32 v8, 4, v0
    s_mul_i32 s3, s69, 256
    s_add_u32 s83, s85, s3
    s_add_u32 s3, s69, 1
    s_and_b32 s3, s3, 3
    s_mul_i32 s3, s3, 256
    s_add_u32 s93, s85, s3
    s_add_u32 s3, s69, 2
    s_and_b32 s3, s3, 3
    s_mul_i32 s3, s3, 256
    s_add_u32 s94, s85, s3
    s_add_u32 s3, s69, 3
    s_and_b32 s3, s3, 3
    s_mul_i32 s3, s3, 256
    s_add_u32 s95, s85, s3
    s_mov_b32 s81, 0
    s_cmp_eq_u32 s4, 1
    s_cbranch_scc1 L_scout
    s_barrier
    s_cmp_lg_u32 s4, 0
    s_cbranch_scc1 L_h1ok
    s_mov_b64 exec, 0xff
    buffer_store_dwordx4 v[36:39], v8, s[40:43], s83 offen sc1
    s_mov_b64 exec, -1
    s_waitcnt vmcnt(1)
    s_branch L_h1go
L_scout:
    s_load_dword s88, s[40:41], s93 glc
    s_load_dword s89, s[40:41], s94 glc
    s_load_dword s90, s[40:41], s95 glc
    s_barrier
    s_branch L_h1t
L_h1:
    s_load_dword s88, s[40:41], s93 glc
    s_load_dword s89, s[40:41], s94 glc
    s_load_dword s90, s[40:41], s95 glc
L_h1t:
    s_add_u32 s81, s81, 1
    s_cmp_ge_u32 s81, 2097152
    s_waitcnt lgkmcnt(0)
    s_cbranch_scc1 L_h1ok
    s_and_b32 s88, s88, s89
    s_and_b32 s88, s88, s90
    s_cbranch_scc0 L_h1
L_h1ok:
    s_waitcnt vmcnt(0)
L_h1go:
    s_barrier
    s_barrier
    s_mov_b32 s81, 0
    v_add_u32 v13, 32768, v12
    s_lshl_b32 s82, 1, s60
    s_cmp_lg_u32 s60, 0
    s_cbranch_scc1 L_ho0
    ds_read_b128 v[32:35], v13
L_ho0:
    s_cmp_lg_u32 s60, 1
    s_cbranch_scc1 L_ho1
    ds_read_b128 v[36:39], v13
L_ho1:
    s_cmp_lg_u32 s60, 2
    s_cbranch_scc1 L_ho2
    ds_read_b128 v[40:43], v13
L_ho2:
    s_cmp_lg_u32 s60, 3
    s_cbranch_scc1 L_ho3
    ds_read_b128 v[44:47], v13
L_ho3:
    s_cmp_lg_u32 s60, 4
    s_cbranch_scc1 L_ho4
    ds_read_b128 v[48:51], v13
L_ho4:
    s_cmp_lg_u32 s60, 5
    s_cbranch_scc1 L_ho5
    ds_read_b128 v[52:55], v13
L_ho5:
    s_cmp_lg_u32 s60, 6
    s_cbranch_scc1 L_ho6
    ds_read_b128 v[56:59], v13
L_ho6:
    s_cmp_lg_u32 s60, 7
    s_cbranch_scc1 L_ho7
    ds_read_b128 v[60:63], v13
L_ho7:
L_hpoll:
    s_load_dwordx8 s[88:95], s[40:41], s80 glc
    s_add_u32 s81, s81, 1
    s_cmp_ge_u32 s81, 2097152
    s_cselect_b32 s86, 0xff, 0
    s_waitcnt lgkmcnt(0)
    s_or_b64 s[88:89], s[88:89], s[90:91]
    s_or_b64 s[92:93], s[92:93], s[94:95]
    s_or_b64 s[88:89], s[88:89], s[92:93]
    s_or_b32 s88, s88, s89
    s_and_b32 s88, s88, 0xff
    s_or_b32 s86, s86, s88
    s_andn2_b32 s86, s86, s82
    s_cbranch_scc0 L_hpoll
    s_or_b32 s82, s82, s86
    s_bitcmp1_b32 s86, 0
    s_cbranch_scc0 L_hs0
    s_mov_b32 s7, 0
    buffer_load_dwordx4 v[32:35], v12, s[44:47], s7 offen sc1
L_hs0:
    s_bitcmp1_b32 s86, 1
    s_cbranch_scc0 L_hs1
    s_mov_b32 s7, 4096
    buffer_load_dwordx4 v[36:39], v12, s[44:47], s7 offen sc1
L_hs1:
    s_bitcmp1_b32 s86, 2
    s_cbranch_scc0 L_hs2
    s_mov_b32 s7, 8192
    buffer_load_dwordx4 v[40:43], v12, s[44:47], s7 offen sc1
L_hs2:
    s_bitcmp1_b32 s86, 3
    s_cbranch_scc0 L_hs3
    s_mov_b32 s7, 12288
    buffer_load_dwordx4 v[44:47], v12, s[44:47], s7 offen sc1
L_hs3:
    s_bitcmp1_b32 s86, 4
    s_cbranch_scc0 L_hs4
    s_mov_b32 s7, 16384
    buffer_load_dwordx4 v[48:51], v12, s[44:47], s7 offen sc1
L_hs4:
    s_bitcmp1_b32 s86, 5
    s_cbranch_scc0 L_hs5
    s_mov_b32 s7, 20480
    buffer_load_dwordx4 v[52:55], v12, s[44:47], s7 offen sc1
L_hs5:
    s_bitcmp1_b32 s86, 6
    s_cbranch_scc0 L_hs6
    s_mov_b32 s7, 24576
    buffer_load_dwordx4 v[56:59], v12, s[44:47], s7 offen sc1
L_hs6:
    s_bitcmp1_b32 s86, 7
    s_cbranch_scc0 L_hs7
    s_mov_b32 s7, 28672
    buffer_load_dwordx4 v[60:63], v12, s[44:47], s7 offen sc1
L_hs7:
    s_cmp_eq_u32 s82, 0xff
    s_cbranch_scc0 L_hpoll
    s_waitcnt vmcnt(0)
    v_mfma_f32_16x16x32_bf16 v[64:67], v[80:83], v[32:35], 0
    v_mfma_f32_16x16x32_bf16 v[64:67], v[80:83], v[36:39], v[64:67]
    v_mfma_f32_16x16x32_bf16 v[64:67], v[80:83], v[40:43], v[64:67]
    v_mfma_f32_16x16x32_bf16 v[64:67], v[80:83], v[44:47], v[64:67]
    v_mfma_f32_16x16x32_bf16 v[64:67], v[80:83], v[48:51], v[64:67]
    v_mfma_f32_16x16x32_bf16 v[64:67], v[80:83], v[52:55], v[64:67]
    v_mfma_f32_16x16x32_bf16 v[64:67], v[80:83], v[56:59], v[64:67]
    v_mfma_f32_16x16x32_bf16 v[64:67], v[80:83], v[60:63], v[64:67]
    v_mfma_f32_16x16x32_bf16 v[68:71], v[84:87], v[32:35], 0
    v_mfma_f32_16x16x32_bf16 v[68:71], v[84:87], v[36:39], v[68:71]
    v_mfma_f32_16x16x32_bf16 v[68:71], v[84:87], v[40:43], v[68:71]
    v_mfma_f32_16x16x32_bf16 v[68:71], v[84:87], v[44:47], v[68:71]
    v_mfma_f32_16x16x32_bf16 v[68:71], v[84:87], v[48:51], v[68:71]
    v_mfma_f32_16x16x32_bf16 v[68:71], v[84:87], v[52:55], v[68:71]
    v_mfma_f32_16x16x32_bf16 v[68:71], v[84:87], v[56:59], v[68:71]
    v_mfma_f32_16x16x32_bf16 v[68:71], v[84:87], v[60:63], v[68:71]
    v_cvt_pk_bf16_f32 v64, v64, v65
    v_cvt_pk_bf16_f32 v65, v66, v67
    s_nop 5
    v_cvt_pk_bf16_f32 v66, v68, v69
    v_cvt_pk_bf16_f32 v67, v70, v71
    buffer_store_dwordx4 v[64:67], v11, s[32:35], s37 offen nt
    s_endpgm
L_iwait:
    v_lshlrev_b32 v8, 2, v0
    v_add_u32 v8, s68, v8
    s_mov_b32 s81, 0
    s_mov_b64 exec, 15
L_ipoll:
    global_load_dword v9, v8, s[78:79] sc1
    s_add_u32 s81, s81, 1
    s_cmp_ge_u32 s81, 2097152
    s_waitcnt vmcnt(0)
    s_cbranch_scc1 L_ipok
    v_cmp_ne_u32 vcc, 0, v9
    s_nop 0
    s_cmp_eq_u32 vcc_lo, 15
    s_cbranch_scc0 L_ipoll
L_ipok:
    s_mov_b64 exec, -1
    s_branch L_iok
L_attn:
    s_getpc_b64 s[40:41]
L_pc:
    s_sub_u32 s40, s40, L_pc-standalone__mha_block_cached__near_ridge_kernel
    s_subb_u32 s41, s41, 0
    s_lshl_b32 s3, s61, 2
    s_add_u32 s3, s3, s4
    s_lshl_b32 s3, s3, 9
    v_and_b32 v1, 3, v0
    v_lshlrev_b32 v1, 7, v1
    v_add_u32 v1, s3, v1
    v_min_u32 v1, L_end-standalone__mha_block_cached__near_ridge_kernel, v1
    global_load_dword v247, v1, s[40:41]
    v_and_b32 v245, 15, v0
    v_lshrrev_b32 v246, 4, v0
    v_and_b32 v1, 12, v245
    v_lshlrev_b32 v1, 1, v1
    v_and_b32 v2, 3, v245
    v_or_b32 v1, v1, v2
    v_lshlrev_b32 v1, 8, v1
    v_and_b32 v2, 1, v246
    v_lshlrev_b32 v2, 1, v2
    v_lshrrev_b32 v3, 1, v246
    v_or_b32 v2, v2, v3
    v_lshlrev_b32 v10, 4, v2
    v_add_u32 v10, v1, v10
    v_xor_b32 v2, v2, v245
    v_lshlrev_b32 v2, 4, v2
    v_add_u32 v16, v1, v2
    v_xor_b32 v17, 64, v16
    v_xor_b32 v18, 0x80, v16
    v_xor_b32 v19, 0xc0, v16
    v_lshrrev_b32 v1, 2, v245
    v_lshlrev_b32 v2, 3, v246
    v_add_u32 v2, v2, v1
    v_lshlrev_b32 v2, 8, v2
    v_and_b32 v3, 1, v246
    v_lshlrev_b32 v3, 2, v3
    v_or_b32 v1, v1, v3
    v_lshlrev_b32 v1, 5, v1
    v_add_u32 v2, v2, v1
    v_and_b32 v1, 3, v0
    v_lshlrev_b32 v1, 3, v1
    v_add_u32 v2, v2, v1
    v_add_u32 v20, 65536, v2
    v_xor_b32 v21, 32, v20
    v_xor_b32 v22, 64, v20
    v_xor_b32 v23, 96, v20
    v_xor_b32 v24, 128, v20
    v_xor_b32 v25, 160, v20
    v_xor_b32 v26, 192, v20
    v_xor_b32 v27, 224, v20
    v_lshrrev_b32 v1, 1, v245
    v_xor_b32 v1, v1, v246
    v_lshlrev_b32 v1, 4, v1
    v_lshlrev_b32 v2, 7, v245
    v_add_u32 v1, v1, v2
    s_lshl_b32 s5, s4, 12
    s_add_u32 s3, s5, 98304
    v_add_u32 v28, s3, v1
    v_xor_b32 v29, 64, v28
    v_lshlrev_b32 v31, 4, v0
    s_mov_b32 s84, 0x3e0293ee
    s_mov_b32 s85, 0x3e0293ee
    s_mov_b32 s36, 0x48800000
    v_and_b32 v1, 3, v0
    v_cmp_eq_u32 vcc, 0, v1
    v_mov_b32 v2, 0x3f803f80
    s_nop 0
    v_cndmask_b32 v32, 0, v2, vcc
    v_cndmask_b32 v33, 0, v2, vcc
    v_cndmask_b32 v34, 0, v2, vcc
    v_cndmask_b32 v35, 0, v2, vcc
    s_lshl_b32 s3, s4, 3
    s_add_u32 s3, s3, s60
    s_lshl_b32 s65, s62, 5
    s_add_u32 s3, s3, s65
    s_lshl_b32 s3, s3, 15
    s_lshl_b32 s68, s69, 13
    s_mov_b32 s30, 0x8000
    s_mov_b32 s31, 0x20000
    s_mul_i32 s66, s69, 4096
    s_mul_i32 s67, s4, 512
    s_add_u32 s67, s67, s66
    s_add_u32 s67, s67, 2048
    s_lshl_b32 s7, s60, 2
    s_add_u32 s67, s67, s7
    s_lshl_b32 s6, s69, 3
    s_add_u32 s6, s6, s65
    s_lshl_b32 s6, s6, 15
    s_add_u32 s6, s6, 33554432
    s_lshl_b32 s37, s4, 16
    s_lshl_b32 s7, s60, 12
    s_add_u32 s37, s37, s7
    s_add_u32 s64, s37, 0x8000
    s_lshl_b32 s82, s62, 2
    s_add_u32 s82, s82, s69
    s_lshl_b32 s82, s82, 2
    s_mul_i32 s7, s62, 16384
    s_add_u32 s7, s7, 16777216
    s_mov_b32 s46, 0x40000
    s_mov_b32 s47, 0x20000
    s_mov_b32 s42, 16384
    s_mov_b32 s43, 0x20000
    v_lshlrev_b32 v12, 4, v0
    v_mul_u32_u24 v11, 256, v0
    s_waitcnt lgkmcnt(0)
    s_add_u32 s28, s58, s3
    s_addc_u32 s29, s59, 0
    s_add_u32 s44, s58, s6
    s_addc_u32 s45, s59, 0
    s_add_u32 s40, s58, s7
    s_addc_u32 s41, s59, 0
    s_add_u32 s3, s65, s63
    s_lshl_b32 s3, s3, 18
    s_add_u32 s8, s50, s3
    s_addc_u32 s9, s51, 0
    s_mov_b32 s10, 0x40000
    s_mov_b32 s11, 0x20000
    s_lshl_b32 s86, s69, 1
    s_add_u32 s86, s86, s62
    s_xor_b32 s86, s86, s60
    s_and_b32 s86, s86, 7
    s_or_b32 s86, s86, s4
    s_cmp_eq_u32 s86, 0
    s_cbranch_scc1 L_clear
L_cleared:
    s_barrier
    ds_read_b128 v[180:183], v28 offset:16384
    ds_read_b128 v[188:191], v29 offset:16384
    ds_read_b128 v[192:195], v29 offset:18432
    ds_read_b128 v[184:187], v28 offset:18432
    ds_read_b64_tr_b16 v[212:213], v20 offset:0
    ds_read_b64_tr_b16 v[214:215], v20 offset:1024
    ds_read_b64_tr_b16 v[216:217], v20 offset:8192
    ds_read_b64_tr_b16 v[218:219], v20 offset:9216
    ds_read_b64_tr_b16 v[220:221], v21 offset:0
    ds_read_b64_tr_b16 v[222:223], v21 offset:1024
    ds_read_b64_tr_b16 v[224:225], v21 offset:8192
    ds_read_b64_tr_b16 v[226:227], v21 offset:9216
    s_waitcnt lgkmcnt(4)
    v_mfma_f32_16x16x32_bf16 v[84:87], v[212:215], v[180:183], 0
    ds_read_b64_tr_b16 v[228:229], v22 offset:0
    v_mfma_f32_16x16x32_bf16 v[84:87], v[216:219], v[188:191], v[84:87]
    ds_read_b64_tr_b16 v[230:231], v22 offset:1024
    v_mfma_f32_16x16x32_bf16 v[92:95], v[216:219], v[192:195], 0
    ds_read_b64_tr_b16 v[232:233], v22 offset:8192
    v_mfma_f32_16x16x32_bf16 v[92:95], v[212:215], v[184:187], v[92:95]
    ds_read_b64_tr_b16 v[234:235], v22 offset:9216
    s_waitcnt lgkmcnt(4)
    v_mfma_f32_16x16x32_bf16 v[96:99], v[220:223], v[184:187], 0
    ds_read_b64_tr_b16 v[236:237], v23 offset:0
    v_mfma_f32_16x16x32_bf16 v[96:99], v[224:227], v[192:195], v[96:99]
    ds_read_b64_tr_b16 v[238:239], v23 offset:1024
    v_mfma_f32_16x16x32_bf16 v[88:91], v[224:227], v[188:191], 0
    ds_read_b64_tr_b16 v[240:241], v23 offset:8192
    v_mfma_f32_16x16x32_bf16 v[88:91], v[220:223], v[180:183], v[88:91]
    ds_read_b64_tr_b16 v[242:243], v23 offset:9216
    s_waitcnt lgkmcnt(4)
    v_mfma_f32_16x16x32_bf16 v[100:103], v[228:231], v[180:183], 0
    ds_read_b64_tr_b16 v[212:213], v24 offset:0
    v_mfma_f32_16x16x32_bf16 v[100:103], v[232:235], v[188:191], v[100:103]
    ds_read_b64_tr_b16 v[214:215], v24 offset:1024
    v_mfma_f32_16x16x32_bf16 v[108:111], v[232:235], v[192:195], 0
    ds_read_b64_tr_b16 v[216:217], v24 offset:8192
    v_mfma_f32_16x16x32_bf16 v[108:111], v[228:231], v[184:187], v[108:111]
    ds_read_b64_tr_b16 v[218:219], v24 offset:9216
    s_waitcnt lgkmcnt(4)
    v_mfma_f32_16x16x32_bf16 v[112:115], v[236:239], v[184:187], 0
    ds_read_b64_tr_b16 v[220:221], v25 offset:0
    v_mfma_f32_16x16x32_bf16 v[112:115], v[240:243], v[192:195], v[112:115]
    ds_read_b64_tr_b16 v[222:223], v25 offset:1024
    v_mfma_f32_16x16x32_bf16 v[104:107], v[240:243], v[188:191], 0
    ds_read_b64_tr_b16 v[224:225], v25 offset:8192
    v_mfma_f32_16x16x32_bf16 v[104:107], v[236:239], v[180:183], v[104:107]
    ds_read_b64_tr_b16 v[226:227], v25 offset:9216
    s_waitcnt lgkmcnt(4)
    v_mfma_f32_16x16x32_bf16 v[116:119], v[212:215], v[180:183], 0
    ds_read_b64_tr_b16 v[228:229], v26 offset:0
    v_mfma_f32_16x16x32_bf16 v[116:119], v[216:219], v[188:191], v[116:119]
    ds_read_b64_tr_b16 v[230:231], v26 offset:1024
    v_mfma_f32_16x16x32_bf16 v[124:127], v[216:219], v[192:195], 0
    ds_read_b64_tr_b16 v[232:233], v26 offset:8192
    v_mfma_f32_16x16x32_bf16 v[124:127], v[212:215], v[184:187], v[124:127]
    ds_read_b64_tr_b16 v[234:235], v26 offset:9216
    s_waitcnt lgkmcnt(4)
    v_mfma_f32_16x16x32_bf16 v[128:131], v[220:223], v[184:187], 0
    ds_read_b64_tr_b16 v[236:237], v27 offset:0
    v_mfma_f32_16x16x32_bf16 v[128:131], v[224:227], v[192:195], v[128:131]
    ds_read_b64_tr_b16 v[238:239], v27 offset:1024
    v_mfma_f32_16x16x32_bf16 v[120:123], v[224:227], v[188:191], 0
    ds_read_b64_tr_b16 v[240:241], v27 offset:8192
    v_mfma_f32_16x16x32_bf16 v[120:123], v[220:223], v[180:183], v[120:123]
    ds_read_b64_tr_b16 v[242:243], v27 offset:9216
    s_waitcnt lgkmcnt(4)
    v_mfma_f32_16x16x32_bf16 v[132:135], v[228:231], v[180:183], 0
    v_mfma_f32_16x16x32_bf16 v[132:135], v[232:235], v[188:191], v[132:135]
    s_waitcnt lgkmcnt(0)
    s_barrier
    ds_read_b128 v[196:199], v28 offset:32768
    ds_read_b128 v[204:207], v29 offset:32768
    ds_read_b128 v[208:211], v29 offset:34816
    ds_read_b128 v[200:203], v28 offset:34816
    ds_read_b64_tr_b16 v[212:213], v20 offset:16384
    ds_read_b64_tr_b16 v[214:215], v20 offset:17408
    v_mfma_f32_16x16x32_bf16 v[140:143], v[232:235], v[192:195], 0
    ds_read_b64_tr_b16 v[216:217], v20 offset:24576
    v_mfma_f32_16x16x32_bf16 v[140:143], v[228:231], v[184:187], v[140:143]
    ds_read_b64_tr_b16 v[218:219], v20 offset:25600
    v_mfma_f32_16x16x32_bf16 v[144:147], v[236:239], v[184:187], 0
    ds_read_b64_tr_b16 v[220:221], v21 offset:16384
    v_mfma_f32_16x16x32_bf16 v[144:147], v[240:243], v[192:195], v[144:147]
    ds_read_b64_tr_b16 v[222:223], v21 offset:17408
    v_mfma_f32_16x16x32_bf16 v[136:139], v[240:243], v[188:191], 0
    ds_read_b64_tr_b16 v[224:225], v21 offset:24576
    v_mfma_f32_16x16x32_bf16 v[136:139], v[236:239], v[180:183], v[136:139]
    ds_read_b64_tr_b16 v[226:227], v21 offset:25600
    s_waitcnt lgkmcnt(4)
    v_mfma_f32_16x16x32_bf16 v[84:87], v[212:215], v[196:199], v[84:87]
    ds_read_b64_tr_b16 v[228:229], v22 offset:16384
    v_mfma_f32_16x16x32_bf16 v[84:87], v[216:219], v[204:207], v[84:87]
    ds_read_b64_tr_b16 v[230:231], v22 offset:17408
    v_mfma_f32_16x16x32_bf16 v[92:95], v[216:219], v[208:211], v[92:95]
    ds_read_b64_tr_b16 v[232:233], v22 offset:24576
    v_mfma_f32_16x16x32_bf16 v[92:95], v[212:215], v[200:203], v[92:95]
    ds_read_b64_tr_b16 v[234:235], v22 offset:25600
    s_waitcnt lgkmcnt(4)
    v_mfma_f32_16x16x32_bf16 v[96:99], v[220:223], v[200:203], v[96:99]
    ds_read_b64_tr_b16 v[236:237], v23 offset:16384
    v_mfma_f32_16x16x32_bf16 v[96:99], v[224:227], v[208:211], v[96:99]
    ds_read_b64_tr_b16 v[238:239], v23 offset:17408
    v_mfma_f32_16x16x32_bf16 v[88:91], v[224:227], v[204:207], v[88:91]
    ds_read_b64_tr_b16 v[240:241], v23 offset:24576
    v_mfma_f32_16x16x32_bf16 v[88:91], v[220:223], v[196:199], v[88:91]
    ds_read_b64_tr_b16 v[242:243], v23 offset:25600
    s_waitcnt lgkmcnt(4)
    v_mfma_f32_16x16x32_bf16 v[100:103], v[228:231], v[196:199], v[100:103]
    ds_read_b64_tr_b16 v[212:213], v24 offset:16384
    v_mfma_f32_16x16x32_bf16 v[100:103], v[232:235], v[204:207], v[100:103]
    ds_read_b64_tr_b16 v[214:215], v24 offset:17408
    v_mfma_f32_16x16x32_bf16 v[108:111], v[232:235], v[208:211], v[108:111]
    ds_read_b64_tr_b16 v[216:217], v24 offset:24576
    v_mfma_f32_16x16x32_bf16 v[108:111], v[228:231], v[200:203], v[108:111]
    ds_read_b64_tr_b16 v[218:219], v24 offset:25600
    s_waitcnt lgkmcnt(4)
    v_mfma_f32_16x16x32_bf16 v[112:115], v[236:239], v[200:203], v[112:115]
    ds_read_b64_tr_b16 v[220:221], v25 offset:16384
    v_mfma_f32_16x16x32_bf16 v[112:115], v[240:243], v[208:211], v[112:115]
    ds_read_b64_tr_b16 v[222:223], v25 offset:17408
    v_mfma_f32_16x16x32_bf16 v[104:107], v[240:243], v[204:207], v[104:107]
    ds_read_b64_tr_b16 v[224:225], v25 offset:24576
    v_mfma_f32_16x16x32_bf16 v[104:107], v[236:239], v[196:199], v[104:107]
    ds_read_b64_tr_b16 v[226:227], v25 offset:25600
    s_waitcnt lgkmcnt(4)
    v_mfma_f32_16x16x32_bf16 v[116:119], v[212:215], v[196:199], v[116:119]
    ds_read_b64_tr_b16 v[228:229], v26 offset:16384
    v_mfma_f32_16x16x32_bf16 v[116:119], v[216:219], v[204:207], v[116:119]
    ds_read_b64_tr_b16 v[230:231], v26 offset:17408
    v_mfma_f32_16x16x32_bf16 v[124:127], v[216:219], v[208:211], v[124:127]
    ds_read_b64_tr_b16 v[232:233], v26 offset:24576
    v_mfma_f32_16x16x32_bf16 v[124:127], v[212:215], v[200:203], v[124:127]
    ds_read_b64_tr_b16 v[234:235], v26 offset:25600
    s_waitcnt lgkmcnt(4)
    v_mfma_f32_16x16x32_bf16 v[128:131], v[220:223], v[200:203], v[128:131]
    ds_read_b64_tr_b16 v[236:237], v27 offset:16384
    v_mfma_f32_16x16x32_bf16 v[128:131], v[224:227], v[208:211], v[128:131]
    ds_read_b64_tr_b16 v[238:239], v27 offset:17408
    v_mfma_f32_16x16x32_bf16 v[120:123], v[224:227], v[204:207], v[120:123]
    ds_read_b64_tr_b16 v[240:241], v27 offset:24576
    v_mfma_f32_16x16x32_bf16 v[120:123], v[220:223], v[196:199], v[120:123]
    ds_read_b64_tr_b16 v[242:243], v27 offset:25600
    s_waitcnt lgkmcnt(4)
    v_mfma_f32_16x16x32_bf16 v[132:135], v[228:231], v[196:199], v[132:135]
    v_mfma_f32_16x16x32_bf16 v[132:135], v[232:235], v[204:207], v[132:135]
    s_waitcnt lgkmcnt(0)
    s_barrier
    ds_read_b128 v[180:183], v28 offset:49152
    ds_read_b128 v[188:191], v29 offset:49152
    ds_read_b128 v[192:195], v29 offset:51200
    ds_read_b128 v[184:187], v28 offset:51200
    ds_read_b64_tr_b16 v[212:213], v20 offset:32768
    ds_read_b64_tr_b16 v[214:215], v20 offset:33792
    v_mfma_f32_16x16x32_bf16 v[140:143], v[232:235], v[208:211], v[140:143]
    ds_read_b64_tr_b16 v[216:217], v20 offset:40960
    v_mfma_f32_16x16x32_bf16 v[140:143], v[228:231], v[200:203], v[140:143]
    ds_read_b64_tr_b16 v[218:219], v20 offset:41984
    v_mfma_f32_16x16x32_bf16 v[144:147], v[236:239], v[200:203], v[144:147]
    ds_read_b64_tr_b16 v[220:221], v21 offset:32768
    v_mfma_f32_16x16x32_bf16 v[144:147], v[240:243], v[208:211], v[144:147]
    ds_read_b64_tr_b16 v[222:223], v21 offset:33792
    v_mfma_f32_16x16x32_bf16 v[136:139], v[240:243], v[204:207], v[136:139]
    ds_read_b64_tr_b16 v[224:225], v21 offset:40960
    v_mfma_f32_16x16x32_bf16 v[136:139], v[236:239], v[196:199], v[136:139]
    ds_read_b64_tr_b16 v[226:227], v21 offset:41984
    s_waitcnt lgkmcnt(4)
    v_mfma_f32_16x16x32_bf16 v[84:87], v[212:215], v[180:183], v[84:87]
    ds_read_b64_tr_b16 v[228:229], v22 offset:32768
    v_mfma_f32_16x16x32_bf16 v[84:87], v[216:219], v[188:191], v[84:87]
    ds_read_b64_tr_b16 v[230:231], v22 offset:33792
    v_mfma_f32_16x16x32_bf16 v[92:95], v[216:219], v[192:195], v[92:95]
    ds_read_b64_tr_b16 v[232:233], v22 offset:40960
    v_mfma_f32_16x16x32_bf16 v[92:95], v[212:215], v[184:187], v[92:95]
    ds_read_b64_tr_b16 v[234:235], v22 offset:41984
    s_waitcnt lgkmcnt(4)
    v_mfma_f32_16x16x32_bf16 v[96:99], v[220:223], v[184:187], v[96:99]
    ds_read_b64_tr_b16 v[236:237], v23 offset:32768
    v_mfma_f32_16x16x32_bf16 v[96:99], v[224:227], v[192:195], v[96:99]
    ds_read_b64_tr_b16 v[238:239], v23 offset:33792
    v_mfma_f32_16x16x32_bf16 v[88:91], v[224:227], v[188:191], v[88:91]
    ds_read_b64_tr_b16 v[240:241], v23 offset:40960
    v_mfma_f32_16x16x32_bf16 v[88:91], v[220:223], v[180:183], v[88:91]
    ds_read_b64_tr_b16 v[242:243], v23 offset:41984
    s_waitcnt lgkmcnt(4)
    v_mfma_f32_16x16x32_bf16 v[100:103], v[228:231], v[180:183], v[100:103]
    ds_read_b64_tr_b16 v[212:213], v24 offset:32768
    v_mfma_f32_16x16x32_bf16 v[100:103], v[232:235], v[188:191], v[100:103]
    ds_read_b64_tr_b16 v[214:215], v24 offset:33792
    v_mfma_f32_16x16x32_bf16 v[108:111], v[232:235], v[192:195], v[108:111]
    ds_read_b64_tr_b16 v[216:217], v24 offset:40960
    v_mfma_f32_16x16x32_bf16 v[108:111], v[228:231], v[184:187], v[108:111]
    ds_read_b64_tr_b16 v[218:219], v24 offset:41984
    s_waitcnt lgkmcnt(4)
    v_mfma_f32_16x16x32_bf16 v[112:115], v[236:239], v[184:187], v[112:115]
    ds_read_b64_tr_b16 v[220:221], v25 offset:32768
    v_mfma_f32_16x16x32_bf16 v[112:115], v[240:243], v[192:195], v[112:115]
    ds_read_b64_tr_b16 v[222:223], v25 offset:33792
    v_mfma_f32_16x16x32_bf16 v[104:107], v[240:243], v[188:191], v[104:107]
    ds_read_b64_tr_b16 v[224:225], v25 offset:40960
    v_mfma_f32_16x16x32_bf16 v[104:107], v[236:239], v[180:183], v[104:107]
    ds_read_b64_tr_b16 v[226:227], v25 offset:41984
    s_waitcnt lgkmcnt(4)
    v_mfma_f32_16x16x32_bf16 v[116:119], v[212:215], v[180:183], v[116:119]
    ds_read_b64_tr_b16 v[228:229], v26 offset:32768
    v_mfma_f32_16x16x32_bf16 v[116:119], v[216:219], v[188:191], v[116:119]
    ds_read_b64_tr_b16 v[230:231], v26 offset:33792
    v_mfma_f32_16x16x32_bf16 v[124:127], v[216:219], v[192:195], v[124:127]
    ds_read_b64_tr_b16 v[232:233], v26 offset:40960
    v_mfma_f32_16x16x32_bf16 v[124:127], v[212:215], v[184:187], v[124:127]
    ds_read_b64_tr_b16 v[234:235], v26 offset:41984
    s_waitcnt lgkmcnt(4)
    v_mfma_f32_16x16x32_bf16 v[128:131], v[220:223], v[184:187], v[128:131]
    ds_read_b64_tr_b16 v[236:237], v27 offset:32768
    v_mfma_f32_16x16x32_bf16 v[128:131], v[224:227], v[192:195], v[128:131]
    ds_read_b64_tr_b16 v[238:239], v27 offset:33792
    v_mfma_f32_16x16x32_bf16 v[120:123], v[224:227], v[188:191], v[120:123]
    ds_read_b64_tr_b16 v[240:241], v27 offset:40960
    v_mfma_f32_16x16x32_bf16 v[120:123], v[220:223], v[180:183], v[120:123]
    ds_read_b64_tr_b16 v[242:243], v27 offset:41984
    s_waitcnt lgkmcnt(4)
    v_mfma_f32_16x16x32_bf16 v[132:135], v[228:231], v[180:183], v[132:135]
    v_mfma_f32_16x16x32_bf16 v[132:135], v[232:235], v[188:191], v[132:135]
    s_waitcnt lgkmcnt(0)
    s_barrier
    ds_read_b128 v[196:199], v28 offset:16384
    ds_read_b128 v[204:207], v29 offset:16384
    ds_read_b128 v[208:211], v29 offset:18432
    ds_read_b128 v[200:203], v28 offset:18432
    ds_read_b64_tr_b16 v[212:213], v20 offset:0
    ds_read_b64_tr_b16 v[214:215], v20 offset:1024
    v_mfma_f32_16x16x32_bf16 v[140:143], v[232:235], v[192:195], v[140:143]
    ds_read_b64_tr_b16 v[216:217], v20 offset:8192
    v_mfma_f32_16x16x32_bf16 v[140:143], v[228:231], v[184:187], v[140:143]
    ds_read_b64_tr_b16 v[218:219], v20 offset:9216
    v_mfma_f32_16x16x32_bf16 v[144:147], v[236:239], v[184:187], v[144:147]
    ds_read_b64_tr_b16 v[220:221], v21 offset:0
    v_mfma_f32_16x16x32_bf16 v[144:147], v[240:243], v[192:195], v[144:147]
    ds_read_b64_tr_b16 v[222:223], v21 offset:1024
    v_mfma_f32_16x16x32_bf16 v[136:139], v[240:243], v[188:191], v[136:139]
    ds_read_b64_tr_b16 v[224:225], v21 offset:8192
    v_mfma_f32_16x16x32_bf16 v[136:139], v[236:239], v[180:183], v[136:139]
    ds_read_b64_tr_b16 v[226:227], v21 offset:9216
    s_waitcnt lgkmcnt(4)
    v_mfma_f32_16x16x32_bf16 v[84:87], v[212:215], v[196:199], v[84:87]
    ds_read_b64_tr_b16 v[228:229], v22 offset:0
    v_mfma_f32_16x16x32_bf16 v[84:87], v[216:219], v[204:207], v[84:87]
    ds_read_b64_tr_b16 v[230:231], v22 offset:1024
    v_mfma_f32_16x16x32_bf16 v[92:95], v[216:219], v[208:211], v[92:95]
    ds_read_b64_tr_b16 v[232:233], v22 offset:8192
    v_mfma_f32_16x16x32_bf16 v[92:95], v[212:215], v[200:203], v[92:95]
    ds_read_b64_tr_b16 v[234:235], v22 offset:9216
    s_waitcnt lgkmcnt(4)
    v_mfma_f32_16x16x32_bf16 v[96:99], v[220:223], v[200:203], v[96:99]
    ds_read_b64_tr_b16 v[236:237], v23 offset:0
    v_mfma_f32_16x16x32_bf16 v[96:99], v[224:227], v[208:211], v[96:99]
    ds_read_b64_tr_b16 v[238:239], v23 offset:1024
    v_mfma_f32_16x16x32_bf16 v[88:91], v[224:227], v[204:207], v[88:91]
    ds_read_b64_tr_b16 v[240:241], v23 offset:8192
    v_mfma_f32_16x16x32_bf16 v[88:91], v[220:223], v[196:199], v[88:91]
    ds_read_b64_tr_b16 v[242:243], v23 offset:9216
    s_waitcnt lgkmcnt(4)
    v_mfma_f32_16x16x32_bf16 v[100:103], v[228:231], v[196:199], v[100:103]
    ds_read_b64_tr_b16 v[212:213], v24 offset:0
    v_mfma_f32_16x16x32_bf16 v[100:103], v[232:235], v[204:207], v[100:103]
    ds_read_b64_tr_b16 v[214:215], v24 offset:1024
    v_mfma_f32_16x16x32_bf16 v[108:111], v[232:235], v[208:211], v[108:111]
    ds_read_b64_tr_b16 v[216:217], v24 offset:8192
    v_mfma_f32_16x16x32_bf16 v[108:111], v[228:231], v[200:203], v[108:111]
    ds_read_b64_tr_b16 v[218:219], v24 offset:9216
    s_waitcnt lgkmcnt(4)
    v_mfma_f32_16x16x32_bf16 v[112:115], v[236:239], v[200:203], v[112:115]
    ds_read_b64_tr_b16 v[220:221], v25 offset:0
    v_mfma_f32_16x16x32_bf16 v[112:115], v[240:243], v[208:211], v[112:115]
    ds_read_b64_tr_b16 v[222:223], v25 offset:1024
    v_mfma_f32_16x16x32_bf16 v[104:107], v[240:243], v[204:207], v[104:107]
    ds_read_b64_tr_b16 v[224:225], v25 offset:8192
    v_mfma_f32_16x16x32_bf16 v[104:107], v[236:239], v[196:199], v[104:107]
    ds_read_b64_tr_b16 v[226:227], v25 offset:9216
    s_waitcnt lgkmcnt(4)
    v_mfma_f32_16x16x32_bf16 v[116:119], v[212:215], v[196:199], v[116:119]
    ds_read_b64_tr_b16 v[228:229], v26 offset:0
    v_mfma_f32_16x16x32_bf16 v[116:119], v[216:219], v[204:207], v[116:119]
    ds_read_b64_tr_b16 v[230:231], v26 offset:1024
    v_mfma_f32_16x16x32_bf16 v[124:127], v[216:219], v[208:211], v[124:127]
    ds_read_b64_tr_b16 v[232:233], v26 offset:8192
    v_mfma_f32_16x16x32_bf16 v[124:127], v[212:215], v[200:203], v[124:127]
    ds_read_b64_tr_b16 v[234:235], v26 offset:9216
    s_waitcnt lgkmcnt(4)
    v_mfma_f32_16x16x32_bf16 v[128:131], v[220:223], v[200:203], v[128:131]
    ds_read_b64_tr_b16 v[236:237], v27 offset:0
    v_mfma_f32_16x16x32_bf16 v[128:131], v[224:227], v[208:211], v[128:131]
    ds_read_b64_tr_b16 v[238:239], v27 offset:1024
    v_mfma_f32_16x16x32_bf16 v[120:123], v[224:227], v[204:207], v[120:123]
    ds_read_b64_tr_b16 v[240:241], v27 offset:8192
    v_mfma_f32_16x16x32_bf16 v[120:123], v[220:223], v[196:199], v[120:123]
    ds_read_b64_tr_b16 v[242:243], v27 offset:9216
    s_waitcnt lgkmcnt(4)
    v_mfma_f32_16x16x32_bf16 v[132:135], v[228:231], v[196:199], v[132:135]
    v_mfma_f32_16x16x32_bf16 v[132:135], v[232:235], v[204:207], v[132:135]
    s_waitcnt lgkmcnt(0)
    s_barrier
    ds_read_b128 v[180:183], v28 offset:32768
    ds_read_b128 v[188:191], v29 offset:32768
    ds_read_b128 v[192:195], v29 offset:34816
    ds_read_b128 v[184:187], v28 offset:34816
    ds_read_b64_tr_b16 v[212:213], v20 offset:16384
    ds_read_b64_tr_b16 v[214:215], v20 offset:17408
    v_mfma_f32_16x16x32_bf16 v[140:143], v[232:235], v[208:211], v[140:143]
    ds_read_b64_tr_b16 v[216:217], v20 offset:24576
    v_mfma_f32_16x16x32_bf16 v[140:143], v[228:231], v[200:203], v[140:143]
    ds_read_b64_tr_b16 v[218:219], v20 offset:25600
    v_mfma_f32_16x16x32_bf16 v[144:147], v[236:239], v[200:203], v[144:147]
    ds_read_b64_tr_b16 v[220:221], v21 offset:16384
    v_mfma_f32_16x16x32_bf16 v[144:147], v[240:243], v[208:211], v[144:147]
    ds_read_b64_tr_b16 v[222:223], v21 offset:17408
    v_mfma_f32_16x16x32_bf16 v[136:139], v[240:243], v[204:207], v[136:139]
    ds_read_b64_tr_b16 v[224:225], v21 offset:24576
    v_mfma_f32_16x16x32_bf16 v[136:139], v[236:239], v[196:199], v[136:139]
    ds_read_b64_tr_b16 v[226:227], v21 offset:25600
    s_cmp_eq_u32 s86, 0
    s_cbranch_scc1 L_mark
L_marked:
    s_waitcnt lgkmcnt(4)
    v_mfma_f32_16x16x32_bf16 v[84:87], v[212:215], v[180:183], v[84:87]
    ds_read_b64_tr_b16 v[228:229], v22 offset:16384
    v_mfma_f32_16x16x32_bf16 v[84:87], v[216:219], v[188:191], v[84:87]
    ds_read_b64_tr_b16 v[230:231], v22 offset:17408
    v_mfma_f32_16x16x32_bf16 v[92:95], v[216:219], v[192:195], v[92:95]
    ds_read_b64_tr_b16 v[232:233], v22 offset:24576
    v_mfma_f32_16x16x32_bf16 v[92:95], v[212:215], v[184:187], v[92:95]
    ds_read_b64_tr_b16 v[234:235], v22 offset:25600
    s_waitcnt lgkmcnt(4)
    v_mfma_f32_16x16x32_bf16 v[96:99], v[220:223], v[184:187], v[96:99]
    ds_read_b64_tr_b16 v[236:237], v23 offset:16384
    v_mfma_f32_16x16x32_bf16 v[96:99], v[224:227], v[192:195], v[96:99]
    ds_read_b64_tr_b16 v[238:239], v23 offset:17408
    v_mfma_f32_16x16x32_bf16 v[88:91], v[224:227], v[188:191], v[88:91]
    ds_read_b64_tr_b16 v[240:241], v23 offset:24576
    v_mfma_f32_16x16x32_bf16 v[88:91], v[220:223], v[180:183], v[88:91]
    ds_read_b64_tr_b16 v[242:243], v23 offset:25600
    s_waitcnt lgkmcnt(4)
    v_mfma_f32_16x16x32_bf16 v[100:103], v[228:231], v[180:183], v[100:103]
    ds_read_b64_tr_b16 v[212:213], v24 offset:16384
    v_mfma_f32_16x16x32_bf16 v[100:103], v[232:235], v[188:191], v[100:103]
    ds_read_b64_tr_b16 v[214:215], v24 offset:17408
    v_mfma_f32_16x16x32_bf16 v[108:111], v[232:235], v[192:195], v[108:111]
    ds_read_b64_tr_b16 v[216:217], v24 offset:24576
    v_mfma_f32_16x16x32_bf16 v[108:111], v[228:231], v[184:187], v[108:111]
    ds_read_b64_tr_b16 v[218:219], v24 offset:25600
    s_waitcnt lgkmcnt(4)
    v_mfma_f32_16x16x32_bf16 v[112:115], v[236:239], v[184:187], v[112:115]
    ds_read_b64_tr_b16 v[220:221], v25 offset:16384
    v_mfma_f32_16x16x32_bf16 v[112:115], v[240:243], v[192:195], v[112:115]
    ds_read_b64_tr_b16 v[222:223], v25 offset:17408
    v_mfma_f32_16x16x32_bf16 v[104:107], v[240:243], v[188:191], v[104:107]
    ds_read_b64_tr_b16 v[224:225], v25 offset:24576
    v_mfma_f32_16x16x32_bf16 v[104:107], v[236:239], v[180:183], v[104:107]
    ds_read_b64_tr_b16 v[226:227], v25 offset:25600
    s_waitcnt lgkmcnt(4)
    v_mfma_f32_16x16x32_bf16 v[116:119], v[212:215], v[180:183], v[116:119]
    ds_read_b64_tr_b16 v[228:229], v26 offset:16384
    v_mfma_f32_16x16x32_bf16 v[116:119], v[216:219], v[188:191], v[116:119]
    ds_read_b64_tr_b16 v[230:231], v26 offset:17408
    v_mfma_f32_16x16x32_bf16 v[124:127], v[216:219], v[192:195], v[124:127]
    ds_read_b64_tr_b16 v[232:233], v26 offset:24576
    v_mfma_f32_16x16x32_bf16 v[124:127], v[212:215], v[184:187], v[124:127]
    ds_read_b64_tr_b16 v[234:235], v26 offset:25600
    s_waitcnt lgkmcnt(4)
    v_mfma_f32_16x16x32_bf16 v[128:131], v[220:223], v[184:187], v[128:131]
    ds_read_b64_tr_b16 v[236:237], v27 offset:16384
    v_mfma_f32_16x16x32_bf16 v[128:131], v[224:227], v[192:195], v[128:131]
    ds_read_b64_tr_b16 v[238:239], v27 offset:17408
    v_mfma_f32_16x16x32_bf16 v[120:123], v[224:227], v[188:191], v[120:123]
    ds_read_b64_tr_b16 v[240:241], v27 offset:24576
    v_mfma_f32_16x16x32_bf16 v[120:123], v[220:223], v[180:183], v[120:123]
    ds_read_b64_tr_b16 v[242:243], v27 offset:25600
    s_waitcnt lgkmcnt(4)
    v_mfma_f32_16x16x32_bf16 v[132:135], v[228:231], v[180:183], v[132:135]
    v_mfma_f32_16x16x32_bf16 v[132:135], v[232:235], v[188:191], v[132:135]
    s_waitcnt lgkmcnt(0)
    s_barrier
    ds_read_b128 v[196:199], v28 offset:49152
    ds_read_b128 v[204:207], v29 offset:49152
    ds_read_b128 v[208:211], v29 offset:51200
    ds_read_b128 v[200:203], v28 offset:51200
    ds_read_b64_tr_b16 v[212:213], v20 offset:32768
    ds_read_b64_tr_b16 v[214:215], v20 offset:33792
    v_mfma_f32_16x16x32_bf16 v[140:143], v[232:235], v[192:195], v[140:143]
    ds_read_b64_tr_b16 v[216:217], v20 offset:40960
    v_mfma_f32_16x16x32_bf16 v[140:143], v[228:231], v[184:187], v[140:143]
    ds_read_b64_tr_b16 v[218:219], v20 offset:41984
    v_mfma_f32_16x16x32_bf16 v[144:147], v[236:239], v[184:187], v[144:147]
    ds_read_b64_tr_b16 v[220:221], v21 offset:32768
    v_mfma_f32_16x16x32_bf16 v[144:147], v[240:243], v[192:195], v[144:147]
    ds_read_b64_tr_b16 v[222:223], v21 offset:33792
    v_mfma_f32_16x16x32_bf16 v[136:139], v[240:243], v[188:191], v[136:139]
    ds_read_b64_tr_b16 v[224:225], v21 offset:40960
    v_mfma_f32_16x16x32_bf16 v[136:139], v[236:239], v[180:183], v[136:139]
    ds_read_b64_tr_b16 v[226:227], v21 offset:41984
    s_waitcnt lgkmcnt(4)
    v_mfma_f32_16x16x32_bf16 v[84:87], v[212:215], v[196:199], v[84:87]
    ds_read_b64_tr_b16 v[228:229], v22 offset:32768
    v_mfma_f32_16x16x32_bf16 v[84:87], v[216:219], v[204:207], v[84:87]
    ds_read_b64_tr_b16 v[230:231], v22 offset:33792
    v_mfma_f32_16x16x32_bf16 v[92:95], v[216:219], v[208:211], v[92:95]
    ds_read_b64_tr_b16 v[232:233], v22 offset:40960
    v_mfma_f32_16x16x32_bf16 v[92:95], v[212:215], v[200:203], v[92:95]
    ds_read_b64_tr_b16 v[234:235], v22 offset:41984
    s_waitcnt lgkmcnt(4)
    v_mfma_f32_16x16x32_bf16 v[96:99], v[220:223], v[200:203], v[96:99]
    ds_read_b64_tr_b16 v[236:237], v23 offset:32768
    v_mfma_f32_16x16x32_bf16 v[96:99], v[224:227], v[208:211], v[96:99]
    ds_read_b64_tr_b16 v[238:239], v23 offset:33792
    v_mfma_f32_16x16x32_bf16 v[88:91], v[224:227], v[204:207], v[88:91]
    ds_read_b64_tr_b16 v[240:241], v23 offset:40960
    v_mfma_f32_16x16x32_bf16 v[88:91], v[220:223], v[196:199], v[88:91]
    ds_read_b64_tr_b16 v[242:243], v23 offset:41984
    s_waitcnt lgkmcnt(4)
    v_mfma_f32_16x16x32_bf16 v[100:103], v[228:231], v[196:199], v[100:103]
    ds_read_b64_tr_b16 v[212:213], v24 offset:32768
    v_mfma_f32_16x16x32_bf16 v[100:103], v[232:235], v[204:207], v[100:103]
    ds_read_b64_tr_b16 v[214:215], v24 offset:33792
    v_mfma_f32_16x16x32_bf16 v[108:111], v[232:235], v[208:211], v[108:111]
    ds_read_b64_tr_b16 v[216:217], v24 offset:40960
    v_mfma_f32_16x16x32_bf16 v[108:111], v[228:231], v[200:203], v[108:111]
    ds_read_b64_tr_b16 v[218:219], v24 offset:41984
    s_waitcnt lgkmcnt(4)
    v_mfma_f32_16x16x32_bf16 v[112:115], v[236:239], v[200:203], v[112:115]
    ds_read_b64_tr_b16 v[220:221], v25 offset:32768
    v_mfma_f32_16x16x32_bf16 v[112:115], v[240:243], v[208:211], v[112:115]
    ds_read_b64_tr_b16 v[222:223], v25 offset:33792
    v_mfma_f32_16x16x32_bf16 v[104:107], v[240:243], v[204:207], v[104:107]
    ds_read_b64_tr_b16 v[224:225], v25 offset:40960
    v_mfma_f32_16x16x32_bf16 v[104:107], v[236:239], v[196:199], v[104:107]
    ds_read_b64_tr_b16 v[226:227], v25 offset:41984
    s_waitcnt lgkmcnt(4)
    v_mfma_f32_16x16x32_bf16 v[116:119], v[212:215], v[196:199], v[116:119]
    ds_read_b64_tr_b16 v[228:229], v26 offset:32768
    v_mfma_f32_16x16x32_bf16 v[116:119], v[216:219], v[204:207], v[116:119]
    ds_read_b64_tr_b16 v[230:231], v26 offset:33792
    v_mfma_f32_16x16x32_bf16 v[124:127], v[216:219], v[208:211], v[124:127]
    ds_read_b64_tr_b16 v[232:233], v26 offset:40960
    v_mfma_f32_16x16x32_bf16 v[124:127], v[212:215], v[200:203], v[124:127]
    ds_read_b64_tr_b16 v[234:235], v26 offset:41984
    s_waitcnt lgkmcnt(4)
    v_mfma_f32_16x16x32_bf16 v[128:131], v[220:223], v[200:203], v[128:131]
    ds_read_b64_tr_b16 v[236:237], v27 offset:32768
    v_mfma_f32_16x16x32_bf16 v[128:131], v[224:227], v[208:211], v[128:131]
    ds_read_b64_tr_b16 v[238:239], v27 offset:33792
    v_mfma_f32_16x16x32_bf16 v[120:123], v[224:227], v[204:207], v[120:123]
    ds_read_b64_tr_b16 v[240:241], v27 offset:40960
    v_mfma_f32_16x16x32_bf16 v[120:123], v[220:223], v[196:199], v[120:123]
    ds_read_b64_tr_b16 v[242:243], v27 offset:41984
    s_waitcnt lgkmcnt(4)
    v_mfma_f32_16x16x32_bf16 v[132:135], v[228:231], v[196:199], v[132:135]
    v_mfma_f32_16x16x32_bf16 v[132:135], v[232:235], v[204:207], v[132:135]
    s_waitcnt lgkmcnt(0)
    s_barrier
    ds_read_b128 v[180:183], v28 offset:16384
    ds_read_b128 v[188:191], v29 offset:16384
    ds_read_b128 v[192:195], v29 offset:18432
    ds_read_b128 v[184:187], v28 offset:18432
    ds_read_b64_tr_b16 v[212:213], v20 offset:0
    ds_read_b64_tr_b16 v[214:215], v20 offset:1024
    v_mfma_f32_16x16x32_bf16 v[140:143], v[232:235], v[208:211], v[140:143]
    ds_read_b64_tr_b16 v[216:217], v20 offset:8192
    v_mfma_f32_16x16x32_bf16 v[140:143], v[228:231], v[200:203], v[140:143]
    ds_read_b64_tr_b16 v[218:219], v20 offset:9216
    v_mfma_f32_16x16x32_bf16 v[144:147], v[236:239], v[200:203], v[144:147]
    ds_read_b64_tr_b16 v[220:221], v21 offset:0
    v_mfma_f32_16x16x32_bf16 v[144:147], v[240:243], v[208:211], v[144:147]
    ds_read_b64_tr_b16 v[222:223], v21 offset:1024
    v_mfma_f32_16x16x32_bf16 v[136:139], v[240:243], v[204:207], v[136:139]
    ds_read_b64_tr_b16 v[224:225], v21 offset:8192
    v_mfma_f32_16x16x32_bf16 v[136:139], v[236:239], v[196:199], v[136:139]
    ds_read_b64_tr_b16 v[226:227], v21 offset:9216
    s_waitcnt lgkmcnt(4)
    v_mfma_f32_16x16x32_bf16 v[84:87], v[212:215], v[180:183], v[84:87]
    ds_read_b64_tr_b16 v[228:229], v22 offset:0
    v_mfma_f32_16x16x32_bf16 v[84:87], v[216:219], v[188:191], v[84:87]
    ds_read_b64_tr_b16 v[230:231], v22 offset:1024
    v_mfma_f32_16x16x32_bf16 v[92:95], v[216:219], v[192:195], v[92:95]
    ds_read_b64_tr_b16 v[232:233], v22 offset:8192
    v_mfma_f32_16x16x32_bf16 v[92:95], v[212:215], v[184:187], v[92:95]
    ds_read_b64_tr_b16 v[234:235], v22 offset:9216
    s_waitcnt lgkmcnt(4)
    v_mfma_f32_16x16x32_bf16 v[96:99], v[220:223], v[184:187], v[96:99]
    ds_read_b64_tr_b16 v[236:237], v23 offset:0
    v_mfma_f32_16x16x32_bf16 v[96:99], v[224:227], v[192:195], v[96:99]
    ds_read_b64_tr_b16 v[238:239], v23 offset:1024
    v_mfma_f32_16x16x32_bf16 v[88:91], v[224:227], v[188:191], v[88:91]
    ds_read_b64_tr_b16 v[240:241], v23 offset:8192
    v_mfma_f32_16x16x32_bf16 v[88:91], v[220:223], v[180:183], v[88:91]
    ds_read_b64_tr_b16 v[242:243], v23 offset:9216
    s_waitcnt lgkmcnt(4)
    v_mfma_f32_16x16x32_bf16 v[100:103], v[228:231], v[180:183], v[100:103]
    ds_read_b64_tr_b16 v[212:213], v24 offset:0
    v_mfma_f32_16x16x32_bf16 v[100:103], v[232:235], v[188:191], v[100:103]
    ds_read_b64_tr_b16 v[214:215], v24 offset:1024
    v_mfma_f32_16x16x32_bf16 v[108:111], v[232:235], v[192:195], v[108:111]
    ds_read_b64_tr_b16 v[216:217], v24 offset:8192
    v_mfma_f32_16x16x32_bf16 v[108:111], v[228:231], v[184:187], v[108:111]
    ds_read_b64_tr_b16 v[218:219], v24 offset:9216
    s_waitcnt lgkmcnt(4)
    v_mfma_f32_16x16x32_bf16 v[112:115], v[236:239], v[184:187], v[112:115]
    ds_read_b64_tr_b16 v[220:221], v25 offset:0
    v_mfma_f32_16x16x32_bf16 v[112:115], v[240:243], v[192:195], v[112:115]
    ds_read_b64_tr_b16 v[222:223], v25 offset:1024
    v_mfma_f32_16x16x32_bf16 v[104:107], v[240:243], v[188:191], v[104:107]
    ds_read_b64_tr_b16 v[224:225], v25 offset:8192
    v_mfma_f32_16x16x32_bf16 v[104:107], v[236:239], v[180:183], v[104:107]
    ds_read_b64_tr_b16 v[226:227], v25 offset:9216
    s_waitcnt lgkmcnt(4)
    v_mfma_f32_16x16x32_bf16 v[116:119], v[212:215], v[180:183], v[116:119]
    ds_read_b64_tr_b16 v[228:229], v26 offset:0
    v_mfma_f32_16x16x32_bf16 v[116:119], v[216:219], v[188:191], v[116:119]
    ds_read_b64_tr_b16 v[230:231], v26 offset:1024
    v_mfma_f32_16x16x32_bf16 v[124:127], v[216:219], v[192:195], v[124:127]
    ds_read_b64_tr_b16 v[232:233], v26 offset:8192
    v_mfma_f32_16x16x32_bf16 v[124:127], v[212:215], v[184:187], v[124:127]
    ds_read_b64_tr_b16 v[234:235], v26 offset:9216
    s_waitcnt lgkmcnt(4)
    v_mfma_f32_16x16x32_bf16 v[128:131], v[220:223], v[184:187], v[128:131]
    ds_read_b64_tr_b16 v[236:237], v27 offset:0
    v_mfma_f32_16x16x32_bf16 v[128:131], v[224:227], v[192:195], v[128:131]
    ds_read_b64_tr_b16 v[238:239], v27 offset:1024
    v_mfma_f32_16x16x32_bf16 v[120:123], v[224:227], v[188:191], v[120:123]
    ds_read_b64_tr_b16 v[240:241], v27 offset:8192
    v_mfma_f32_16x16x32_bf16 v[120:123], v[220:223], v[180:183], v[120:123]
    ds_read_b64_tr_b16 v[242:243], v27 offset:9216
    s_waitcnt lgkmcnt(4)
    v_mfma_f32_16x16x32_bf16 v[132:135], v[228:231], v[180:183], v[132:135]
    v_mfma_f32_16x16x32_bf16 v[132:135], v[232:235], v[188:191], v[132:135]
    s_waitcnt lgkmcnt(0)
    s_barrier
    ds_read_b128 v[196:199], v28 offset:32768
    ds_read_b128 v[204:207], v29 offset:32768
    ds_read_b128 v[208:211], v29 offset:34816
    ds_read_b128 v[200:203], v28 offset:34816
    ds_read_b64_tr_b16 v[212:213], v20 offset:16384
    ds_read_b64_tr_b16 v[214:215], v20 offset:17408
    v_mfma_f32_16x16x32_bf16 v[140:143], v[232:235], v[192:195], v[140:143]
    ds_read_b64_tr_b16 v[216:217], v20 offset:24576
    v_mfma_f32_16x16x32_bf16 v[140:143], v[228:231], v[184:187], v[140:143]
    ds_read_b64_tr_b16 v[218:219], v20 offset:25600
    v_mfma_f32_16x16x32_bf16 v[144:147], v[236:239], v[184:187], v[144:147]
    ds_read_b64_tr_b16 v[220:221], v21 offset:16384
    v_mfma_f32_16x16x32_bf16 v[144:147], v[240:243], v[192:195], v[144:147]
    ds_read_b64_tr_b16 v[222:223], v21 offset:17408
    v_mfma_f32_16x16x32_bf16 v[136:139], v[240:243], v[188:191], v[136:139]
    ds_read_b64_tr_b16 v[224:225], v21 offset:24576
    v_mfma_f32_16x16x32_bf16 v[136:139], v[236:239], v[180:183], v[136:139]
    ds_read_b64_tr_b16 v[226:227], v21 offset:25600
    s_waitcnt lgkmcnt(4)
    v_mfma_f32_16x16x32_bf16 v[84:87], v[212:215], v[196:199], v[84:87]
    ds_read_b64_tr_b16 v[228:229], v22 offset:16384
    v_mfma_f32_16x16x32_bf16 v[84:87], v[216:219], v[204:207], v[84:87]
    ds_read_b64_tr_b16 v[230:231], v22 offset:17408
    v_mfma_f32_16x16x32_bf16 v[92:95], v[216:219], v[208:211], v[92:95]
    ds_read_b64_tr_b16 v[232:233], v22 offset:24576
    v_mfma_f32_16x16x32_bf16 v[92:95], v[212:215], v[200:203], v[92:95]
    ds_read_b64_tr_b16 v[234:235], v22 offset:25600
    s_waitcnt lgkmcnt(4)
    v_mfma_f32_16x16x32_bf16 v[96:99], v[220:223], v[200:203], v[96:99]
    ds_read_b64_tr_b16 v[236:237], v23 offset:16384
    v_mfma_f32_16x16x32_bf16 v[96:99], v[224:227], v[208:211], v[96:99]
    ds_read_b64_tr_b16 v[238:239], v23 offset:17408
    v_mfma_f32_16x16x32_bf16 v[88:91], v[224:227], v[204:207], v[88:91]
    ds_read_b64_tr_b16 v[240:241], v23 offset:24576
    v_mfma_f32_16x16x32_bf16 v[88:91], v[220:223], v[196:199], v[88:91]
    ds_read_b64_tr_b16 v[242:243], v23 offset:25600
    s_waitcnt lgkmcnt(4)
    v_mfma_f32_16x16x32_bf16 v[100:103], v[228:231], v[196:199], v[100:103]
    ds_read_b64_tr_b16 v[212:213], v24 offset:16384
    v_mfma_f32_16x16x32_bf16 v[100:103], v[232:235], v[204:207], v[100:103]
    ds_read_b64_tr_b16 v[214:215], v24 offset:17408
    v_mfma_f32_16x16x32_bf16 v[108:111], v[232:235], v[208:211], v[108:111]
    ds_read_b64_tr_b16 v[216:217], v24 offset:24576
    v_mfma_f32_16x16x32_bf16 v[108:111], v[228:231], v[200:203], v[108:111]
    ds_read_b64_tr_b16 v[218:219], v24 offset:25600
    s_waitcnt lgkmcnt(4)
    v_mfma_f32_16x16x32_bf16 v[112:115], v[236:239], v[200:203], v[112:115]
    ds_read_b64_tr_b16 v[220:221], v25 offset:16384
    v_mfma_f32_16x16x32_bf16 v[112:115], v[240:243], v[208:211], v[112:115]
    ds_read_b64_tr_b16 v[222:223], v25 offset:17408
    v_mfma_f32_16x16x32_bf16 v[104:107], v[240:243], v[204:207], v[104:107]
    ds_read_b64_tr_b16 v[224:225], v25 offset:24576
    v_mfma_f32_16x16x32_bf16 v[104:107], v[236:239], v[196:199], v[104:107]
    ds_read_b64_tr_b16 v[226:227], v25 offset:25600
    s_waitcnt lgkmcnt(4)
    v_mfma_f32_16x16x32_bf16 v[116:119], v[212:215], v[196:199], v[116:119]
    ds_read_b64_tr_b16 v[228:229], v26 offset:16384
    v_mfma_f32_16x16x32_bf16 v[116:119], v[216:219], v[204:207], v[116:119]
    ds_read_b64_tr_b16 v[230:231], v26 offset:17408
    v_mfma_f32_16x16x32_bf16 v[124:127], v[216:219], v[208:211], v[124:127]
    ds_read_b64_tr_b16 v[232:233], v26 offset:24576
    v_mfma_f32_16x16x32_bf16 v[124:127], v[212:215], v[200:203], v[124:127]
    ds_read_b64_tr_b16 v[234:235], v26 offset:25600
    s_waitcnt lgkmcnt(4)
    v_mfma_f32_16x16x32_bf16 v[128:131], v[220:223], v[200:203], v[128:131]
    ds_read_b64_tr_b16 v[236:237], v27 offset:16384
    v_mfma_f32_16x16x32_bf16 v[128:131], v[224:227], v[208:211], v[128:131]
    ds_read_b64_tr_b16 v[238:239], v27 offset:17408
    v_mfma_f32_16x16x32_bf16 v[120:123], v[224:227], v[204:207], v[120:123]
    ds_read_b64_tr_b16 v[240:241], v27 offset:24576
    v_mfma_f32_16x16x32_bf16 v[120:123], v[220:223], v[196:199], v[120:123]
    ds_read_b64_tr_b16 v[242:243], v27 offset:25600
    s_waitcnt lgkmcnt(4)
    v_mfma_f32_16x16x32_bf16 v[132:135], v[228:231], v[196:199], v[132:135]
    v_mfma_f32_16x16x32_bf16 v[132:135], v[232:235], v[204:207], v[132:135]
    s_waitcnt lgkmcnt(0)
    s_barrier
    v_mfma_f32_16x16x32_bf16 v[140:143], v[232:235], v[208:211], v[140:143]
    ds_read_b128 v[212:215], v16 offset:0
    v_mfma_f32_16x16x32_bf16 v[140:143], v[228:231], v[200:203], v[140:143]
    ds_read_b128 v[216:219], v17 offset:0
    v_mfma_f32_16x16x32_bf16 v[144:147], v[236:239], v[200:203], v[144:147]
    ds_read_b128 v[220:223], v18 offset:0
    v_mfma_f32_16x16x32_bf16 v[144:147], v[240:243], v[208:211], v[144:147]
    ds_read_b128 v[224:227], v19 offset:0
    v_mfma_f32_16x16x32_bf16 v[136:139], v[240:243], v[204:207], v[136:139]
    v_mfma_f32_16x16x32_bf16 v[136:139], v[236:239], v[196:199], v[136:139]
    v_pk_mul_f32 v[84:85], v[84:85], s[84:85]
    v_pk_mul_f32 v[86:87], v[86:87], s[84:85]
    v_pk_mul_f32 v[88:89], v[88:89], s[84:85]
    v_pk_mul_f32 v[90:91], v[90:91], s[84:85]
    v_cvt_pk_bf16_f32 v52, v84, v85
    v_cvt_pk_bf16_f32 v53, v86, v87
    v_cvt_pk_bf16_f32 v54, v88, v89
    v_cvt_pk_bf16_f32 v55, v90, v91
    v_pk_mul_f32 v[92:93], v[92:93], s[84:85]
    v_pk_mul_f32 v[94:95], v[94:95], s[84:85]
    v_pk_mul_f32 v[96:97], v[96:97], s[84:85]
    v_pk_mul_f32 v[98:99], v[98:99], s[84:85]
    v_cvt_pk_bf16_f32 v56, v92, v93
    v_cvt_pk_bf16_f32 v57, v94, v95
    v_cvt_pk_bf16_f32 v58, v96, v97
    v_cvt_pk_bf16_f32 v59, v98, v99
    v_permlane16_swap_b32 v52, v54
    v_permlane16_swap_b32 v53, v55
    v_pk_mul_f32 v[100:101], v[100:101], s[84:85]
    v_pk_mul_f32 v[102:103], v[102:103], s[84:85]
    v_pk_mul_f32 v[104:105], v[104:105], s[84:85]
    v_pk_mul_f32 v[106:107], v[106:107], s[84:85]
    v_cvt_pk_bf16_f32 v60, v100, v101
    v_cvt_pk_bf16_f32 v61, v102, v103
    v_cvt_pk_bf16_f32 v62, v104, v105
    v_cvt_pk_bf16_f32 v63, v106, v107
    v_permlane16_swap_b32 v56, v58
    v_permlane16_swap_b32 v57, v59
    v_pk_mul_f32 v[108:109], v[108:109], s[84:85]
    v_pk_mul_f32 v[110:111], v[110:111], s[84:85]
    v_pk_mul_f32 v[112:113], v[112:113], s[84:85]
    v_pk_mul_f32 v[114:115], v[114:115], s[84:85]
    v_cvt_pk_bf16_f32 v64, v108, v109
    v_cvt_pk_bf16_f32 v65, v110, v111
    v_cvt_pk_bf16_f32 v66, v112, v113
    v_cvt_pk_bf16_f32 v67, v114, v115
    v_permlane16_swap_b32 v60, v62
    v_permlane16_swap_b32 v61, v63
    v_pk_mul_f32 v[116:117], v[116:117], s[84:85]
    v_pk_mul_f32 v[118:119], v[118:119], s[84:85]
    v_pk_mul_f32 v[120:121], v[120:121], s[84:85]
    v_pk_mul_f32 v[122:123], v[122:123], s[84:85]
    v_cvt_pk_bf16_f32 v68, v116, v117
    v_cvt_pk_bf16_f32 v69, v118, v119
    v_cvt_pk_bf16_f32 v70, v120, v121
    v_cvt_pk_bf16_f32 v71, v122, v123
    v_permlane16_swap_b32 v64, v66
    v_permlane16_swap_b32 v65, v67
    v_pk_mul_f32 v[124:125], v[124:125], s[84:85]
    v_pk_mul_f32 v[126:127], v[126:127], s[84:85]
    v_pk_mul_f32 v[128:129], v[128:129], s[84:85]
    v_pk_mul_f32 v[130:131], v[130:131], s[84:85]
    v_cvt_pk_bf16_f32 v72, v124, v125
    v_cvt_pk_bf16_f32 v73, v126, v127
    v_cvt_pk_bf16_f32 v74, v128, v129
    v_cvt_pk_bf16_f32 v75, v130, v131
    v_permlane16_swap_b32 v68, v70
    v_permlane16_swap_b32 v69, v71
    v_pk_mul_f32 v[132:133], v[132:133], s[84:85]
    v_pk_mul_f32 v[134:135], v[134:135], s[84:85]
    v_pk_mul_f32 v[136:137], v[136:137], s[84:85]
    v_pk_mul_f32 v[138:139], v[138:139], s[84:85]
    v_cvt_pk_bf16_f32 v76, v132, v133
    v_cvt_pk_bf16_f32 v77, v134, v135
    v_cvt_pk_bf16_f32 v78, v136, v137
    v_cvt_pk_bf16_f32 v79, v138, v139
    v_permlane16_swap_b32 v72, v74
    v_permlane16_swap_b32 v73, v75
    v_pk_mul_f32 v[140:141], v[140:141], s[84:85]
    v_pk_mul_f32 v[142:143], v[142:143], s[84:85]
    v_pk_mul_f32 v[144:145], v[144:145], s[84:85]
    v_pk_mul_f32 v[146:147], v[146:147], s[84:85]
    v_cvt_pk_bf16_f32 v80, v140, v141
    v_cvt_pk_bf16_f32 v81, v142, v143
    v_cvt_pk_bf16_f32 v82, v144, v145
    v_cvt_pk_bf16_f32 v83, v146, v147
    v_permlane16_swap_b32 v76, v78
    v_permlane16_swap_b32 v77, v79
    s_nop 1
    v_permlane16_swap_b32 v80, v82
    v_permlane16_swap_b32 v81, v83
    s_waitcnt lgkmcnt(2)
    v_mfma_f32_16x16x32_bf16 v[148:151], v[212:215], v[52:55], 0
    v_mfma_f32_16x16x32_bf16 v[148:151], v[216:219], v[60:63], v[148:151]
    ds_read_b128 v[228:231], v18 offset:1024
    v_mfma_f32_16x16x32_bf16 v[156:159], v[216:219], v[64:67], 0
    v_mfma_f32_16x16x32_bf16 v[156:159], v[212:215], v[56:59], v[156:159]
    ds_read_b128 v[232:235], v19 offset:1024
    s_waitcnt lgkmcnt(2)
    v_mfma_f32_16x16x32_bf16 v[156:159], v[220:223], v[72:75], v[156:159]
    v_mfma_f32_16x16x32_bf16 v[156:159], v[224:227], v[80:83], v[156:159]
    ds_read_b128 v[236:239], v16 offset:1024
    v_mfma_f32_16x16x32_bf16 v[148:151], v[224:227], v[76:79], v[148:151]
    v_mfma_f32_16x16x32_bf16 v[148:151], v[220:223], v[68:71], v[148:151]
    ds_read_b128 v[240:243], v17 offset:1024
    s_waitcnt lgkmcnt(2)
    v_mfma_f32_16x16x32_bf16 v[152:155], v[228:231], v[68:71], 0
    v_mfma_f32_16x16x32_bf16 v[152:155], v[232:235], v[76:79], v[152:155]
    ds_read_b128 v[212:215], v16 offset:8192
    v_mfma_f32_16x16x32_bf16 v[160:163], v[232:235], v[80:83], 0
    v_mfma_f32_16x16x32_bf16 v[160:163], v[228:231], v[72:75], v[160:163]
    ds_read_b128 v[216:219], v17 offset:8192
    s_waitcnt lgkmcnt(2)
    v_mfma_f32_16x16x32_bf16 v[160:163], v[236:239], v[56:59], v[160:163]
    v_mfma_f32_16x16x32_bf16 v[160:163], v[240:243], v[64:67], v[160:163]
    ds_read_b128 v[220:223], v18 offset:8192
    v_mfma_f32_16x16x32_bf16 v[152:155], v[240:243], v[60:63], v[152:155]
    v_mfma_f32_16x16x32_bf16 v[152:155], v[236:239], v[52:55], v[152:155]
    ds_read_b128 v[224:227], v19 offset:8192
    s_waitcnt lgkmcnt(2)
    v_mfma_f32_16x16x32_bf16 v[164:167], v[212:215], v[52:55], 0
    v_mfma_f32_16x16x32_bf16 v[164:167], v[216:219], v[60:63], v[164:167]
    ds_read_b128 v[228:231], v18 offset:9216
    v_mfma_f32_16x16x32_bf16 v[172:175], v[216:219], v[64:67], 0
    v_mfma_f32_16x16x32_bf16 v[172:175], v[212:215], v[56:59], v[172:175]
    ds_read_b128 v[232:235], v19 offset:9216
    s_waitcnt lgkmcnt(2)
    v_mfma_f32_16x16x32_bf16 v[172:175], v[220:223], v[72:75], v[172:175]
    v_mfma_f32_16x16x32_bf16 v[172:175], v[224:227], v[80:83], v[172:175]
    ds_read_b128 v[236:239], v16 offset:9216
    v_mfma_f32_16x16x32_bf16 v[164:167], v[224:227], v[76:79], v[164:167]
    v_mfma_f32_16x16x32_bf16 v[164:167], v[220:223], v[68:71], v[164:167]
    ds_read_b128 v[240:243], v17 offset:9216
    s_waitcnt lgkmcnt(2)
    v_mfma_f32_16x16x32_bf16 v[168:171], v[228:231], v[68:71], 0
    v_mfma_f32_16x16x32_bf16 v[168:171], v[232:235], v[76:79], v[168:171]
    s_waitcnt lgkmcnt(0)
    s_barrier
    v_mfma_f32_16x16x32_bf16 v[176:179], v[232:235], v[80:83], 0
    ds_read_b128 v[212:215], v16 offset:16384
    v_mfma_f32_16x16x32_bf16 v[176:179], v[228:231], v[72:75], v[176:179]
    ds_read_b128 v[216:219], v17 offset:16384
    v_mfma_f32_16x16x32_bf16 v[176:179], v[236:239], v[56:59], v[176:179]
    v_mfma_f32_16x16x32_bf16 v[176:179], v[240:243], v[64:67], v[176:179]
    ds_read_b128 v[220:223], v18 offset:16384
    v_mfma_f32_16x16x32_bf16 v[168:171], v[240:243], v[60:63], v[168:171]
    v_mfma_f32_16x16x32_bf16 v[168:171], v[236:239], v[52:55], v[168:171]
    ds_read_b128 v[224:227], v19 offset:16384
    s_nop 7
    v_max3_f32 v1, v148, v149, v150
    v_max3_f32 v2, v156, v157, v158
    v_max3_f32 v1, v1, v151, v152
    v_max3_f32 v2, v2, v159, v160
    v_max3_f32 v1, v1, v153, v154
    v_max3_f32 v2, v2, v161, v162
    v_max3_f32 v1, v1, v155, v164
    v_max3_f32 v2, v2, v163, v172
    v_max3_f32 v1, v1, v165, v166
    v_max3_f32 v2, v2, v173, v174
    v_max3_f32 v1, v1, v167, v168
    v_max3_f32 v2, v2, v175, v176
    v_max3_f32 v1, v1, v169, v170
    v_max3_f32 v2, v2, v177, v178
    v_max_f32 v1, v1, v171
    v_max_f32 v2, v2, v179
    v_mov_b32 v3, v1
    v_mov_b32 v30, v2
    s_nop 1
    v_permlane32_swap_b32 v1, v3
    v_permlane32_swap_b32 v2, v30
    v_max_f32 v1, v1, v3
    v_max_f32 v2, v2, v30
    v_mov_b32 v3, v1
    v_mov_b32 v30, v2
    s_nop 1
    v_permlane16_swap_b32 v1, v3
    v_permlane16_swap_b32 v2, v30
    v_max_f32 v1, v1, v3
    v_max_f32 v2, v2, v30
    v_sub_f32 v36, 0, v1
    v_sub_f32 v37, 0, v1
    v_sub_f32 v38, 0, v1
    v_sub_f32 v39, 0, v1
    v_sub_f32 v40, 0, v2
    v_sub_f32 v41, 0, v2
    v_sub_f32 v42, 0, v2
    v_sub_f32 v43, 0, v2
    v_sub_f32 v148, v148, v1
    v_sub_f32 v149, v149, v1
    v_sub_f32 v150, v150, v1
    v_sub_f32 v151, v151, v1
    v_sub_f32 v152, v152, v1
    v_sub_f32 v153, v153, v1
    v_sub_f32 v154, v154, v1
    v_sub_f32 v155, v155, v1
    v_sub_f32 v156, v156, v2
    v_sub_f32 v157, v157, v2
    v_sub_f32 v158, v158, v2
    v_sub_f32 v159, v159, v2
    v_sub_f32 v160, v160, v2
    v_sub_f32 v161, v161, v2
    v_sub_f32 v162, v162, v2
    v_sub_f32 v163, v163, v2
    v_sub_f32 v164, v164, v1
    v_sub_f32 v165, v165, v1
    v_sub_f32 v166, v166, v1
    v_sub_f32 v167, v167, v1
    v_sub_f32 v168, v168, v1
    v_sub_f32 v169, v169, v1
    v_sub_f32 v170, v170, v1
    v_sub_f32 v171, v171, v1
    v_sub_f32 v172, v172, v2
    v_sub_f32 v173, v173, v2
    v_sub_f32 v174, v174, v2
    v_sub_f32 v175, v175, v2
    v_sub_f32 v176, v176, v2
    v_sub_f32 v177, v177, v2
    v_sub_f32 v178, v178, v2
    v_sub_f32 v179, v179, v2
    s_waitcnt lgkmcnt(2)
    v_mfma_f32_16x16x32_bf16 v[180:183], v[212:215], v[52:55], v[36:39]
    v_exp_f32 v148, v148
    v_mfma_f32_16x16x32_bf16 v[180:183], v[216:219], v[60:63], v[180:183]
    ds_read_b128 v[228:231], v18 offset:17408
    v_exp_f32 v149, v149
    v_exp_f32 v150, v150
    v_exp_f32 v151, v151
    v_mfma_f32_16x16x32_bf16 v[188:191], v[216:219], v[64:67], v[40:43]
    v_exp_f32 v152, v152
    v_mfma_f32_16x16x32_bf16 v[188:191], v[212:215], v[56:59], v[188:191]
    ds_read_b128 v[232:235], v19 offset:17408
    s_waitcnt lgkmcnt(2)
    v_mfma_f32_16x16x32_bf16 v[188:191], v[220:223], v[72:75], v[188:191]
    v_exp_f32 v153, v153
    v_mfma_f32_16x16x32_bf16 v[188:191], v[224:227], v[80:83], v[188:191]
    ds_read_b128 v[236:239], v16 offset:17408
    v_cvt_pk_bf16_f32 v148, v148, v149
    v_cvt_pk_bf16_f32 v149, v150, v151
    v_cvt_pk_bf16_f32 v150, v152, v153
    v_exp_f32 v154, v154
    v_exp_f32 v155, v155
    v_mfma_f32_16x16x32_bf16 v[180:183], v[224:227], v[76:79], v[180:183]
    v_exp_f32 v156, v156
    v_mfma_f32_16x16x32_bf16 v[180:183], v[220:223], v[68:71], v[180:183]
    ds_read_b128 v[240:243], v17 offset:17408
    v_cvt_pk_bf16_f32 v151, v154, v155
    v_exp_f32 v157, v157
    v_exp_f32 v158, v158
    v_exp_f32 v159, v159
    s_waitcnt lgkmcnt(2)
    v_mfma_f32_16x16x32_bf16 v[184:187], v[228:231], v[68:71], v[36:39]
    v_exp_f32 v160, v160
    v_mfma_f32_16x16x32_bf16 v[184:187], v[232:235], v[76:79], v[184:187]
    ds_read_b128 v[212:215], v16 offset:24576
    v_cvt_pk_bf16_f32 v156, v156, v157
    v_cvt_pk_bf16_f32 v157, v158, v159
    v_exp_f32 v161, v161
    v_exp_f32 v162, v162
    v_mfma_f32_16x16x32_bf16 v[192:195], v[232:235], v[80:83], v[40:43]
    v_exp_f32 v163, v163
    v_mfma_f32_16x16x32_bf16 v[192:195], v[228:231], v[72:75], v[192:195]
    ds_read_b128 v[216:219], v17 offset:24576
    s_waitcnt lgkmcnt(2)
    v_mfma_f32_16x16x32_bf16 v[192:195], v[236:239], v[56:59], v[192:195]
    v_exp_f32 v164, v164
    v_mfma_f32_16x16x32_bf16 v[192:195], v[240:243], v[64:67], v[192:195]
    ds_read_b128 v[220:223], v18 offset:24576
    v_cvt_pk_bf16_f32 v158, v160, v161
    v_cvt_pk_bf16_f32 v159, v162, v163
    v_exp_f32 v165, v165
    v_exp_f32 v166, v166
    v_exp_f32 v167, v167
    v_mfma_f32_16x16x32_bf16 v[184:187], v[240:243], v[60:63], v[184:187]
    v_exp_f32 v168, v168
    v_mfma_f32_16x16x32_bf16 v[184:187], v[236:239], v[52:55], v[184:187]
    ds_read_b128 v[224:227], v19 offset:24576
    v_cvt_pk_bf16_f32 v164, v164, v165
    v_cvt_pk_bf16_f32 v165, v166, v167
    v_exp_f32 v169, v169
    v_exp_f32 v170, v170
    s_waitcnt lgkmcnt(2)
    v_mfma_f32_16x16x32_bf16 v[196:199], v[212:215], v[52:55], v[36:39]
    v_exp_f32 v171, v171
    v_mfma_f32_16x16x32_bf16 v[196:199], v[216:219], v[60:63], v[196:199]
    ds_read_b128 v[228:231], v18 offset:25600
    v_cvt_pk_bf16_f32 v166, v168, v169
    v_cvt_pk_bf16_f32 v167, v170, v171
    v_exp_f32 v172, v172
    v_exp_f32 v173, v173
    v_exp_f32 v174, v174
    v_mfma_f32_16x16x32_bf16 v[204:207], v[216:219], v[64:67], v[40:43]
    v_exp_f32 v175, v175
    v_mfma_f32_16x16x32_bf16 v[204:207], v[212:215], v[56:59], v[204:207]
    ds_read_b128 v[232:235], v19 offset:25600
    s_waitcnt lgkmcnt(2)
    v_mfma_f32_16x16x32_bf16 v[204:207], v[220:223], v[72:75], v[204:207]
    v_exp_f32 v176, v176
    v_mfma_f32_16x16x32_bf16 v[204:207], v[224:227], v[80:83], v[204:207]
    ds_read_b128 v[236:239], v16 offset:25600
    v_cvt_pk_bf16_f32 v172, v172, v173
    v_cvt_pk_bf16_f32 v173, v174, v175
    v_exp_f32 v177, v177
    v_exp_f32 v178, v178
    v_mfma_f32_16x16x32_bf16 v[196:199], v[224:227], v[76:79], v[196:199]
    v_exp_f32 v179, v179
    v_mfma_f32_16x16x32_bf16 v[196:199], v[220:223], v[68:71], v[196:199]
    ds_read_b128 v[240:243], v17 offset:25600
    v_mfma_f32_16x16x32_bf16 v[44:47], v[32:35], v[148:151], 0
    v_cvt_pk_bf16_f32 v174, v176, v177
    v_cvt_pk_bf16_f32 v175, v178, v179
    v_mfma_f32_16x16x32_bf16 v[44:47], v[32:35], v[164:167], v[44:47]
    v_mfma_f32_16x16x32_bf16 v[48:51], v[32:35], v[156:159], 0
    v_mfma_f32_16x16x32_bf16 v[48:51], v[32:35], v[172:175], v[48:51]
    s_waitcnt lgkmcnt(2)
    v_mfma_f32_16x16x32_bf16 v[200:203], v[228:231], v[68:71], v[36:39]
    v_mfma_f32_16x16x32_bf16 v[200:203], v[232:235], v[76:79], v[200:203]
    s_waitcnt lgkmcnt(0)
    s_barrier
    ds_read_b64_tr_b16 v[212:213], v20 offset:32768
    ds_read_b64_tr_b16 v[214:215], v20 offset:33792
    v_mfma_f32_16x16x32_bf16 v[208:211], v[232:235], v[80:83], v[40:43]
    ds_read_b64_tr_b16 v[216:217], v20 offset:40960
    v_mfma_f32_16x16x32_bf16 v[208:211], v[228:231], v[72:75], v[208:211]
    ds_read_b64_tr_b16 v[218:219], v20 offset:41984
    v_mfma_f32_16x16x32_bf16 v[208:211], v[236:239], v[56:59], v[208:211]
    ds_read_b64_tr_b16 v[220:221], v21 offset:32768
    v_mfma_f32_16x16x32_bf16 v[208:211], v[240:243], v[64:67], v[208:211]
    ds_read_b64_tr_b16 v[222:223], v21 offset:33792
    v_mfma_f32_16x16x32_bf16 v[200:203], v[240:243], v[60:63], v[200:203]
    ds_read_b64_tr_b16 v[224:225], v21 offset:40960
    v_mfma_f32_16x16x32_bf16 v[200:203], v[236:239], v[52:55], v[200:203]
    ds_read_b64_tr_b16 v[226:227], v21 offset:41984
    s_waitcnt lgkmcnt(4)
    v_mfma_f32_16x16x32_bf16 v[92:95], v[212:215], v[156:159], 0
    ds_read_b64_tr_b16 v[228:229], v22 offset:32768
    v_mfma_f32_16x16x32_bf16 v[92:95], v[216:219], v[172:175], v[92:95]
    ds_read_b64_tr_b16 v[230:231], v22 offset:33792
    v_mfma_f32_16x16x32_bf16 v[84:87], v[216:219], v[164:167], 0
    ds_read_b64_tr_b16 v[232:233], v22 offset:40960
    v_mfma_f32_16x16x32_bf16 v[84:87], v[212:215], v[148:151], v[84:87]
    ds_read_b64_tr_b16 v[234:235], v22 offset:41984
    s_waitcnt lgkmcnt(4)
    v_mfma_f32_16x16x32_bf16 v[88:91], v[220:223], v[148:151], 0
    ds_read_b64_tr_b16 v[236:237], v23 offset:32768
    v_mfma_f32_16x16x32_bf16 v[88:91], v[224:227], v[164:167], v[88:91]
    ds_read_b64_tr_b16 v[238:239], v23 offset:33792
    v_mfma_f32_16x16x32_bf16 v[96:99], v[224:227], v[172:175], 0
    ds_read_b64_tr_b16 v[240:241], v23 offset:40960
    v_mfma_f32_16x16x32_bf16 v[96:99], v[220:223], v[156:159], v[96:99]
    ds_read_b64_tr_b16 v[242:243], v23 offset:41984
    s_waitcnt lgkmcnt(4)
    v_mfma_f32_16x16x32_bf16 v[108:111], v[228:231], v[156:159], 0
    ds_read_b64_tr_b16 v[212:213], v24 offset:32768
    v_mfma_f32_16x16x32_bf16 v[108:111], v[232:235], v[172:175], v[108:111]
    ds_read_b64_tr_b16 v[214:215], v24 offset:33792
    v_mfma_f32_16x16x32_bf16 v[100:103], v[232:235], v[164:167], 0
    ds_read_b64_tr_b16 v[216:217], v24 offset:40960
    v_mfma_f32_16x16x32_bf16 v[100:103], v[228:231], v[148:151], v[100:103]
    ds_read_b64_tr_b16 v[218:219], v24 offset:41984
    s_waitcnt lgkmcnt(4)
    v_mfma_f32_16x16x32_bf16 v[104:107], v[236:239], v[148:151], 0
    ds_read_b64_tr_b16 v[220:221], v25 offset:32768
    v_mfma_f32_16x16x32_bf16 v[104:107], v[240:243], v[164:167], v[104:107]
    ds_read_b64_tr_b16 v[222:223], v25 offset:33792
    v_mfma_f32_16x16x32_bf16 v[112:115], v[240:243], v[172:175], 0
    ds_read_b64_tr_b16 v[224:225], v25 offset:40960
    v_mfma_f32_16x16x32_bf16 v[112:115], v[236:239], v[156:159], v[112:115]
    ds_read_b64_tr_b16 v[226:227], v25 offset:41984
    s_waitcnt lgkmcnt(4)
    v_mfma_f32_16x16x32_bf16 v[124:127], v[212:215], v[156:159], 0
    ds_read_b64_tr_b16 v[228:229], v26 offset:32768
    v_mfma_f32_16x16x32_bf16 v[124:127], v[216:219], v[172:175], v[124:127]
    ds_read_b64_tr_b16 v[230:231], v26 offset:33792
    v_mfma_f32_16x16x32_bf16 v[116:119], v[216:219], v[164:167], 0
    ds_read_b64_tr_b16 v[232:233], v26 offset:40960
    v_mfma_f32_16x16x32_bf16 v[116:119], v[212:215], v[148:151], v[116:119]
    ds_read_b64_tr_b16 v[234:235], v26 offset:41984
    s_waitcnt lgkmcnt(4)
    v_mfma_f32_16x16x32_bf16 v[120:123], v[220:223], v[148:151], 0
    ds_read_b64_tr_b16 v[236:237], v27 offset:32768
    v_mfma_f32_16x16x32_bf16 v[120:123], v[224:227], v[164:167], v[120:123]
    ds_read_b64_tr_b16 v[238:239], v27 offset:33792
    v_mfma_f32_16x16x32_bf16 v[128:131], v[224:227], v[172:175], 0
    ds_read_b64_tr_b16 v[240:241], v27 offset:40960
    v_mfma_f32_16x16x32_bf16 v[128:131], v[220:223], v[156:159], v[128:131]
    ds_read_b64_tr_b16 v[242:243], v27 offset:41984
    s_waitcnt lgkmcnt(4)
    v_mfma_f32_16x16x32_bf16 v[140:143], v[228:231], v[156:159], 0
    v_mfma_f32_16x16x32_bf16 v[140:143], v[232:235], v[172:175], v[140:143]
    s_waitcnt lgkmcnt(0)
    s_barrier
    v_mfma_f32_16x16x32_bf16 v[132:135], v[232:235], v[164:167], 0
    ds_read_b128 v[212:215], v16 offset:32768
    v_mfma_f32_16x16x32_bf16 v[132:135], v[228:231], v[148:151], v[132:135]
    ds_read_b128 v[216:219], v17 offset:32768
    v_mfma_f32_16x16x32_bf16 v[136:139], v[236:239], v[148:151], 0
    ds_read_b128 v[220:223], v18 offset:32768
    v_mfma_f32_16x16x32_bf16 v[136:139], v[240:243], v[164:167], v[136:139]
    ds_read_b128 v[224:227], v19 offset:32768
    v_mfma_f32_16x16x32_bf16 v[144:147], v[240:243], v[172:175], 0
    v_mfma_f32_16x16x32_bf16 v[144:147], v[236:239], v[156:159], v[144:147]
    s_waitcnt lgkmcnt(2)
    v_mfma_f32_16x16x32_bf16 v[148:151], v[212:215], v[52:55], v[36:39]
    v_exp_f32 v180, v180
    v_mfma_f32_16x16x32_bf16 v[148:151], v[216:219], v[60:63], v[148:151]
    ds_read_b128 v[228:231], v18 offset:33792
    v_exp_f32 v181, v181
    v_exp_f32 v182, v182
    v_exp_f32 v183, v183
    v_mfma_f32_16x16x32_bf16 v[156:159], v[216:219], v[64:67], v[40:43]
    v_exp_f32 v184, v184
    v_mfma_f32_16x16x32_bf16 v[156:159], v[212:215], v[56:59], v[156:159]
    ds_read_b128 v[232:235], v19 offset:33792
    s_waitcnt lgkmcnt(2)
    v_mfma_f32_16x16x32_bf16 v[156:159], v[220:223], v[72:75], v[156:159]
    v_exp_f32 v185, v185
    v_mfma_f32_16x16x32_bf16 v[156:159], v[224:227], v[80:83], v[156:159]
    ds_read_b128 v[236:239], v16 offset:33792
    v_cvt_pk_bf16_f32 v180, v180, v181
    v_cvt_pk_bf16_f32 v181, v182, v183
    v_cvt_pk_bf16_f32 v182, v184, v185
    v_exp_f32 v186, v186
    v_exp_f32 v187, v187
    v_mfma_f32_16x16x32_bf16 v[148:151], v[224:227], v[76:79], v[148:151]
    v_exp_f32 v188, v188
    v_mfma_f32_16x16x32_bf16 v[148:151], v[220:223], v[68:71], v[148:151]
    ds_read_b128 v[240:243], v17 offset:33792
    v_cvt_pk_bf16_f32 v183, v186, v187
    v_exp_f32 v189, v189
    v_exp_f32 v190, v190
    v_exp_f32 v191, v191
    s_waitcnt lgkmcnt(2)
    v_mfma_f32_16x16x32_bf16 v[152:155], v[228:231], v[68:71], v[36:39]
    v_exp_f32 v192, v192
    v_mfma_f32_16x16x32_bf16 v[152:155], v[232:235], v[76:79], v[152:155]
    ds_read_b128 v[212:215], v16 offset:40960
    v_cvt_pk_bf16_f32 v188, v188, v189
    v_cvt_pk_bf16_f32 v189, v190, v191
    v_exp_f32 v193, v193
    v_exp_f32 v194, v194
    v_mfma_f32_16x16x32_bf16 v[160:163], v[232:235], v[80:83], v[40:43]
    v_exp_f32 v195, v195
    v_mfma_f32_16x16x32_bf16 v[160:163], v[228:231], v[72:75], v[160:163]
    ds_read_b128 v[216:219], v17 offset:40960
    s_waitcnt lgkmcnt(2)
    v_mfma_f32_16x16x32_bf16 v[160:163], v[236:239], v[56:59], v[160:163]
    v_exp_f32 v196, v196
    v_mfma_f32_16x16x32_bf16 v[160:163], v[240:243], v[64:67], v[160:163]
    ds_read_b128 v[220:223], v18 offset:40960
    v_cvt_pk_bf16_f32 v190, v192, v193
    v_cvt_pk_bf16_f32 v191, v194, v195
    v_exp_f32 v197, v197
    v_exp_f32 v198, v198
    v_exp_f32 v199, v199
    v_mfma_f32_16x16x32_bf16 v[152:155], v[240:243], v[60:63], v[152:155]
    v_exp_f32 v200, v200
    v_mfma_f32_16x16x32_bf16 v[152:155], v[236:239], v[52:55], v[152:155]
    ds_read_b128 v[224:227], v19 offset:40960
    v_cvt_pk_bf16_f32 v196, v196, v197
    v_cvt_pk_bf16_f32 v197, v198, v199
    v_exp_f32 v201, v201
    v_exp_f32 v202, v202
    s_waitcnt lgkmcnt(2)
    v_mfma_f32_16x16x32_bf16 v[164:167], v[212:215], v[52:55], v[36:39]
    v_exp_f32 v203, v203
    v_mfma_f32_16x16x32_bf16 v[164:167], v[216:219], v[60:63], v[164:167]
    ds_read_b128 v[228:231], v18 offset:41984
    v_cvt_pk_bf16_f32 v198, v200, v201
    v_cvt_pk_bf16_f32 v199, v202, v203
    v_exp_f32 v204, v204
    v_exp_f32 v205, v205
    v_exp_f32 v206, v206
    v_mfma_f32_16x16x32_bf16 v[172:175], v[216:219], v[64:67], v[40:43]
    v_exp_f32 v207, v207
    v_mfma_f32_16x16x32_bf16 v[172:175], v[212:215], v[56:59], v[172:175]
    ds_read_b128 v[232:235], v19 offset:41984
    s_waitcnt lgkmcnt(2)
    v_mfma_f32_16x16x32_bf16 v[172:175], v[220:223], v[72:75], v[172:175]
    v_exp_f32 v208, v208
    v_mfma_f32_16x16x32_bf16 v[172:175], v[224:227], v[80:83], v[172:175]
    ds_read_b128 v[236:239], v16 offset:41984
    v_cvt_pk_bf16_f32 v204, v204, v205
    v_cvt_pk_bf16_f32 v205, v206, v207
    v_exp_f32 v209, v209
    v_exp_f32 v210, v210
    v_mfma_f32_16x16x32_bf16 v[164:167], v[224:227], v[76:79], v[164:167]
    v_exp_f32 v211, v211
    v_mfma_f32_16x16x32_bf16 v[164:167], v[220:223], v[68:71], v[164:167]
    ds_read_b128 v[240:243], v17 offset:41984
    v_mfma_f32_16x16x32_bf16 v[248:251], v[32:35], v[180:183], v[44:47]
    v_cvt_pk_bf16_f32 v206, v208, v209
    v_cvt_pk_bf16_f32 v207, v210, v211
    v_mfma_f32_16x16x32_bf16 v[248:251], v[32:35], v[196:199], v[248:251]
    v_mfma_f32_16x16x32_bf16 v[252:255], v[32:35], v[188:191], v[48:51]
    v_mfma_f32_16x16x32_bf16 v[252:255], v[32:35], v[204:207], v[252:255]
    s_waitcnt lgkmcnt(2)
    v_mfma_f32_16x16x32_bf16 v[168:171], v[228:231], v[68:71], v[36:39]
    v_mfma_f32_16x16x32_bf16 v[168:171], v[232:235], v[76:79], v[168:171]
    s_waitcnt lgkmcnt(0)
    s_barrier
    ds_read_b64_tr_b16 v[212:213], v20 offset:0
    ds_read_b64_tr_b16 v[214:215], v20 offset:1024
    v_mfma_f32_16x16x32_bf16 v[176:179], v[232:235], v[80:83], v[40:43]
    ds_read_b64_tr_b16 v[216:217], v20 offset:8192
    v_mfma_f32_16x16x32_bf16 v[176:179], v[228:231], v[72:75], v[176:179]
    ds_read_b64_tr_b16 v[218:219], v20 offset:9216
    v_mfma_f32_16x16x32_bf16 v[176:179], v[236:239], v[56:59], v[176:179]
    ds_read_b64_tr_b16 v[220:221], v21 offset:0
    v_max_f32 v1, v248, v252
    v_mfma_f32_16x16x32_bf16 v[176:179], v[240:243], v[64:67], v[176:179]
    ds_read_b64_tr_b16 v[222:223], v21 offset:1024
    v_cmp_lt_f32 vcc, s36, v1
    v_mfma_f32_16x16x32_bf16 v[168:171], v[240:243], v[60:63], v[168:171]
    ds_read_b64_tr_b16 v[224:225], v21 offset:8192
    v_mfma_f32_16x16x32_bf16 v[168:171], v[236:239], v[52:55], v[168:171]
    ds_read_b64_tr_b16 v[226:227], v21 offset:9216
    s_cbranch_vccnz L_rare1
L_back1:
    s_waitcnt lgkmcnt(4)
    v_mfma_f32_16x16x32_bf16 v[92:95], v[212:215], v[188:191], v[92:95]
    ds_read_b64_tr_b16 v[228:229], v22 offset:0
    v_mfma_f32_16x16x32_bf16 v[92:95], v[216:219], v[204:207], v[92:95]
    ds_read_b64_tr_b16 v[230:231], v22 offset:1024
    v_mfma_f32_16x16x32_bf16 v[84:87], v[216:219], v[196:199], v[84:87]
    ds_read_b64_tr_b16 v[232:233], v22 offset:8192
    v_mfma_f32_16x16x32_bf16 v[84:87], v[212:215], v[180:183], v[84:87]
    ds_read_b64_tr_b16 v[234:235], v22 offset:9216
    s_waitcnt lgkmcnt(4)
    v_mfma_f32_16x16x32_bf16 v[88:91], v[220:223], v[180:183], v[88:91]
    ds_read_b64_tr_b16 v[236:237], v23 offset:0
    v_mfma_f32_16x16x32_bf16 v[88:91], v[224:227], v[196:199], v[88:91]
    ds_read_b64_tr_b16 v[238:239], v23 offset:1024
    v_mfma_f32_16x16x32_bf16 v[96:99], v[224:227], v[204:207], v[96:99]
    ds_read_b64_tr_b16 v[240:241], v23 offset:8192
    v_mfma_f32_16x16x32_bf16 v[96:99], v[220:223], v[188:191], v[96:99]
    ds_read_b64_tr_b16 v[242:243], v23 offset:9216
    s_waitcnt lgkmcnt(4)
    v_mfma_f32_16x16x32_bf16 v[108:111], v[228:231], v[188:191], v[108:111]
    ds_read_b64_tr_b16 v[212:213], v24 offset:0
    v_mfma_f32_16x16x32_bf16 v[108:111], v[232:235], v[204:207], v[108:111]
    ds_read_b64_tr_b16 v[214:215], v24 offset:1024
    v_mfma_f32_16x16x32_bf16 v[100:103], v[232:235], v[196:199], v[100:103]
    ds_read_b64_tr_b16 v[216:217], v24 offset:8192
    v_mfma_f32_16x16x32_bf16 v[100:103], v[228:231], v[180:183], v[100:103]
    ds_read_b64_tr_b16 v[218:219], v24 offset:9216
    s_waitcnt lgkmcnt(4)
    v_mfma_f32_16x16x32_bf16 v[104:107], v[236:239], v[180:183], v[104:107]
    ds_read_b64_tr_b16 v[220:221], v25 offset:0
    v_mfma_f32_16x16x32_bf16 v[104:107], v[240:243], v[196:199], v[104:107]
    ds_read_b64_tr_b16 v[222:223], v25 offset:1024
    v_mfma_f32_16x16x32_bf16 v[112:115], v[240:243], v[204:207], v[112:115]
    ds_read_b64_tr_b16 v[224:225], v25 offset:8192
    v_mfma_f32_16x16x32_bf16 v[112:115], v[236:239], v[188:191], v[112:115]
    ds_read_b64_tr_b16 v[226:227], v25 offset:9216
    s_waitcnt lgkmcnt(4)
    v_mfma_f32_16x16x32_bf16 v[124:127], v[212:215], v[188:191], v[124:127]
    ds_read_b64_tr_b16 v[228:229], v26 offset:0
    v_mfma_f32_16x16x32_bf16 v[124:127], v[216:219], v[204:207], v[124:127]
    ds_read_b64_tr_b16 v[230:231], v26 offset:1024
    v_mfma_f32_16x16x32_bf16 v[116:119], v[216:219], v[196:199], v[116:119]
    ds_read_b64_tr_b16 v[232:233], v26 offset:8192
    v_mfma_f32_16x16x32_bf16 v[116:119], v[212:215], v[180:183], v[116:119]
    ds_read_b64_tr_b16 v[234:235], v26 offset:9216
    s_waitcnt lgkmcnt(4)
    v_mfma_f32_16x16x32_bf16 v[120:123], v[220:223], v[180:183], v[120:123]
    ds_read_b64_tr_b16 v[236:237], v27 offset:0
    v_mfma_f32_16x16x32_bf16 v[120:123], v[224:227], v[196:199], v[120:123]
    ds_read_b64_tr_b16 v[238:239], v27 offset:1024
    v_mfma_f32_16x16x32_bf16 v[128:131], v[224:227], v[204:207], v[128:131]
    ds_read_b64_tr_b16 v[240:241], v27 offset:8192
    v_mfma_f32_16x16x32_bf16 v[128:131], v[220:223], v[188:191], v[128:131]
    ds_read_b64_tr_b16 v[242:243], v27 offset:9216
    s_waitcnt lgkmcnt(4)
    v_mfma_f32_16x16x32_bf16 v[140:143], v[228:231], v[188:191], v[140:143]
    v_mfma_f32_16x16x32_bf16 v[140:143], v[232:235], v[204:207], v[140:143]
    s_waitcnt lgkmcnt(0)
    s_barrier
    v_mfma_f32_16x16x32_bf16 v[132:135], v[232:235], v[196:199], v[132:135]
    ds_read_b128 v[212:215], v16 offset:49152
    v_mfma_f32_16x16x32_bf16 v[132:135], v[228:231], v[180:183], v[132:135]
    ds_read_b128 v[216:219], v17 offset:49152
    v_mfma_f32_16x16x32_bf16 v[136:139], v[236:239], v[180:183], v[136:139]
    ds_read_b128 v[220:223], v18 offset:49152
    v_mfma_f32_16x16x32_bf16 v[136:139], v[240:243], v[196:199], v[136:139]
    ds_read_b128 v[224:227], v19 offset:49152
    v_mfma_f32_16x16x32_bf16 v[144:147], v[240:243], v[204:207], v[144:147]
    v_mfma_f32_16x16x32_bf16 v[144:147], v[236:239], v[188:191], v[144:147]
    s_waitcnt lgkmcnt(2)
    v_mfma_f32_16x16x32_bf16 v[180:183], v[212:215], v[52:55], v[36:39]
    v_exp_f32 v148, v148
    v_mfma_f32_16x16x32_bf16 v[180:183], v[216:219], v[60:63], v[180:183]
    ds_read_b128 v[228:231], v18 offset:50176
    v_exp_f32 v149, v149
    v_exp_f32 v150, v150
    v_exp_f32 v151, v151
    v_mfma_f32_16x16x32_bf16 v[188:191], v[216:219], v[64:67], v[40:43]
    v_exp_f32 v152, v152
    v_mfma_f32_16x16x32_bf16 v[188:191], v[212:215], v[56:59], v[188:191]
    ds_read_b128 v[232:235], v19 offset:50176
    s_waitcnt lgkmcnt(2)
    v_mfma_f32_16x16x32_bf16 v[188:191], v[220:223], v[72:75], v[188:191]
    v_exp_f32 v153, v153
    v_mfma_f32_16x16x32_bf16 v[188:191], v[224:227], v[80:83], v[188:191]
    ds_read_b128 v[236:239], v16 offset:50176
    v_cvt_pk_bf16_f32 v148, v148, v149
    v_cvt_pk_bf16_f32 v149, v150, v151
    v_cvt_pk_bf16_f32 v150, v152, v153
    v_exp_f32 v154, v154
    v_exp_f32 v155, v155
    v_mfma_f32_16x16x32_bf16 v[180:183], v[224:227], v[76:79], v[180:183]
    v_exp_f32 v156, v156
    v_mfma_f32_16x16x32_bf16 v[180:183], v[220:223], v[68:71], v[180:183]
    ds_read_b128 v[240:243], v17 offset:50176
    v_cvt_pk_bf16_f32 v151, v154, v155
    v_exp_f32 v157, v157
    v_exp_f32 v158, v158
    v_exp_f32 v159, v159
    s_waitcnt lgkmcnt(2)
    v_mfma_f32_16x16x32_bf16 v[184:187], v[228:231], v[68:71], v[36:39]
    v_exp_f32 v160, v160
    v_mfma_f32_16x16x32_bf16 v[184:187], v[232:235], v[76:79], v[184:187]
    ds_read_b128 v[212:215], v16 offset:57344
    v_cvt_pk_bf16_f32 v156, v156, v157
    v_cvt_pk_bf16_f32 v157, v158, v159
    v_exp_f32 v161, v161
    v_exp_f32 v162, v162
    v_mfma_f32_16x16x32_bf16 v[192:195], v[232:235], v[80:83], v[40:43]
    v_exp_f32 v163, v163
    v_mfma_f32_16x16x32_bf16 v[192:195], v[228:231], v[72:75], v[192:195]
    ds_read_b128 v[216:219], v17 offset:57344
    s_waitcnt lgkmcnt(2)
    v_mfma_f32_16x16x32_bf16 v[192:195], v[236:239], v[56:59], v[192:195]
    v_exp_f32 v164, v164
    v_mfma_f32_16x16x32_bf16 v[192:195], v[240:243], v[64:67], v[192:195]
    ds_read_b128 v[220:223], v18 offset:57344
    v_cvt_pk_bf16_f32 v158, v160, v161
    v_cvt_pk_bf16_f32 v159, v162, v163
    v_exp_f32 v165, v165
    v_exp_f32 v166, v166
    v_exp_f32 v167, v167
    v_mfma_f32_16x16x32_bf16 v[184:187], v[240:243], v[60:63], v[184:187]
    v_exp_f32 v168, v168
    v_mfma_f32_16x16x32_bf16 v[184:187], v[236:239], v[52:55], v[184:187]
    ds_read_b128 v[224:227], v19 offset:57344
    v_cvt_pk_bf16_f32 v164, v164, v165
    v_cvt_pk_bf16_f32 v165, v166, v167
    v_exp_f32 v169, v169
    v_exp_f32 v170, v170
    s_waitcnt lgkmcnt(2)
    v_mfma_f32_16x16x32_bf16 v[196:199], v[212:215], v[52:55], v[36:39]
    v_exp_f32 v171, v171
    v_mfma_f32_16x16x32_bf16 v[196:199], v[216:219], v[60:63], v[196:199]
    ds_read_b128 v[228:231], v18 offset:58368
    v_cvt_pk_bf16_f32 v166, v168, v169
    v_cvt_pk_bf16_f32 v167, v170, v171
    v_exp_f32 v172, v172
    v_exp_f32 v173, v173
    v_exp_f32 v174, v174
    v_mfma_f32_16x16x32_bf16 v[204:207], v[216:219], v[64:67], v[40:43]
    v_exp_f32 v175, v175
    v_mfma_f32_16x16x32_bf16 v[204:207], v[212:215], v[56:59], v[204:207]
    ds_read_b128 v[232:235], v19 offset:58368
    s_waitcnt lgkmcnt(2)
    v_mfma_f32_16x16x32_bf16 v[204:207], v[220:223], v[72:75], v[204:207]
    v_exp_f32 v176, v176
    v_mfma_f32_16x16x32_bf16 v[204:207], v[224:227], v[80:83], v[204:207]
    ds_read_b128 v[236:239], v16 offset:58368
    v_cvt_pk_bf16_f32 v172, v172, v173
    v_cvt_pk_bf16_f32 v173, v174, v175
    v_exp_f32 v177, v177
    v_exp_f32 v178, v178
    v_mfma_f32_16x16x32_bf16 v[196:199], v[224:227], v[76:79], v[196:199]
    v_exp_f32 v179, v179
    v_mfma_f32_16x16x32_bf16 v[196:199], v[220:223], v[68:71], v[196:199]
    ds_read_b128 v[240:243], v17 offset:58368
    v_mfma_f32_16x16x32_bf16 v[44:47], v[32:35], v[148:151], v[248:251]
    v_cvt_pk_bf16_f32 v174, v176, v177
    v_cvt_pk_bf16_f32 v175, v178, v179
    v_mfma_f32_16x16x32_bf16 v[44:47], v[32:35], v[164:167], v[44:47]
    v_mfma_f32_16x16x32_bf16 v[48:51], v[32:35], v[156:159], v[252:255]
    v_mfma_f32_16x16x32_bf16 v[48:51], v[32:35], v[172:175], v[48:51]
    s_waitcnt lgkmcnt(2)
    v_mfma_f32_16x16x32_bf16 v[200:203], v[228:231], v[68:71], v[36:39]
    v_mfma_f32_16x16x32_bf16 v[200:203], v[232:235], v[76:79], v[200:203]
    s_waitcnt lgkmcnt(0)
    s_barrier
    ds_read_b64_tr_b16 v[212:213], v20 offset:49152
    ds_read_b64_tr_b16 v[214:215], v20 offset:50176
    v_mfma_f32_16x16x32_bf16 v[208:211], v[232:235], v[80:83], v[40:43]
    ds_read_b64_tr_b16 v[216:217], v20 offset:57344
    v_mfma_f32_16x16x32_bf16 v[208:211], v[228:231], v[72:75], v[208:211]
    ds_read_b64_tr_b16 v[218:219], v20 offset:58368
    v_mfma_f32_16x16x32_bf16 v[208:211], v[236:239], v[56:59], v[208:211]
    ds_read_b64_tr_b16 v[220:221], v21 offset:49152
    v_max_f32 v1, v44, v48
    v_mfma_f32_16x16x32_bf16 v[208:211], v[240:243], v[64:67], v[208:211]
    ds_read_b64_tr_b16 v[222:223], v21 offset:50176
    v_cmp_lt_f32 vcc, s36, v1
    v_mfma_f32_16x16x32_bf16 v[200:203], v[240:243], v[60:63], v[200:203]
    ds_read_b64_tr_b16 v[224:225], v21 offset:57344
    v_mfma_f32_16x16x32_bf16 v[200:203], v[236:239], v[52:55], v[200:203]
    ds_read_b64_tr_b16 v[226:227], v21 offset:58368
    s_cbranch_vccnz L_rare2
L_back2:
    s_waitcnt lgkmcnt(4)
    v_mfma_f32_16x16x32_bf16 v[92:95], v[212:215], v[156:159], v[92:95]
    ds_read_b64_tr_b16 v[228:229], v22 offset:49152
    v_mfma_f32_16x16x32_bf16 v[92:95], v[216:219], v[172:175], v[92:95]
    ds_read_b64_tr_b16 v[230:231], v22 offset:50176
    v_mfma_f32_16x16x32_bf16 v[84:87], v[216:219], v[164:167], v[84:87]
    ds_read_b64_tr_b16 v[232:233], v22 offset:57344
    v_mfma_f32_16x16x32_bf16 v[84:87], v[212:215], v[148:151], v[84:87]
    ds_read_b64_tr_b16 v[234:235], v22 offset:58368
    s_waitcnt lgkmcnt(4)
    v_mfma_f32_16x16x32_bf16 v[88:91], v[220:223], v[148:151], v[88:91]
    ds_read_b64_tr_b16 v[236:237], v23 offset:49152
    v_mfma_f32_16x16x32_bf16 v[88:91], v[224:227], v[164:167], v[88:91]
    ds_read_b64_tr_b16 v[238:239], v23 offset:50176
    v_mfma_f32_16x16x32_bf16 v[96:99], v[224:227], v[172:175], v[96:99]
    ds_read_b64_tr_b16 v[240:241], v23 offset:57344
    v_mfma_f32_16x16x32_bf16 v[96:99], v[220:223], v[156:159], v[96:99]
    ds_read_b64_tr_b16 v[242:243], v23 offset:58368
    s_waitcnt lgkmcnt(4)
    v_mfma_f32_16x16x32_bf16 v[108:111], v[228:231], v[156:159], v[108:111]
    ds_read_b64_tr_b16 v[212:213], v24 offset:49152
    v_mfma_f32_16x16x32_bf16 v[108:111], v[232:235], v[172:175], v[108:111]
    ds_read_b64_tr_b16 v[214:215], v24 offset:50176
    v_mfma_f32_16x16x32_bf16 v[100:103], v[232:235], v[164:167], v[100:103]
    ds_read_b64_tr_b16 v[216:217], v24 offset:57344
    v_mfma_f32_16x16x32_bf16 v[100:103], v[228:231], v[148:151], v[100:103]
    ds_read_b64_tr_b16 v[218:219], v24 offset:58368
    s_waitcnt lgkmcnt(4)
    v_mfma_f32_16x16x32_bf16 v[104:107], v[236:239], v[148:151], v[104:107]
    ds_read_b64_tr_b16 v[220:221], v25 offset:49152
    v_mfma_f32_16x16x32_bf16 v[104:107], v[240:243], v[164:167], v[104:107]
    ds_read_b64_tr_b16 v[222:223], v25 offset:50176
    v_mfma_f32_16x16x32_bf16 v[112:115], v[240:243], v[172:175], v[112:115]
    ds_read_b64_tr_b16 v[224:225], v25 offset:57344
    v_mfma_f32_16x16x32_bf16 v[112:115], v[236:239], v[156:159], v[112:115]
    ds_read_b64_tr_b16 v[226:227], v25 offset:58368
    s_waitcnt lgkmcnt(4)
    v_mfma_f32_16x16x32_bf16 v[124:127], v[212:215], v[156:159], v[124:127]
    ds_read_b64_tr_b16 v[228:229], v26 offset:49152
    v_mfma_f32_16x16x32_bf16 v[124:127], v[216:219], v[172:175], v[124:127]
    ds_read_b64_tr_b16 v[230:231], v26 offset:50176
    v_mfma_f32_16x16x32_bf16 v[116:119], v[216:219], v[164:167], v[116:119]
    ds_read_b64_tr_b16 v[232:233], v26 offset:57344
    v_mfma_f32_16x16x32_bf16 v[116:119], v[212:215], v[148:151], v[116:119]
    ds_read_b64_tr_b16 v[234:235], v26 offset:58368
    s_waitcnt lgkmcnt(4)
    v_mfma_f32_16x16x32_bf16 v[120:123], v[220:223], v[148:151], v[120:123]
    ds_read_b64_tr_b16 v[236:237], v27 offset:49152
    v_mfma_f32_16x16x32_bf16 v[120:123], v[224:227], v[164:167], v[120:123]
    ds_read_b64_tr_b16 v[238:239], v27 offset:50176
    v_mfma_f32_16x16x32_bf16 v[128:131], v[224:227], v[172:175], v[128:131]
    ds_read_b64_tr_b16 v[240:241], v27 offset:57344
    v_mfma_f32_16x16x32_bf16 v[128:131], v[220:223], v[156:159], v[128:131]
    ds_read_b64_tr_b16 v[242:243], v27 offset:58368
    s_waitcnt lgkmcnt(4)
    v_mfma_f32_16x16x32_bf16 v[140:143], v[228:231], v[156:159], v[140:143]
    v_mfma_f32_16x16x32_bf16 v[140:143], v[232:235], v[172:175], v[140:143]
    s_waitcnt lgkmcnt(0)
    s_barrier
    v_mfma_f32_16x16x32_bf16 v[132:135], v[232:235], v[164:167], v[132:135]
    ds_read_b128 v[212:215], v16 offset:0
    v_mfma_f32_16x16x32_bf16 v[132:135], v[228:231], v[148:151], v[132:135]
    ds_read_b128 v[216:219], v17 offset:0
    v_mfma_f32_16x16x32_bf16 v[136:139], v[236:239], v[148:151], v[136:139]
    ds_read_b128 v[220:223], v18 offset:0
    v_mfma_f32_16x16x32_bf16 v[136:139], v[240:243], v[164:167], v[136:139]
    ds_read_b128 v[224:227], v19 offset:0
    v_mfma_f32_16x16x32_bf16 v[144:147], v[240:243], v[172:175], v[144:147]
    v_mfma_f32_16x16x32_bf16 v[144:147], v[236:239], v[156:159], v[144:147]
    s_waitcnt lgkmcnt(2)
    v_mfma_f32_16x16x32_bf16 v[148:151], v[212:215], v[52:55], v[36:39]
    v_exp_f32 v180, v180
    v_mfma_f32_16x16x32_bf16 v[148:151], v[216:219], v[60:63], v[148:151]
    ds_read_b128 v[228:231], v18 offset:1024
    v_exp_f32 v181, v181
    v_exp_f32 v182, v182
    v_exp_f32 v183, v183
    v_mfma_f32_16x16x32_bf16 v[156:159], v[216:219], v[64:67], v[40:43]
    v_exp_f32 v184, v184
    v_mfma_f32_16x16x32_bf16 v[156:159], v[212:215], v[56:59], v[156:159]
    ds_read_b128 v[232:235], v19 offset:1024
    s_waitcnt lgkmcnt(2)
    v_mfma_f32_16x16x32_bf16 v[156:159], v[220:223], v[72:75], v[156:159]
    v_exp_f32 v185, v185
    v_mfma_f32_16x16x32_bf16 v[156:159], v[224:227], v[80:83], v[156:159]
    ds_read_b128 v[236:239], v16 offset:1024
    v_cvt_pk_bf16_f32 v180, v180, v181
    v_cvt_pk_bf16_f32 v181, v182, v183
    v_cvt_pk_bf16_f32 v182, v184, v185
    v_exp_f32 v186, v186
    v_exp_f32 v187, v187
    v_mfma_f32_16x16x32_bf16 v[148:151], v[224:227], v[76:79], v[148:151]
    v_exp_f32 v188, v188
    v_mfma_f32_16x16x32_bf16 v[148:151], v[220:223], v[68:71], v[148:151]
    ds_read_b128 v[240:243], v17 offset:1024
    v_cvt_pk_bf16_f32 v183, v186, v187
    v_exp_f32 v189, v189
    v_exp_f32 v190, v190
    v_exp_f32 v191, v191
    s_waitcnt lgkmcnt(2)
    v_mfma_f32_16x16x32_bf16 v[152:155], v[228:231], v[68:71], v[36:39]
    v_exp_f32 v192, v192
    v_mfma_f32_16x16x32_bf16 v[152:155], v[232:235], v[76:79], v[152:155]
    ds_read_b128 v[212:215], v16 offset:8192
    v_cvt_pk_bf16_f32 v188, v188, v189
    v_cvt_pk_bf16_f32 v189, v190, v191
    v_exp_f32 v193, v193
    v_exp_f32 v194, v194
    v_mfma_f32_16x16x32_bf16 v[160:163], v[232:235], v[80:83], v[40:43]
    v_exp_f32 v195, v195
    v_mfma_f32_16x16x32_bf16 v[160:163], v[228:231], v[72:75], v[160:163]
    ds_read_b128 v[216:219], v17 offset:8192
    s_waitcnt lgkmcnt(2)
    v_mfma_f32_16x16x32_bf16 v[160:163], v[236:239], v[56:59], v[160:163]
    v_exp_f32 v196, v196
    v_mfma_f32_16x16x32_bf16 v[160:163], v[240:243], v[64:67], v[160:163]
    ds_read_b128 v[220:223], v18 offset:8192
    v_cvt_pk_bf16_f32 v190, v192, v193
    v_cvt_pk_bf16_f32 v191, v194, v195
    v_exp_f32 v197, v197
    v_exp_f32 v198, v198
    v_exp_f32 v199, v199
    v_mfma_f32_16x16x32_bf16 v[152:155], v[240:243], v[60:63], v[152:155]
    v_exp_f32 v200, v200
    v_mfma_f32_16x16x32_bf16 v[152:155], v[236:239], v[52:55], v[152:155]
    ds_read_b128 v[224:227], v19 offset:8192
    v_cvt_pk_bf16_f32 v196, v196, v197
    v_cvt_pk_bf16_f32 v197, v198, v199
    v_exp_f32 v201, v201
    v_exp_f32 v202, v202
    s_waitcnt lgkmcnt(2)
    v_mfma_f32_16x16x32_bf16 v[164:167], v[212:215], v[52:55], v[36:39]
    v_exp_f32 v203, v203
    v_mfma_f32_16x16x32_bf16 v[164:167], v[216:219], v[60:63], v[164:167]
    ds_read_b128 v[228:231], v18 offset:9216
    v_cvt_pk_bf16_f32 v198, v200, v201
    v_cvt_pk_bf16_f32 v199, v202, v203
    v_exp_f32 v204, v204
    v_exp_f32 v205, v205
    v_exp_f32 v206, v206
    v_mfma_f32_16x16x32_bf16 v[172:175], v[216:219], v[64:67], v[40:43]
    v_exp_f32 v207, v207
    v_mfma_f32_16x16x32_bf16 v[172:175], v[212:215], v[56:59], v[172:175]
    ds_read_b128 v[232:235], v19 offset:9216
    s_waitcnt lgkmcnt(2)
    v_mfma_f32_16x16x32_bf16 v[172:175], v[220:223], v[72:75], v[172:175]
    v_exp_f32 v208, v208
    v_mfma_f32_16x16x32_bf16 v[172:175], v[224:227], v[80:83], v[172:175]
    ds_read_b128 v[236:239], v16 offset:9216
    v_cvt_pk_bf16_f32 v204, v204, v205
    v_cvt_pk_bf16_f32 v205, v206, v207
    v_exp_f32 v209, v209
    v_exp_f32 v210, v210
    v_mfma_f32_16x16x32_bf16 v[164:167], v[224:227], v[76:79], v[164:167]
    v_exp_f32 v211, v211
    v_mfma_f32_16x16x32_bf16 v[164:167], v[220:223], v[68:71], v[164:167]
    ds_read_b128 v[240:243], v17 offset:9216
    v_mfma_f32_16x16x32_bf16 v[248:251], v[32:35], v[180:183], v[44:47]
    v_cvt_pk_bf16_f32 v206, v208, v209
    v_cvt_pk_bf16_f32 v207, v210, v211
    v_mfma_f32_16x16x32_bf16 v[248:251], v[32:35], v[196:199], v[248:251]
    v_mfma_f32_16x16x32_bf16 v[252:255], v[32:35], v[188:191], v[48:51]
    v_mfma_f32_16x16x32_bf16 v[252:255], v[32:35], v[204:207], v[252:255]
    s_waitcnt lgkmcnt(2)
    v_mfma_f32_16x16x32_bf16 v[168:171], v[228:231], v[68:71], v[36:39]
    v_mfma_f32_16x16x32_bf16 v[168:171], v[232:235], v[76:79], v[168:171]
    s_waitcnt lgkmcnt(0)
    s_barrier
    ds_read_b64_tr_b16 v[212:213], v20 offset:16384
    ds_read_b64_tr_b16 v[214:215], v20 offset:17408
    v_mfma_f32_16x16x32_bf16 v[176:179], v[232:235], v[80:83], v[40:43]
    ds_read_b64_tr_b16 v[216:217], v20 offset:24576
    v_mfma_f32_16x16x32_bf16 v[176:179], v[228:231], v[72:75], v[176:179]
    ds_read_b64_tr_b16 v[218:219], v20 offset:25600
    v_mfma_f32_16x16x32_bf16 v[176:179], v[236:239], v[56:59], v[176:179]
    ds_read_b64_tr_b16 v[220:221], v21 offset:16384
    v_max_f32 v1, v248, v252
    v_mfma_f32_16x16x32_bf16 v[176:179], v[240:243], v[64:67], v[176:179]
    ds_read_b64_tr_b16 v[222:223], v21 offset:17408
    v_cmp_lt_f32 vcc, s36, v1
    v_mfma_f32_16x16x32_bf16 v[168:171], v[240:243], v[60:63], v[168:171]
    ds_read_b64_tr_b16 v[224:225], v21 offset:24576
    v_mfma_f32_16x16x32_bf16 v[168:171], v[236:239], v[52:55], v[168:171]
    ds_read_b64_tr_b16 v[226:227], v21 offset:25600
    s_cbranch_vccnz L_rare3
L_back3:
    s_waitcnt lgkmcnt(4)
    v_mfma_f32_16x16x32_bf16 v[92:95], v[212:215], v[188:191], v[92:95]
    ds_read_b64_tr_b16 v[228:229], v22 offset:16384
    v_mfma_f32_16x16x32_bf16 v[92:95], v[216:219], v[204:207], v[92:95]
    ds_read_b64_tr_b16 v[230:231], v22 offset:17408
    v_mfma_f32_16x16x32_bf16 v[84:87], v[216:219], v[196:199], v[84:87]
    ds_read_b64_tr_b16 v[232:233], v22 offset:24576
    v_mfma_f32_16x16x32_bf16 v[84:87], v[212:215], v[180:183], v[84:87]
    ds_read_b64_tr_b16 v[234:235], v22 offset:25600
    s_waitcnt lgkmcnt(4)
    v_mfma_f32_16x16x32_bf16 v[88:91], v[220:223], v[180:183], v[88:91]
    ds_read_b64_tr_b16 v[236:237], v23 offset:16384
    v_mfma_f32_16x16x32_bf16 v[88:91], v[224:227], v[196:199], v[88:91]
    ds_read_b64_tr_b16 v[238:239], v23 offset:17408
    v_mfma_f32_16x16x32_bf16 v[96:99], v[224:227], v[204:207], v[96:99]
    ds_read_b64_tr_b16 v[240:241], v23 offset:24576
    v_mfma_f32_16x16x32_bf16 v[96:99], v[220:223], v[188:191], v[96:99]
    ds_read_b64_tr_b16 v[242:243], v23 offset:25600
    s_waitcnt lgkmcnt(4)
    v_mfma_f32_16x16x32_bf16 v[108:111], v[228:231], v[188:191], v[108:111]
    ds_read_b64_tr_b16 v[212:213], v24 offset:16384
    v_mfma_f32_16x16x32_bf16 v[108:111], v[232:235], v[204:207], v[108:111]
    ds_read_b64_tr_b16 v[214:215], v24 offset:17408
    v_mfma_f32_16x16x32_bf16 v[100:103], v[232:235], v[196:199], v[100:103]
    ds_read_b64_tr_b16 v[216:217], v24 offset:24576
    v_mfma_f32_16x16x32_bf16 v[100:103], v[228:231], v[180:183], v[100:103]
    ds_read_b64_tr_b16 v[218:219], v24 offset:25600
    s_waitcnt lgkmcnt(4)
    v_mfma_f32_16x16x32_bf16 v[104:107], v[236:239], v[180:183], v[104:107]
    ds_read_b64_tr_b16 v[220:221], v25 offset:16384
    v_mfma_f32_16x16x32_bf16 v[104:107], v[240:243], v[196:199], v[104:107]
    ds_read_b64_tr_b16 v[222:223], v25 offset:17408
    v_mfma_f32_16x16x32_bf16 v[112:115], v[240:243], v[204:207], v[112:115]
    ds_read_b64_tr_b16 v[224:225], v25 offset:24576
    v_mfma_f32_16x16x32_bf16 v[112:115], v[236:239], v[188:191], v[112:115]
    ds_read_b64_tr_b16 v[226:227], v25 offset:25600
    s_waitcnt lgkmcnt(4)
    v_mfma_f32_16x16x32_bf16 v[124:127], v[212:215], v[188:191], v[124:127]
    ds_read_b64_tr_b16 v[228:229], v26 offset:16384
    v_mfma_f32_16x16x32_bf16 v[124:127], v[216:219], v[204:207], v[124:127]
    ds_read_b64_tr_b16 v[230:231], v26 offset:17408
    v_mfma_f32_16x16x32_bf16 v[116:119], v[216:219], v[196:199], v[116:119]
    ds_read_b64_tr_b16 v[232:233], v26 offset:24576
    v_mfma_f32_16x16x32_bf16 v[116:119], v[212:215], v[180:183], v[116:119]
    ds_read_b64_tr_b16 v[234:235], v26 offset:25600
    s_waitcnt lgkmcnt(4)
    v_mfma_f32_16x16x32_bf16 v[120:123], v[220:223], v[180:183], v[120:123]
    ds_read_b64_tr_b16 v[236:237], v27 offset:16384
    v_mfma_f32_16x16x32_bf16 v[120:123], v[224:227], v[196:199], v[120:123]
    ds_read_b64_tr_b16 v[238:239], v27 offset:17408
    v_mfma_f32_16x16x32_bf16 v[128:131], v[224:227], v[204:207], v[128:131]
    ds_read_b64_tr_b16 v[240:241], v27 offset:24576
    v_mfma_f32_16x16x32_bf16 v[128:131], v[220:223], v[188:191], v[128:131]
    ds_read_b64_tr_b16 v[242:243], v27 offset:25600
    s_waitcnt lgkmcnt(4)
    v_mfma_f32_16x16x32_bf16 v[140:143], v[228:231], v[188:191], v[140:143]
    v_mfma_f32_16x16x32_bf16 v[140:143], v[232:235], v[204:207], v[140:143]
    s_waitcnt lgkmcnt(0)
    s_barrier
    v_mfma_f32_16x16x32_bf16 v[132:135], v[232:235], v[196:199], v[132:135]
    ds_read_b128 v[212:215], v16 offset:16384
    v_mfma_f32_16x16x32_bf16 v[132:135], v[228:231], v[180:183], v[132:135]
    ds_read_b128 v[216:219], v17 offset:16384
    v_mfma_f32_16x16x32_bf16 v[136:139], v[236:239], v[180:183], v[136:139]
    ds_read_b128 v[220:223], v18 offset:16384
    v_mfma_f32_16x16x32_bf16 v[136:139], v[240:243], v[196:199], v[136:139]
    ds_read_b128 v[224:227], v19 offset:16384
    v_mfma_f32_16x16x32_bf16 v[144:147], v[240:243], v[204:207], v[144:147]
    v_mfma_f32_16x16x32_bf16 v[144:147], v[236:239], v[188:191], v[144:147]
    s_waitcnt lgkmcnt(2)
    v_mfma_f32_16x16x32_bf16 v[180:183], v[212:215], v[52:55], v[36:39]
    v_exp_f32 v148, v148
    v_mfma_f32_16x16x32_bf16 v[180:183], v[216:219], v[60:63], v[180:183]
    ds_read_b128 v[228:231], v18 offset:17408
    v_exp_f32 v149, v149
    v_exp_f32 v150, v150
    v_exp_f32 v151, v151
    v_mfma_f32_16x16x32_bf16 v[188:191], v[216:219], v[64:67], v[40:43]
    v_exp_f32 v152, v152
    v_mfma_f32_16x16x32_bf16 v[188:191], v[212:215], v[56:59], v[188:191]
    ds_read_b128 v[232:235], v19 offset:17408
    s_waitcnt lgkmcnt(2)
    v_mfma_f32_16x16x32_bf16 v[188:191], v[220:223], v[72:75], v[188:191]
    v_exp_f32 v153, v153
    v_mfma_f32_16x16x32_bf16 v[188:191], v[224:227], v[80:83], v[188:191]
    ds_read_b128 v[236:239], v16 offset:17408
    v_cvt_pk_bf16_f32 v148, v148, v149
    v_cvt_pk_bf16_f32 v149, v150, v151
    v_cvt_pk_bf16_f32 v150, v152, v153
    v_exp_f32 v154, v154
    v_exp_f32 v155, v155
    v_mfma_f32_16x16x32_bf16 v[180:183], v[224:227], v[76:79], v[180:183]
    v_exp_f32 v156, v156
    v_mfma_f32_16x16x32_bf16 v[180:183], v[220:223], v[68:71], v[180:183]
    ds_read_b128 v[240:243], v17 offset:17408
    v_cvt_pk_bf16_f32 v151, v154, v155
    v_exp_f32 v157, v157
    v_exp_f32 v158, v158
    v_exp_f32 v159, v159
    s_waitcnt lgkmcnt(2)
    v_mfma_f32_16x16x32_bf16 v[184:187], v[228:231], v[68:71], v[36:39]
    v_exp_f32 v160, v160
    v_mfma_f32_16x16x32_bf16 v[184:187], v[232:235], v[76:79], v[184:187]
    ds_read_b128 v[212:215], v16 offset:24576
    v_cvt_pk_bf16_f32 v156, v156, v157
    v_cvt_pk_bf16_f32 v157, v158, v159
    v_exp_f32 v161, v161
    v_exp_f32 v162, v162
    v_mfma_f32_16x16x32_bf16 v[192:195], v[232:235], v[80:83], v[40:43]
    v_exp_f32 v163, v163
    v_mfma_f32_16x16x32_bf16 v[192:195], v[228:231], v[72:75], v[192:195]
    ds_read_b128 v[216:219], v17 offset:24576
    s_waitcnt lgkmcnt(2)
    v_mfma_f32_16x16x32_bf16 v[192:195], v[236:239], v[56:59], v[192:195]
    v_exp_f32 v164, v164
    v_mfma_f32_16x16x32_bf16 v[192:195], v[240:243], v[64:67], v[192:195]
    ds_read_b128 v[220:223], v18 offset:24576
    v_cvt_pk_bf16_f32 v158, v160, v161
    v_cvt_pk_bf16_f32 v159, v162, v163
    v_exp_f32 v165, v165
    v_exp_f32 v166, v166
    v_exp_f32 v167, v167
    v_mfma_f32_16x16x32_bf16 v[184:187], v[240:243], v[60:63], v[184:187]
    v_exp_f32 v168, v168
    v_mfma_f32_16x16x32_bf16 v[184:187], v[236:239], v[52:55], v[184:187]
    ds_read_b128 v[224:227], v19 offset:24576
    v_cvt_pk_bf16_f32 v164, v164, v165
    v_cvt_pk_bf16_f32 v165, v166, v167
    v_exp_f32 v169, v169
    v_exp_f32 v170, v170
    s_waitcnt lgkmcnt(2)
    v_mfma_f32_16x16x32_bf16 v[196:199], v[212:215], v[52:55], v[36:39]
    v_exp_f32 v171, v171
    v_mfma_f32_16x16x32_bf16 v[196:199], v[216:219], v[60:63], v[196:199]
    ds_read_b128 v[228:231], v18 offset:25600
    v_cvt_pk_bf16_f32 v166, v168, v169
    v_cvt_pk_bf16_f32 v167, v170, v171
    v_exp_f32 v172, v172
    v_exp_f32 v173, v173
    v_exp_f32 v174, v174
    v_mfma_f32_16x16x32_bf16 v[204:207], v[216:219], v[64:67], v[40:43]
    v_exp_f32 v175, v175
    v_mfma_f32_16x16x32_bf16 v[204:207], v[212:215], v[56:59], v[204:207]
    ds_read_b128 v[232:235], v19 offset:25600
    s_waitcnt lgkmcnt(2)
    v_mfma_f32_16x16x32_bf16 v[204:207], v[220:223], v[72:75], v[204:207]
    v_exp_f32 v176, v176
    v_mfma_f32_16x16x32_bf16 v[204:207], v[224:227], v[80:83], v[204:207]
    ds_read_b128 v[236:239], v16 offset:25600
    v_cvt_pk_bf16_f32 v172, v172, v173
    v_cvt_pk_bf16_f32 v173, v174, v175
    v_exp_f32 v177, v177
    v_exp_f32 v178, v178
    v_mfma_f32_16x16x32_bf16 v[196:199], v[224:227], v[76:79], v[196:199]
    v_exp_f32 v179, v179
    v_mfma_f32_16x16x32_bf16 v[196:199], v[220:223], v[68:71], v[196:199]
    ds_read_b128 v[240:243], v17 offset:25600
    v_mfma_f32_16x16x32_bf16 v[44:47], v[32:35], v[148:151], v[248:251]
    v_cvt_pk_bf16_f32 v174, v176, v177
    v_cvt_pk_bf16_f32 v175, v178, v179
    v_mfma_f32_16x16x32_bf16 v[44:47], v[32:35], v[164:167], v[44:47]
    v_mfma_f32_16x16x32_bf16 v[48:51], v[32:35], v[156:159], v[252:255]
    v_mfma_f32_16x16x32_bf16 v[48:51], v[32:35], v[172:175], v[48:51]
    s_waitcnt lgkmcnt(2)
    v_mfma_f32_16x16x32_bf16 v[200:203], v[228:231], v[68:71], v[36:39]
    v_mfma_f32_16x16x32_bf16 v[200:203], v[232:235], v[76:79], v[200:203]
    s_waitcnt lgkmcnt(0)
    s_barrier
    ds_read_b64_tr_b16 v[212:213], v20 offset:32768
    ds_read_b64_tr_b16 v[214:215], v20 offset:33792
    v_mfma_f32_16x16x32_bf16 v[208:211], v[232:235], v[80:83], v[40:43]
    ds_read_b64_tr_b16 v[216:217], v20 offset:40960
    v_mfma_f32_16x16x32_bf16 v[208:211], v[228:231], v[72:75], v[208:211]
    ds_read_b64_tr_b16 v[218:219], v20 offset:41984
    v_mfma_f32_16x16x32_bf16 v[208:211], v[236:239], v[56:59], v[208:211]
    ds_read_b64_tr_b16 v[220:221], v21 offset:32768
    v_max_f32 v1, v44, v48
    v_mfma_f32_16x16x32_bf16 v[208:211], v[240:243], v[64:67], v[208:211]
    ds_read_b64_tr_b16 v[222:223], v21 offset:33792
    v_cmp_lt_f32 vcc, s36, v1
    v_mfma_f32_16x16x32_bf16 v[200:203], v[240:243], v[60:63], v[200:203]
    ds_read_b64_tr_b16 v[224:225], v21 offset:40960
    v_mfma_f32_16x16x32_bf16 v[200:203], v[236:239], v[52:55], v[200:203]
    ds_read_b64_tr_b16 v[226:227], v21 offset:41984
    s_cbranch_vccnz L_rare4
L_back4:
    s_waitcnt lgkmcnt(4)
    v_mfma_f32_16x16x32_bf16 v[92:95], v[212:215], v[156:159], v[92:95]
    ds_read_b64_tr_b16 v[228:229], v22 offset:32768
    v_mfma_f32_16x16x32_bf16 v[92:95], v[216:219], v[172:175], v[92:95]
    ds_read_b64_tr_b16 v[230:231], v22 offset:33792
    v_mfma_f32_16x16x32_bf16 v[84:87], v[216:219], v[164:167], v[84:87]
    ds_read_b64_tr_b16 v[232:233], v22 offset:40960
    v_mfma_f32_16x16x32_bf16 v[84:87], v[212:215], v[148:151], v[84:87]
    ds_read_b64_tr_b16 v[234:235], v22 offset:41984
    s_waitcnt lgkmcnt(4)
    v_mfma_f32_16x16x32_bf16 v[88:91], v[220:223], v[148:151], v[88:91]
    ds_read_b64_tr_b16 v[236:237], v23 offset:32768
    v_mfma_f32_16x16x32_bf16 v[88:91], v[224:227], v[164:167], v[88:91]
    ds_read_b64_tr_b16 v[238:239], v23 offset:33792
    v_mfma_f32_16x16x32_bf16 v[96:99], v[224:227], v[172:175], v[96:99]
    ds_read_b64_tr_b16 v[240:241], v23 offset:40960
    v_mfma_f32_16x16x32_bf16 v[96:99], v[220:223], v[156:159], v[96:99]
    ds_read_b64_tr_b16 v[242:243], v23 offset:41984
    s_waitcnt lgkmcnt(4)
    v_mfma_f32_16x16x32_bf16 v[108:111], v[228:231], v[156:159], v[108:111]
    ds_read_b64_tr_b16 v[212:213], v24 offset:32768
    v_mfma_f32_16x16x32_bf16 v[108:111], v[232:235], v[172:175], v[108:111]
    ds_read_b64_tr_b16 v[214:215], v24 offset:33792
    v_mfma_f32_16x16x32_bf16 v[100:103], v[232:235], v[164:167], v[100:103]
    ds_read_b64_tr_b16 v[216:217], v24 offset:40960
    v_mfma_f32_16x16x32_bf16 v[100:103], v[228:231], v[148:151], v[100:103]
    ds_read_b64_tr_b16 v[218:219], v24 offset:41984
    s_waitcnt lgkmcnt(4)
    v_mfma_f32_16x16x32_bf16 v[104:107], v[236:239], v[148:151], v[104:107]
    ds_read_b64_tr_b16 v[220:221], v25 offset:32768
    v_mfma_f32_16x16x32_bf16 v[104:107], v[240:243], v[164:167], v[104:107]
    ds_read_b64_tr_b16 v[222:223], v25 offset:33792
    v_mfma_f32_16x16x32_bf16 v[112:115], v[240:243], v[172:175], v[112:115]
    ds_read_b64_tr_b16 v[224:225], v25 offset:40960
    v_mfma_f32_16x16x32_bf16 v[112:115], v[236:239], v[156:159], v[112:115]
    ds_read_b64_tr_b16 v[226:227], v25 offset:41984
    s_waitcnt lgkmcnt(4)
    v_mfma_f32_16x16x32_bf16 v[124:127], v[212:215], v[156:159], v[124:127]
    ds_read_b64_tr_b16 v[228:229], v26 offset:32768
    v_mfma_f32_16x16x32_bf16 v[124:127], v[216:219], v[172:175], v[124:127]
    ds_read_b64_tr_b16 v[230:231], v26 offset:33792
    v_mfma_f32_16x16x32_bf16 v[116:119], v[216:219], v[164:167], v[116:119]
    ds_read_b64_tr_b16 v[232:233], v26 offset:40960
    v_mfma_f32_16x16x32_bf16 v[116:119], v[212:215], v[148:151], v[116:119]
    ds_read_b64_tr_b16 v[234:235], v26 offset:41984
    s_waitcnt lgkmcnt(4)
    v_mfma_f32_16x16x32_bf16 v[120:123], v[220:223], v[148:151], v[120:123]
    ds_read_b64_tr_b16 v[236:237], v27 offset:32768
    v_mfma_f32_16x16x32_bf16 v[120:123], v[224:227], v[164:167], v[120:123]
    ds_read_b64_tr_b16 v[238:239], v27 offset:33792
    v_mfma_f32_16x16x32_bf16 v[128:131], v[224:227], v[172:175], v[128:131]
    ds_read_b64_tr_b16 v[240:241], v27 offset:40960
    v_mfma_f32_16x16x32_bf16 v[128:131], v[220:223], v[156:159], v[128:131]
    ds_read_b64_tr_b16 v[242:243], v27 offset:41984
    s_waitcnt lgkmcnt(4)
    v_mfma_f32_16x16x32_bf16 v[140:143], v[228:231], v[156:159], v[140:143]
    v_mfma_f32_16x16x32_bf16 v[140:143], v[232:235], v[172:175], v[140:143]
    s_waitcnt lgkmcnt(0)
    s_barrier
    v_mfma_f32_16x16x32_bf16 v[132:135], v[232:235], v[164:167], v[132:135]
    ds_read_b128 v[212:215], v16 offset:32768
    v_mfma_f32_16x16x32_bf16 v[132:135], v[228:231], v[148:151], v[132:135]
    ds_read_b128 v[216:219], v17 offset:32768
    v_mfma_f32_16x16x32_bf16 v[136:139], v[236:239], v[148:151], v[136:139]
    ds_read_b128 v[220:223], v18 offset:32768
    v_mfma_f32_16x16x32_bf16 v[136:139], v[240:243], v[164:167], v[136:139]
    ds_read_b128 v[224:227], v19 offset:32768
    v_mfma_f32_16x16x32_bf16 v[144:147], v[240:243], v[172:175], v[144:147]
    v_mfma_f32_16x16x32_bf16 v[144:147], v[236:239], v[156:159], v[144:147]
    s_waitcnt lgkmcnt(2)
    v_mfma_f32_16x16x32_bf16 v[148:151], v[212:215], v[52:55], v[36:39]
    v_exp_f32 v180, v180
    v_mfma_f32_16x16x32_bf16 v[148:151], v[216:219], v[60:63], v[148:151]
    ds_read_b128 v[228:231], v18 offset:33792
    v_exp_f32 v181, v181
    v_exp_f32 v182, v182
    v_exp_f32 v183, v183
    v_mfma_f32_16x16x32_bf16 v[156:159], v[216:219], v[64:67], v[40:43]
    v_exp_f32 v184, v184
    v_mfma_f32_16x16x32_bf16 v[156:159], v[212:215], v[56:59], v[156:159]
    ds_read_b128 v[232:235], v19 offset:33792
    s_waitcnt lgkmcnt(2)
    v_mfma_f32_16x16x32_bf16 v[156:159], v[220:223], v[72:75], v[156:159]
    v_exp_f32 v185, v185
    v_mfma_f32_16x16x32_bf16 v[156:159], v[224:227], v[80:83], v[156:159]
    ds_read_b128 v[236:239], v16 offset:33792
    v_cvt_pk_bf16_f32 v180, v180, v181
    v_cvt_pk_bf16_f32 v181, v182, v183
    v_cvt_pk_bf16_f32 v182, v184, v185
    v_exp_f32 v186, v186
    v_exp_f32 v187, v187
    v_mfma_f32_16x16x32_bf16 v[148:151], v[224:227], v[76:79], v[148:151]
    v_exp_f32 v188, v188
    v_mfma_f32_16x16x32_bf16 v[148:151], v[220:223], v[68:71], v[148:151]
    ds_read_b128 v[240:243], v17 offset:33792
    v_cvt_pk_bf16_f32 v183, v186, v187
    v_exp_f32 v189, v189
    v_exp_f32 v190, v190
    v_exp_f32 v191, v191
    s_waitcnt lgkmcnt(2)
    v_mfma_f32_16x16x32_bf16 v[152:155], v[228:231], v[68:71], v[36:39]
    v_exp_f32 v192, v192
    v_mfma_f32_16x16x32_bf16 v[152:155], v[232:235], v[76:79], v[152:155]
    ds_read_b128 v[212:215], v16 offset:40960
    v_cvt_pk_bf16_f32 v188, v188, v189
    v_cvt_pk_bf16_f32 v189, v190, v191
    v_exp_f32 v193, v193
    v_exp_f32 v194, v194
    v_mfma_f32_16x16x32_bf16 v[160:163], v[232:235], v[80:83], v[40:43]
    v_exp_f32 v195, v195
    v_mfma_f32_16x16x32_bf16 v[160:163], v[228:231], v[72:75], v[160:163]
    ds_read_b128 v[216:219], v17 offset:40960
    s_waitcnt lgkmcnt(2)
    v_mfma_f32_16x16x32_bf16 v[160:163], v[236:239], v[56:59], v[160:163]
    v_exp_f32 v196, v196
    v_mfma_f32_16x16x32_bf16 v[160:163], v[240:243], v[64:67], v[160:163]
    ds_read_b128 v[220:223], v18 offset:40960
    v_cvt_pk_bf16_f32 v190, v192, v193
    v_cvt_pk_bf16_f32 v191, v194, v195
    v_exp_f32 v197, v197
    v_exp_f32 v198, v198
    v_exp_f32 v199, v199
    v_mfma_f32_16x16x32_bf16 v[152:155], v[240:243], v[60:63], v[152:155]
    v_exp_f32 v200, v200
    v_mfma_f32_16x16x32_bf16 v[152:155], v[236:239], v[52:55], v[152:155]
    ds_read_b128 v[224:227], v19 offset:40960
    v_cvt_pk_bf16_f32 v196, v196, v197
    v_cvt_pk_bf16_f32 v197, v198, v199
    v_exp_f32 v201, v201
    v_exp_f32 v202, v202
    s_waitcnt lgkmcnt(2)
    v_mfma_f32_16x16x32_bf16 v[164:167], v[212:215], v[52:55], v[36:39]
    v_exp_f32 v203, v203
    v_mfma_f32_16x16x32_bf16 v[164:167], v[216:219], v[60:63], v[164:167]
    ds_read_b128 v[228:231], v18 offset:41984
    v_cvt_pk_bf16_f32 v198, v200, v201
    v_cvt_pk_bf16_f32 v199, v202, v203
    v_exp_f32 v204, v204
    v_exp_f32 v205, v205
    v_exp_f32 v206, v206
    v_mfma_f32_16x16x32_bf16 v[172:175], v[216:219], v[64:67], v[40:43]
    v_exp_f32 v207, v207
    v_mfma_f32_16x16x32_bf16 v[172:175], v[212:215], v[56:59], v[172:175]
    ds_read_b128 v[232:235], v19 offset:41984
    s_waitcnt lgkmcnt(2)
    v_mfma_f32_16x16x32_bf16 v[172:175], v[220:223], v[72:75], v[172:175]
    v_exp_f32 v208, v208
    v_mfma_f32_16x16x32_bf16 v[172:175], v[224:227], v[80:83], v[172:175]
    ds_read_b128 v[236:239], v16 offset:41984
    v_cvt_pk_bf16_f32 v204, v204, v205
    v_cvt_pk_bf16_f32 v205, v206, v207
    v_exp_f32 v209, v209
    v_exp_f32 v210, v210
    v_mfma_f32_16x16x32_bf16 v[164:167], v[224:227], v[76:79], v[164:167]
    v_exp_f32 v211, v211
    v_mfma_f32_16x16x32_bf16 v[164:167], v[220:223], v[68:71], v[164:167]
    ds_read_b128 v[240:243], v17 offset:41984
    v_mfma_f32_16x16x32_bf16 v[248:251], v[32:35], v[180:183], v[44:47]
    v_cvt_pk_bf16_f32 v206, v208, v209
    v_cvt_pk_bf16_f32 v207, v210, v211
    v_mfma_f32_16x16x32_bf16 v[248:251], v[32:35], v[196:199], v[248:251]
    v_mfma_f32_16x16x32_bf16 v[252:255], v[32:35], v[188:191], v[48:51]
    v_mfma_f32_16x16x32_bf16 v[252:255], v[32:35], v[204:207], v[252:255]
    s_waitcnt lgkmcnt(2)
    v_mfma_f32_16x16x32_bf16 v[168:171], v[228:231], v[68:71], v[36:39]
    v_mfma_f32_16x16x32_bf16 v[168:171], v[232:235], v[76:79], v[168:171]
    s_waitcnt lgkmcnt(0)
    s_barrier
    ds_read_b64_tr_b16 v[212:213], v20 offset:0
    ds_read_b64_tr_b16 v[214:215], v20 offset:1024
    v_mfma_f32_16x16x32_bf16 v[176:179], v[232:235], v[80:83], v[40:43]
    ds_read_b64_tr_b16 v[216:217], v20 offset:8192
    v_mfma_f32_16x16x32_bf16 v[176:179], v[228:231], v[72:75], v[176:179]
    ds_read_b64_tr_b16 v[218:219], v20 offset:9216
    v_mfma_f32_16x16x32_bf16 v[176:179], v[236:239], v[56:59], v[176:179]
    ds_read_b64_tr_b16 v[220:221], v21 offset:0
    v_max_f32 v1, v248, v252
    v_mfma_f32_16x16x32_bf16 v[176:179], v[240:243], v[64:67], v[176:179]
    ds_read_b64_tr_b16 v[222:223], v21 offset:1024
    v_cmp_lt_f32 vcc, s36, v1
    v_mfma_f32_16x16x32_bf16 v[168:171], v[240:243], v[60:63], v[168:171]
    ds_read_b64_tr_b16 v[224:225], v21 offset:8192
    v_mfma_f32_16x16x32_bf16 v[168:171], v[236:239], v[52:55], v[168:171]
    ds_read_b64_tr_b16 v[226:227], v21 offset:9216
    s_cbranch_vccnz L_rare5
L_back5:
    s_waitcnt lgkmcnt(4)
    v_mfma_f32_16x16x32_bf16 v[92:95], v[212:215], v[188:191], v[92:95]
    ds_read_b64_tr_b16 v[228:229], v22 offset:0
    v_mfma_f32_16x16x32_bf16 v[92:95], v[216:219], v[204:207], v[92:95]
    ds_read_b64_tr_b16 v[230:231], v22 offset:1024
    v_mfma_f32_16x16x32_bf16 v[84:87], v[216:219], v[196:199], v[84:87]
    ds_read_b64_tr_b16 v[232:233], v22 offset:8192
    v_mfma_f32_16x16x32_bf16 v[84:87], v[212:215], v[180:183], v[84:87]
    ds_read_b64_tr_b16 v[234:235], v22 offset:9216
    s_waitcnt lgkmcnt(4)
    v_mfma_f32_16x16x32_bf16 v[88:91], v[220:223], v[180:183], v[88:91]
    ds_read_b64_tr_b16 v[236:237], v23 offset:0
    v_mfma_f32_16x16x32_bf16 v[88:91], v[224:227], v[196:199], v[88:91]
    ds_read_b64_tr_b16 v[238:239], v23 offset:1024
    v_mfma_f32_16x16x32_bf16 v[96:99], v[224:227], v[204:207], v[96:99]
    ds_read_b64_tr_b16 v[240:241], v23 offset:8192
    v_mfma_f32_16x16x32_bf16 v[96:99], v[220:223], v[188:191], v[96:99]
    ds_read_b64_tr_b16 v[242:243], v23 offset:9216
    s_waitcnt lgkmcnt(4)
    v_mfma_f32_16x16x32_bf16 v[108:111], v[228:231], v[188:191], v[108:111]
    ds_read_b64_tr_b16 v[212:213], v24 offset:0
    v_mfma_f32_16x16x32_bf16 v[108:111], v[232:235], v[204:207], v[108:111]
    ds_read_b64_tr_b16 v[214:215], v24 offset:1024
    v_mfma_f32_16x16x32_bf16 v[100:103], v[232:235], v[196:199], v[100:103]
    ds_read_b64_tr_b16 v[216:217], v24 offset:8192
    v_mfma_f32_16x16x32_bf16 v[100:103], v[228:231], v[180:183], v[100:103]
    ds_read_b64_tr_b16 v[218:219], v24 offset:9216
    s_waitcnt lgkmcnt(4)
    v_mfma_f32_16x16x32_bf16 v[104:107], v[236:239], v[180:183], v[104:107]
    ds_read_b64_tr_b16 v[220:221], v25 offset:0
    v_mfma_f32_16x16x32_bf16 v[104:107], v[240:243], v[196:199], v[104:107]
    ds_read_b64_tr_b16 v[222:223], v25 offset:1024
    v_mfma_f32_16x16x32_bf16 v[112:115], v[240:243], v[204:207], v[112:115]
    ds_read_b64_tr_b16 v[224:225], v25 offset:8192
    v_mfma_f32_16x16x32_bf16 v[112:115], v[236:239], v[188:191], v[112:115]
    ds_read_b64_tr_b16 v[226:227], v25 offset:9216
    s_waitcnt lgkmcnt(4)
    v_mfma_f32_16x16x32_bf16 v[124:127], v[212:215], v[188:191], v[124:127]
    ds_read_b64_tr_b16 v[228:229], v26 offset:0
    v_mfma_f32_16x16x32_bf16 v[124:127], v[216:219], v[204:207], v[124:127]
    ds_read_b64_tr_b16 v[230:231], v26 offset:1024
    v_mfma_f32_16x16x32_bf16 v[116:119], v[216:219], v[196:199], v[116:119]
    ds_read_b64_tr_b16 v[232:233], v26 offset:8192
    v_mfma_f32_16x16x32_bf16 v[116:119], v[212:215], v[180:183], v[116:119]
    ds_read_b64_tr_b16 v[234:235], v26 offset:9216
    s_waitcnt lgkmcnt(4)
    v_mfma_f32_16x16x32_bf16 v[120:123], v[220:223], v[180:183], v[120:123]
    ds_read_b64_tr_b16 v[236:237], v27 offset:0
    v_mfma_f32_16x16x32_bf16 v[120:123], v[224:227], v[196:199], v[120:123]
    ds_read_b64_tr_b16 v[238:239], v27 offset:1024
    v_mfma_f32_16x16x32_bf16 v[128:131], v[224:227], v[204:207], v[128:131]
    ds_read_b64_tr_b16 v[240:241], v27 offset:8192
    v_mfma_f32_16x16x32_bf16 v[128:131], v[220:223], v[188:191], v[128:131]
    ds_read_b64_tr_b16 v[242:243], v27 offset:9216
    s_waitcnt lgkmcnt(4)
    v_mfma_f32_16x16x32_bf16 v[140:143], v[228:231], v[188:191], v[140:143]
    v_mfma_f32_16x16x32_bf16 v[140:143], v[232:235], v[204:207], v[140:143]
    s_waitcnt lgkmcnt(0)
    s_barrier
    v_mfma_f32_16x16x32_bf16 v[132:135], v[232:235], v[196:199], v[132:135]
    ds_read_b128 v[212:215], v16 offset:49152
    v_mfma_f32_16x16x32_bf16 v[132:135], v[228:231], v[180:183], v[132:135]
    ds_read_b128 v[216:219], v17 offset:49152
    v_mfma_f32_16x16x32_bf16 v[136:139], v[236:239], v[180:183], v[136:139]
    ds_read_b128 v[220:223], v18 offset:49152
    v_mfma_f32_16x16x32_bf16 v[136:139], v[240:243], v[196:199], v[136:139]
    ds_read_b128 v[224:227], v19 offset:49152
    v_mfma_f32_16x16x32_bf16 v[144:147], v[240:243], v[204:207], v[144:147]
    v_mfma_f32_16x16x32_bf16 v[144:147], v[236:239], v[188:191], v[144:147]
    s_waitcnt lgkmcnt(2)
    v_mfma_f32_16x16x32_bf16 v[180:183], v[212:215], v[52:55], v[36:39]
    v_exp_f32 v148, v148
    v_mfma_f32_16x16x32_bf16 v[180:183], v[216:219], v[60:63], v[180:183]
    ds_read_b128 v[228:231], v18 offset:50176
    v_exp_f32 v149, v149
    v_exp_f32 v150, v150
    v_exp_f32 v151, v151
    v_mfma_f32_16x16x32_bf16 v[188:191], v[216:219], v[64:67], v[40:43]
    v_exp_f32 v152, v152
    v_mfma_f32_16x16x32_bf16 v[188:191], v[212:215], v[56:59], v[188:191]
    ds_read_b128 v[232:235], v19 offset:50176
    s_waitcnt lgkmcnt(2)
    v_mfma_f32_16x16x32_bf16 v[188:191], v[220:223], v[72:75], v[188:191]
    v_exp_f32 v153, v153
    v_mfma_f32_16x16x32_bf16 v[188:191], v[224:227], v[80:83], v[188:191]
    ds_read_b128 v[236:239], v16 offset:50176
    v_cvt_pk_bf16_f32 v148, v148, v149
    v_cvt_pk_bf16_f32 v149, v150, v151
    v_cvt_pk_bf16_f32 v150, v152, v153
    v_exp_f32 v154, v154
    v_exp_f32 v155, v155
    v_mfma_f32_16x16x32_bf16 v[180:183], v[224:227], v[76:79], v[180:183]
    v_exp_f32 v156, v156
    v_mfma_f32_16x16x32_bf16 v[180:183], v[220:223], v[68:71], v[180:183]
    ds_read_b128 v[240:243], v17 offset:50176
    v_cvt_pk_bf16_f32 v151, v154, v155
    v_exp_f32 v157, v157
    v_exp_f32 v158, v158
    v_exp_f32 v159, v159
    s_waitcnt lgkmcnt(2)
    v_mfma_f32_16x16x32_bf16 v[184:187], v[228:231], v[68:71], v[36:39]
    v_exp_f32 v160, v160
    v_mfma_f32_16x16x32_bf16 v[184:187], v[232:235], v[76:79], v[184:187]
    ds_read_b128 v[212:215], v16 offset:57344
    v_cvt_pk_bf16_f32 v156, v156, v157
    v_cvt_pk_bf16_f32 v157, v158, v159
    v_exp_f32 v161, v161
    v_exp_f32 v162, v162
    v_mfma_f32_16x16x32_bf16 v[192:195], v[232:235], v[80:83], v[40:43]
    v_exp_f32 v163, v163
    v_mfma_f32_16x16x32_bf16 v[192:195], v[228:231], v[72:75], v[192:195]
    ds_read_b128 v[216:219], v17 offset:57344
    s_waitcnt lgkmcnt(2)
    v_mfma_f32_16x16x32_bf16 v[192:195], v[236:239], v[56:59], v[192:195]
    v_exp_f32 v164, v164
    v_mfma_f32_16x16x32_bf16 v[192:195], v[240:243], v[64:67], v[192:195]
    ds_read_b128 v[220:223], v18 offset:57344
    v_cvt_pk_bf16_f32 v158, v160, v161
    v_cvt_pk_bf16_f32 v159, v162, v163
    v_exp_f32 v165, v165
    v_exp_f32 v166, v166
    v_exp_f32 v167, v167
    v_mfma_f32_16x16x32_bf16 v[184:187], v[240:243], v[60:63], v[184:187]
    v_exp_f32 v168, v168
    v_mfma_f32_16x16x32_bf16 v[184:187], v[236:239], v[52:55], v[184:187]
    ds_read_b128 v[224:227], v19 offset:57344
    v_cvt_pk_bf16_f32 v164, v164, v165
    v_cvt_pk_bf16_f32 v165, v166, v167
    v_exp_f32 v169, v169
    v_exp_f32 v170, v170
    s_waitcnt lgkmcnt(2)
    v_mfma_f32_16x16x32_bf16 v[196:199], v[212:215], v[52:55], v[36:39]
    v_exp_f32 v171, v171
    v_mfma_f32_16x16x32_bf16 v[196:199], v[216:219], v[60:63], v[196:199]
    ds_read_b128 v[228:231], v18 offset:58368
    v_cvt_pk_bf16_f32 v166, v168, v169
    v_cvt_pk_bf16_f32 v167, v170, v171
    v_exp_f32 v172, v172
    v_exp_f32 v173, v173
    v_exp_f32 v174, v174
    v_mfma_f32_16x16x32_bf16 v[204:207], v[216:219], v[64:67], v[40:43]
    v_exp_f32 v175, v175
    v_mfma_f32_16x16x32_bf16 v[204:207], v[212:215], v[56:59], v[204:207]
    ds_read_b128 v[232:235], v19 offset:58368
    s_waitcnt lgkmcnt(2)
    v_mfma_f32_16x16x32_bf16 v[204:207], v[220:223], v[72:75], v[204:207]
    v_exp_f32 v176, v176
    v_mfma_f32_16x16x32_bf16 v[204:207], v[224:227], v[80:83], v[204:207]
    ds_read_b128 v[236:239], v16 offset:58368
    v_cvt_pk_bf16_f32 v172, v172, v173
    v_cvt_pk_bf16_f32 v173, v174, v175
    v_exp_f32 v177, v177
    v_exp_f32 v178, v178
    v_mfma_f32_16x16x32_bf16 v[196:199], v[224:227], v[76:79], v[196:199]
    v_exp_f32 v179, v179
    v_mfma_f32_16x16x32_bf16 v[196:199], v[220:223], v[68:71], v[196:199]
    ds_read_b128 v[240:243], v17 offset:58368
    v_mfma_f32_16x16x32_bf16 v[44:47], v[32:35], v[148:151], v[248:251]
    v_cvt_pk_bf16_f32 v174, v176, v177
    v_cvt_pk_bf16_f32 v175, v178, v179
    v_mfma_f32_16x16x32_bf16 v[44:47], v[32:35], v[164:167], v[44:47]
    v_mfma_f32_16x16x32_bf16 v[48:51], v[32:35], v[156:159], v[252:255]
    v_mfma_f32_16x16x32_bf16 v[48:51], v[32:35], v[172:175], v[48:51]
    s_waitcnt lgkmcnt(2)
    v_mfma_f32_16x16x32_bf16 v[200:203], v[228:231], v[68:71], v[36:39]
    v_mfma_f32_16x16x32_bf16 v[200:203], v[232:235], v[76:79], v[200:203]
    s_waitcnt lgkmcnt(0)
    s_barrier
    ds_read_b64_tr_b16 v[212:213], v20 offset:49152
    ds_read_b64_tr_b16 v[214:215], v20 offset:50176
    v_mfma_f32_16x16x32_bf16 v[208:211], v[232:235], v[80:83], v[40:43]
    ds_read_b64_tr_b16 v[216:217], v20 offset:57344
    v_mfma_f32_16x16x32_bf16 v[208:211], v[228:231], v[72:75], v[208:211]
    ds_read_b64_tr_b16 v[218:219], v20 offset:58368
    v_mfma_f32_16x16x32_bf16 v[208:211], v[236:239], v[56:59], v[208:211]
    ds_read_b64_tr_b16 v[220:221], v21 offset:49152
    v_max_f32 v1, v44, v48
    v_mfma_f32_16x16x32_bf16 v[208:211], v[240:243], v[64:67], v[208:211]
    ds_read_b64_tr_b16 v[222:223], v21 offset:50176
    v_cmp_lt_f32 vcc, s36, v1
    v_mfma_f32_16x16x32_bf16 v[200:203], v[240:243], v[60:63], v[200:203]
    ds_read_b64_tr_b16 v[224:225], v21 offset:57344
    v_mfma_f32_16x16x32_bf16 v[200:203], v[236:239], v[52:55], v[200:203]
    ds_read_b64_tr_b16 v[226:227], v21 offset:58368
    s_cbranch_vccnz L_rare6
L_back6:
    s_waitcnt lgkmcnt(4)
    v_mfma_f32_16x16x32_bf16 v[92:95], v[212:215], v[156:159], v[92:95]
    ds_read_b64_tr_b16 v[228:229], v22 offset:49152
    v_mfma_f32_16x16x32_bf16 v[92:95], v[216:219], v[172:175], v[92:95]
    ds_read_b64_tr_b16 v[230:231], v22 offset:50176
    v_mfma_f32_16x16x32_bf16 v[84:87], v[216:219], v[164:167], v[84:87]
    ds_read_b64_tr_b16 v[232:233], v22 offset:57344
    v_mfma_f32_16x16x32_bf16 v[84:87], v[212:215], v[148:151], v[84:87]
    ds_read_b64_tr_b16 v[234:235], v22 offset:58368
    s_waitcnt lgkmcnt(4)
    v_mfma_f32_16x16x32_bf16 v[88:91], v[220:223], v[148:151], v[88:91]
    ds_read_b64_tr_b16 v[236:237], v23 offset:49152
    v_mfma_f32_16x16x32_bf16 v[88:91], v[224:227], v[164:167], v[88:91]
    ds_read_b64_tr_b16 v[238:239], v23 offset:50176
    v_mfma_f32_16x16x32_bf16 v[96:99], v[224:227], v[172:175], v[96:99]
    ds_read_b64_tr_b16 v[240:241], v23 offset:57344
    v_mfma_f32_16x16x32_bf16 v[96:99], v[220:223], v[156:159], v[96:99]
    ds_read_b64_tr_b16 v[242:243], v23 offset:58368
    s_waitcnt lgkmcnt(4)
    v_mfma_f32_16x16x32_bf16 v[108:111], v[228:231], v[156:159], v[108:111]
    ds_read_b64_tr_b16 v[212:213], v24 offset:49152
    v_mfma_f32_16x16x32_bf16 v[108:111], v[232:235], v[172:175], v[108:111]
    ds_read_b64_tr_b16 v[214:215], v24 offset:50176
    v_mfma_f32_16x16x32_bf16 v[100:103], v[232:235], v[164:167], v[100:103]
    ds_read_b64_tr_b16 v[216:217], v24 offset:57344
    v_mfma_f32_16x16x32_bf16 v[100:103], v[228:231], v[148:151], v[100:103]
    ds_read_b64_tr_b16 v[218:219], v24 offset:58368
    s_waitcnt lgkmcnt(4)
    v_mfma_f32_16x16x32_bf16 v[104:107], v[236:239], v[148:151], v[104:107]
    ds_read_b64_tr_b16 v[220:221], v25 offset:49152
    v_mfma_f32_16x16x32_bf16 v[104:107], v[240:243], v[164:167], v[104:107]
    ds_read_b64_tr_b16 v[222:223], v25 offset:50176
    v_mfma_f32_16x16x32_bf16 v[112:115], v[240:243], v[172:175], v[112:115]
    ds_read_b64_tr_b16 v[224:225], v25 offset:57344
    v_mfma_f32_16x16x32_bf16 v[112:115], v[236:239], v[156:159], v[112:115]
    ds_read_b64_tr_b16 v[226:227], v25 offset:58368
    s_waitcnt lgkmcnt(4)
    v_mfma_f32_16x16x32_bf16 v[124:127], v[212:215], v[156:159], v[124:127]
    ds_read_b64_tr_b16 v[228:229], v26 offset:49152
    v_mfma_f32_16x16x32_bf16 v[124:127], v[216:219], v[172:175], v[124:127]
    ds_read_b64_tr_b16 v[230:231], v26 offset:50176
    v_mfma_f32_16x16x32_bf16 v[116:119], v[216:219], v[164:167], v[116:119]
    ds_read_b64_tr_b16 v[232:233], v26 offset:57344
    v_mfma_f32_16x16x32_bf16 v[116:119], v[212:215], v[148:151], v[116:119]
    ds_read_b64_tr_b16 v[234:235], v26 offset:58368
    s_waitcnt lgkmcnt(4)
    v_mfma_f32_16x16x32_bf16 v[120:123], v[220:223], v[148:151], v[120:123]
    ds_read_b64_tr_b16 v[236:237], v27 offset:49152
    v_mfma_f32_16x16x32_bf16 v[120:123], v[224:227], v[164:167], v[120:123]
    ds_read_b64_tr_b16 v[238:239], v27 offset:50176
    v_mfma_f32_16x16x32_bf16 v[128:131], v[224:227], v[172:175], v[128:131]
    ds_read_b64_tr_b16 v[240:241], v27 offset:57344
    v_mfma_f32_16x16x32_bf16 v[128:131], v[220:223], v[156:159], v[128:131]
    ds_read_b64_tr_b16 v[242:243], v27 offset:58368
    s_waitcnt lgkmcnt(4)
    v_mfma_f32_16x16x32_bf16 v[140:143], v[228:231], v[156:159], v[140:143]
    v_mfma_f32_16x16x32_bf16 v[140:143], v[232:235], v[172:175], v[140:143]
    s_waitcnt lgkmcnt(0)
    s_barrier
    v_mfma_f32_16x16x32_bf16 v[132:135], v[232:235], v[164:167], v[132:135]
    ds_read_b128 v[212:215], v16 offset:0
    v_mfma_f32_16x16x32_bf16 v[132:135], v[228:231], v[148:151], v[132:135]
    ds_read_b128 v[216:219], v17 offset:0
    v_mfma_f32_16x16x32_bf16 v[136:139], v[236:239], v[148:151], v[136:139]
    ds_read_b128 v[220:223], v18 offset:0
    v_mfma_f32_16x16x32_bf16 v[136:139], v[240:243], v[164:167], v[136:139]
    ds_read_b128 v[224:227], v19 offset:0
    v_mfma_f32_16x16x32_bf16 v[144:147], v[240:243], v[172:175], v[144:147]
    v_mfma_f32_16x16x32_bf16 v[144:147], v[236:239], v[156:159], v[144:147]
    s_waitcnt lgkmcnt(2)
    v_mfma_f32_16x16x32_bf16 v[148:151], v[212:215], v[52:55], v[36:39]
    v_exp_f32 v180, v180
    v_mfma_f32_16x16x32_bf16 v[148:151], v[216:219], v[60:63], v[148:151]
    ds_read_b128 v[228:231], v18 offset:1024
    v_exp_f32 v181, v181
    v_exp_f32 v182, v182
    v_exp_f32 v183, v183
    v_mfma_f32_16x16x32_bf16 v[156:159], v[216:219], v[64:67], v[40:43]
    v_exp_f32 v184, v184
    v_mfma_f32_16x16x32_bf16 v[156:159], v[212:215], v[56:59], v[156:159]
    ds_read_b128 v[232:235], v19 offset:1024
    s_waitcnt lgkmcnt(2)
    v_mfma_f32_16x16x32_bf16 v[156:159], v[220:223], v[72:75], v[156:159]
    v_exp_f32 v185, v185
    v_mfma_f32_16x16x32_bf16 v[156:159], v[224:227], v[80:83], v[156:159]
    ds_read_b128 v[236:239], v16 offset:1024
    v_cvt_pk_bf16_f32 v180, v180, v181
    v_cvt_pk_bf16_f32 v181, v182, v183
    v_cvt_pk_bf16_f32 v182, v184, v185
    v_exp_f32 v186, v186
    v_exp_f32 v187, v187
    v_mfma_f32_16x16x32_bf16 v[148:151], v[224:227], v[76:79], v[148:151]
    v_exp_f32 v188, v188
    v_mfma_f32_16x16x32_bf16 v[148:151], v[220:223], v[68:71], v[148:151]
    ds_read_b128 v[240:243], v17 offset:1024
    v_cvt_pk_bf16_f32 v183, v186, v187
    v_exp_f32 v189, v189
    v_exp_f32 v190, v190
    v_exp_f32 v191, v191
    s_waitcnt lgkmcnt(2)
    v_mfma_f32_16x16x32_bf16 v[152:155], v[228:231], v[68:71], v[36:39]
    v_exp_f32 v192, v192
    v_mfma_f32_16x16x32_bf16 v[152:155], v[232:235], v[76:79], v[152:155]
    ds_read_b128 v[212:215], v16 offset:8192
    v_cvt_pk_bf16_f32 v188, v188, v189
    v_cvt_pk_bf16_f32 v189, v190, v191
    v_exp_f32 v193, v193
    v_exp_f32 v194, v194
    v_mfma_f32_16x16x32_bf16 v[160:163], v[232:235], v[80:83], v[40:43]
    v_exp_f32 v195, v195
    v_mfma_f32_16x16x32_bf16 v[160:163], v[228:231], v[72:75], v[160:163]
    ds_read_b128 v[216:219], v17 offset:8192
    s_waitcnt lgkmcnt(2)
    v_mfma_f32_16x16x32_bf16 v[160:163], v[236:239], v[56:59], v[160:163]
    v_exp_f32 v196, v196
    v_mfma_f32_16x16x32_bf16 v[160:163], v[240:243], v[64:67], v[160:163]
    ds_read_b128 v[220:223], v18 offset:8192
    v_cvt_pk_bf16_f32 v190, v192, v193
    v_cvt_pk_bf16_f32 v191, v194, v195
    v_exp_f32 v197, v197
    v_exp_f32 v198, v198
    v_exp_f32 v199, v199
    v_mfma_f32_16x16x32_bf16 v[152:155], v[240:243], v[60:63], v[152:155]
    v_exp_f32 v200, v200
    v_mfma_f32_16x16x32_bf16 v[152:155], v[236:239], v[52:55], v[152:155]
    ds_read_b128 v[224:227], v19 offset:8192
    v_cvt_pk_bf16_f32 v196, v196, v197
    v_cvt_pk_bf16_f32 v197, v198, v199
    v_exp_f32 v201, v201
    v_exp_f32 v202, v202
    s_waitcnt lgkmcnt(2)
    v_mfma_f32_16x16x32_bf16 v[164:167], v[212:215], v[52:55], v[36:39]
    v_exp_f32 v203, v203
    v_mfma_f32_16x16x32_bf16 v[164:167], v[216:219], v[60:63], v[164:167]
    ds_read_b128 v[228:231], v18 offset:9216
    v_cvt_pk_bf16_f32 v198, v200, v201
    v_cvt_pk_bf16_f32 v199, v202, v203
    v_exp_f32 v204, v204
    v_exp_f32 v205, v205
    v_exp_f32 v206, v206
    v_mfma_f32_16x16x32_bf16 v[172:175], v[216:219], v[64:67], v[40:43]
    v_exp_f32 v207, v207
    v_mfma_f32_16x16x32_bf16 v[172:175], v[212:215], v[56:59], v[172:175]
    ds_read_b128 v[232:235], v19 offset:9216
    s_waitcnt lgkmcnt(2)
    v_mfma_f32_16x16x32_bf16 v[172:175], v[220:223], v[72:75], v[172:175]
    v_exp_f32 v208, v208
    v_mfma_f32_16x16x32_bf16 v[172:175], v[224:227], v[80:83], v[172:175]
    ds_read_b128 v[236:239], v16 offset:9216
    v_cvt_pk_bf16_f32 v204, v204, v205
    v_cvt_pk_bf16_f32 v205, v206, v207
    v_exp_f32 v209, v209
    v_exp_f32 v210, v210
    v_mfma_f32_16x16x32_bf16 v[164:167], v[224:227], v[76:79], v[164:167]
    v_exp_f32 v211, v211
    v_mfma_f32_16x16x32_bf16 v[164:167], v[220:223], v[68:71], v[164:167]
    ds_read_b128 v[240:243], v17 offset:9216
    v_mfma_f32_16x16x32_bf16 v[248:251], v[32:35], v[180:183], v[44:47]
    v_cvt_pk_bf16_f32 v206, v208, v209
    v_cvt_pk_bf16_f32 v207, v210, v211
    v_mfma_f32_16x16x32_bf16 v[248:251], v[32:35], v[196:199], v[248:251]
    v_mfma_f32_16x16x32_bf16 v[252:255], v[32:35], v[188:191], v[48:51]
    v_mfma_f32_16x16x32_bf16 v[252:255], v[32:35], v[204:207], v[252:255]
    s_waitcnt lgkmcnt(2)
    v_mfma_f32_16x16x32_bf16 v[168:171], v[228:231], v[68:71], v[36:39]
    v_mfma_f32_16x16x32_bf16 v[168:171], v[232:235], v[76:79], v[168:171]
    s_waitcnt lgkmcnt(0)
    s_barrier
    ds_read_b64_tr_b16 v[212:213], v20 offset:16384
    ds_read_b64_tr_b16 v[214:215], v20 offset:17408
    v_mfma_f32_16x16x32_bf16 v[176:179], v[232:235], v[80:83], v[40:43]
    ds_read_b64_tr_b16 v[216:217], v20 offset:24576
    v_mfma_f32_16x16x32_bf16 v[176:179], v[228:231], v[72:75], v[176:179]
    ds_read_b64_tr_b16 v[218:219], v20 offset:25600
    v_mfma_f32_16x16x32_bf16 v[176:179], v[236:239], v[56:59], v[176:179]
    ds_read_b64_tr_b16 v[220:221], v21 offset:16384
    v_max_f32 v1, v248, v252
    v_mfma_f32_16x16x32_bf16 v[176:179], v[240:243], v[64:67], v[176:179]
    ds_read_b64_tr_b16 v[222:223], v21 offset:17408
    v_cmp_lt_f32 vcc, s36, v1
    v_mfma_f32_16x16x32_bf16 v[168:171], v[240:243], v[60:63], v[168:171]
    ds_read_b64_tr_b16 v[224:225], v21 offset:24576
    v_mfma_f32_16x16x32_bf16 v[168:171], v[236:239], v[52:55], v[168:171]
    ds_read_b64_tr_b16 v[226:227], v21 offset:25600
    s_cbranch_vccnz L_rare7
L_back7:
    s_waitcnt lgkmcnt(4)
    v_mfma_f32_16x16x32_bf16 v[92:95], v[212:215], v[188:191], v[92:95]
    ds_read_b64_tr_b16 v[228:229], v22 offset:16384
    v_mfma_f32_16x16x32_bf16 v[92:95], v[216:219], v[204:207], v[92:95]
    ds_read_b64_tr_b16 v[230:231], v22 offset:17408
    v_mfma_f32_16x16x32_bf16 v[84:87], v[216:219], v[196:199], v[84:87]
    ds_read_b64_tr_b16 v[232:233], v22 offset:24576
    v_mfma_f32_16x16x32_bf16 v[84:87], v[212:215], v[180:183], v[84:87]
    ds_read_b64_tr_b16 v[234:235], v22 offset:25600
    s_waitcnt lgkmcnt(4)
    v_mfma_f32_16x16x32_bf16 v[88:91], v[220:223], v[180:183], v[88:91]
    ds_read_b64_tr_b16 v[236:237], v23 offset:16384
    v_mfma_f32_16x16x32_bf16 v[88:91], v[224:227], v[196:199], v[88:91]
    ds_read_b64_tr_b16 v[238:239], v23 offset:17408
    v_mfma_f32_16x16x32_bf16 v[96:99], v[224:227], v[204:207], v[96:99]
    ds_read_b64_tr_b16 v[240:241], v23 offset:24576
    v_mfma_f32_16x16x32_bf16 v[96:99], v[220:223], v[188:191], v[96:99]
    ds_read_b64_tr_b16 v[242:243], v23 offset:25600
    s_waitcnt lgkmcnt(4)
    v_mfma_f32_16x16x32_bf16 v[108:111], v[228:231], v[188:191], v[108:111]
    ds_read_b64_tr_b16 v[212:213], v24 offset:16384
    v_mfma_f32_16x16x32_bf16 v[108:111], v[232:235], v[204:207], v[108:111]
    ds_read_b64_tr_b16 v[214:215], v24 offset:17408
    v_mfma_f32_16x16x32_bf16 v[100:103], v[232:235], v[196:199], v[100:103]
    ds_read_b64_tr_b16 v[216:217], v24 offset:24576
    v_mfma_f32_16x16x32_bf16 v[100:103], v[228:231], v[180:183], v[100:103]
    ds_read_b64_tr_b16 v[218:219], v24 offset:25600
    s_waitcnt lgkmcnt(4)
    v_mfma_f32_16x16x32_bf16 v[104:107], v[236:239], v[180:183], v[104:107]
    ds_read_b64_tr_b16 v[220:221], v25 offset:16384
    v_mfma_f32_16x16x32_bf16 v[104:107], v[240:243], v[196:199], v[104:107]
    ds_read_b64_tr_b16 v[222:223], v25 offset:17408
    v_mfma_f32_16x16x32_bf16 v[112:115], v[240:243], v[204:207], v[112:115]
    ds_read_b64_tr_b16 v[224:225], v25 offset:24576
    v_mfma_f32_16x16x32_bf16 v[112:115], v[236:239], v[188:191], v[112:115]
    ds_read_b64_tr_b16 v[226:227], v25 offset:25600
    s_waitcnt lgkmcnt(4)
    v_mfma_f32_16x16x32_bf16 v[124:127], v[212:215], v[188:191], v[124:127]
    ds_read_b64_tr_b16 v[228:229], v26 offset:16384
    v_mfma_f32_16x16x32_bf16 v[124:127], v[216:219], v[204:207], v[124:127]
    ds_read_b64_tr_b16 v[230:231], v26 offset:17408
    v_mfma_f32_16x16x32_bf16 v[116:119], v[216:219], v[196:199], v[116:119]
    ds_read_b64_tr_b16 v[232:233], v26 offset:24576
    v_mfma_f32_16x16x32_bf16 v[116:119], v[212:215], v[180:183], v[116:119]
    ds_read_b64_tr_b16 v[234:235], v26 offset:25600
    s_waitcnt lgkmcnt(4)
    v_mfma_f32_16x16x32_bf16 v[120:123], v[220:223], v[180:183], v[120:123]
    ds_read_b64_tr_b16 v[236:237], v27 offset:16384
    v_mfma_f32_16x16x32_bf16 v[120:123], v[224:227], v[196:199], v[120:123]
    ds_read_b64_tr_b16 v[238:239], v27 offset:17408
    v_mfma_f32_16x16x32_bf16 v[128:131], v[224:227], v[204:207], v[128:131]
    ds_read_b64_tr_b16 v[240:241], v27 offset:24576
    v_mfma_f32_16x16x32_bf16 v[128:131], v[220:223], v[188:191], v[128:131]
    ds_read_b64_tr_b16 v[242:243], v27 offset:25600
    s_waitcnt lgkmcnt(4)
    v_mfma_f32_16x16x32_bf16 v[140:143], v[228:231], v[188:191], v[140:143]
    v_mfma_f32_16x16x32_bf16 v[140:143], v[232:235], v[204:207], v[140:143]
    s_waitcnt lgkmcnt(0)
    s_barrier
    v_mfma_f32_16x16x32_bf16 v[132:135], v[232:235], v[196:199], v[132:135]
    ds_read_b128 v[212:215], v16 offset:32768
    v_mfma_f32_16x16x32_bf16 v[132:135], v[228:231], v[180:183], v[132:135]
    ds_read_b128 v[216:219], v17 offset:32768
    v_mfma_f32_16x16x32_bf16 v[136:139], v[236:239], v[180:183], v[136:139]
    ds_read_b128 v[220:223], v18 offset:32768
    v_mfma_f32_16x16x32_bf16 v[136:139], v[240:243], v[196:199], v[136:139]
    ds_read_b128 v[224:227], v19 offset:32768
    v_mfma_f32_16x16x32_bf16 v[144:147], v[240:243], v[204:207], v[144:147]
    v_mfma_f32_16x16x32_bf16 v[144:147], v[236:239], v[188:191], v[144:147]
    s_waitcnt lgkmcnt(2)
    v_mfma_f32_16x16x32_bf16 v[180:183], v[212:215], v[52:55], v[36:39]
    v_exp_f32 v148, v148
    v_mfma_f32_16x16x32_bf16 v[180:183], v[216:219], v[60:63], v[180:183]
    ds_read_b128 v[228:231], v18 offset:33792
    v_exp_f32 v149, v149
    v_exp_f32 v150, v150
    v_exp_f32 v151, v151
    v_mfma_f32_16x16x32_bf16 v[188:191], v[216:219], v[64:67], v[40:43]
    v_exp_f32 v152, v152
    v_mfma_f32_16x16x32_bf16 v[188:191], v[212:215], v[56:59], v[188:191]
    ds_read_b128 v[232:235], v19 offset:33792
    s_waitcnt lgkmcnt(2)
    v_mfma_f32_16x16x32_bf16 v[188:191], v[220:223], v[72:75], v[188:191]
    v_exp_f32 v153, v153
    v_mfma_f32_16x16x32_bf16 v[188:191], v[224:227], v[80:83], v[188:191]
    ds_read_b128 v[236:239], v16 offset:33792
    v_cvt_pk_bf16_f32 v148, v148, v149
    v_cvt_pk_bf16_f32 v149, v150, v151
    v_cvt_pk_bf16_f32 v150, v152, v153
    v_exp_f32 v154, v154
    v_exp_f32 v155, v155
    v_mfma_f32_16x16x32_bf16 v[180:183], v[224:227], v[76:79], v[180:183]
    v_exp_f32 v156, v156
    v_mfma_f32_16x16x32_bf16 v[180:183], v[220:223], v[68:71], v[180:183]
    ds_read_b128 v[240:243], v17 offset:33792
    v_cvt_pk_bf16_f32 v151, v154, v155
    v_exp_f32 v157, v157
    v_exp_f32 v158, v158
    v_exp_f32 v159, v159
    s_waitcnt lgkmcnt(2)
    v_mfma_f32_16x16x32_bf16 v[184:187], v[228:231], v[68:71], v[36:39]
    v_exp_f32 v160, v160
    v_mfma_f32_16x16x32_bf16 v[184:187], v[232:235], v[76:79], v[184:187]
    ds_read_b128 v[212:215], v16 offset:40960
    v_cvt_pk_bf16_f32 v156, v156, v157
    v_cvt_pk_bf16_f32 v157, v158, v159
    v_exp_f32 v161, v161
    v_exp_f32 v162, v162
    v_mfma_f32_16x16x32_bf16 v[192:195], v[232:235], v[80:83], v[40:43]
    v_exp_f32 v163, v163
    v_mfma_f32_16x16x32_bf16 v[192:195], v[228:231], v[72:75], v[192:195]
    ds_read_b128 v[216:219], v17 offset:40960
    s_waitcnt lgkmcnt(2)
    v_mfma_f32_16x16x32_bf16 v[192:195], v[236:239], v[56:59], v[192:195]
    v_exp_f32 v164, v164
    v_mfma_f32_16x16x32_bf16 v[192:195], v[240:243], v[64:67], v[192:195]
    ds_read_b128 v[220:223], v18 offset:40960
    v_cvt_pk_bf16_f32 v158, v160, v161
    v_cvt_pk_bf16_f32 v159, v162, v163
    v_exp_f32 v165, v165
    v_exp_f32 v166, v166
    v_exp_f32 v167, v167
    v_mfma_f32_16x16x32_bf16 v[184:187], v[240:243], v[60:63], v[184:187]
    v_exp_f32 v168, v168
    v_mfma_f32_16x16x32_bf16 v[184:187], v[236:239], v[52:55], v[184:187]
    ds_read_b128 v[224:227], v19 offset:40960
    v_cvt_pk_bf16_f32 v164, v164, v165
    v_cvt_pk_bf16_f32 v165, v166, v167
    v_exp_f32 v169, v169
    v_exp_f32 v170, v170
    s_waitcnt lgkmcnt(2)
    v_mfma_f32_16x16x32_bf16 v[196:199], v[212:215], v[52:55], v[36:39]
    v_exp_f32 v171, v171
    v_mfma_f32_16x16x32_bf16 v[196:199], v[216:219], v[60:63], v[196:199]
    ds_read_b128 v[228:231], v18 offset:41984
    v_cvt_pk_bf16_f32 v166, v168, v169
    v_cvt_pk_bf16_f32 v167, v170, v171
    v_exp_f32 v172, v172
    v_exp_f32 v173, v173
    v_exp_f32 v174, v174
    v_mfma_f32_16x16x32_bf16 v[204:207], v[216:219], v[64:67], v[40:43]
    v_exp_f32 v175, v175
    v_mfma_f32_16x16x32_bf16 v[204:207], v[212:215], v[56:59], v[204:207]
    ds_read_b128 v[232:235], v19 offset:41984
    s_waitcnt lgkmcnt(2)
    v_mfma_f32_16x16x32_bf16 v[204:207], v[220:223], v[72:75], v[204:207]
    v_exp_f32 v176, v176
    v_mfma_f32_16x16x32_bf16 v[204:207], v[224:227], v[80:83], v[204:207]
    ds_read_b128 v[236:239], v16 offset:41984
    v_cvt_pk_bf16_f32 v172, v172, v173
    v_cvt_pk_bf16_f32 v173, v174, v175
    v_exp_f32 v177, v177
    v_exp_f32 v178, v178
    v_mfma_f32_16x16x32_bf16 v[196:199], v[224:227], v[76:79], v[196:199]
    v_exp_f32 v179, v179
    v_mfma_f32_16x16x32_bf16 v[196:199], v[220:223], v[68:71], v[196:199]
    ds_read_b128 v[240:243], v17 offset:41984
    v_mfma_f32_16x16x32_bf16 v[44:47], v[32:35], v[148:151], v[248:251]
    v_cvt_pk_bf16_f32 v174, v176, v177
    v_cvt_pk_bf16_f32 v175, v178, v179
    v_mfma_f32_16x16x32_bf16 v[44:47], v[32:35], v[164:167], v[44:47]
    v_mfma_f32_16x16x32_bf16 v[48:51], v[32:35], v[156:159], v[252:255]
    v_mfma_f32_16x16x32_bf16 v[48:51], v[32:35], v[172:175], v[48:51]
    s_waitcnt lgkmcnt(2)
    v_mfma_f32_16x16x32_bf16 v[200:203], v[228:231], v[68:71], v[36:39]
    v_mfma_f32_16x16x32_bf16 v[200:203], v[232:235], v[76:79], v[200:203]
    s_waitcnt lgkmcnt(0)
    s_barrier
    ds_read_b64_tr_b16 v[212:213], v20 offset:0
    ds_read_b64_tr_b16 v[214:215], v20 offset:1024
    v_mfma_f32_16x16x32_bf16 v[208:211], v[232:235], v[80:83], v[40:43]
    ds_read_b64_tr_b16 v[216:217], v20 offset:8192
    v_mfma_f32_16x16x32_bf16 v[208:211], v[228:231], v[72:75], v[208:211]
    ds_read_b64_tr_b16 v[218:219], v20 offset:9216
    v_mfma_f32_16x16x32_bf16 v[208:211], v[236:239], v[56:59], v[208:211]
    ds_read_b64_tr_b16 v[220:221], v21 offset:0
    v_max_f32 v1, v44, v48
    v_mfma_f32_16x16x32_bf16 v[208:211], v[240:243], v[64:67], v[208:211]
    ds_read_b64_tr_b16 v[222:223], v21 offset:1024
    v_cmp_lt_f32 vcc, s36, v1
    v_mfma_f32_16x16x32_bf16 v[200:203], v[240:243], v[60:63], v[200:203]
    ds_read_b64_tr_b16 v[224:225], v21 offset:8192
    v_mfma_f32_16x16x32_bf16 v[200:203], v[236:239], v[52:55], v[200:203]
    ds_read_b64_tr_b16 v[226:227], v21 offset:9216
    s_cbranch_vccnz L_rare8
L_back8:
    s_waitcnt lgkmcnt(4)
    v_mfma_f32_16x16x32_bf16 v[92:95], v[212:215], v[156:159], v[92:95]
    ds_read_b64_tr_b16 v[228:229], v22 offset:0
    v_mfma_f32_16x16x32_bf16 v[92:95], v[216:219], v[172:175], v[92:95]
    ds_read_b64_tr_b16 v[230:231], v22 offset:1024
    v_mfma_f32_16x16x32_bf16 v[84:87], v[216:219], v[164:167], v[84:87]
    ds_read_b64_tr_b16 v[232:233], v22 offset:8192
    v_mfma_f32_16x16x32_bf16 v[84:87], v[212:215], v[148:151], v[84:87]
    ds_read_b64_tr_b16 v[234:235], v22 offset:9216
    s_waitcnt lgkmcnt(4)
    v_mfma_f32_16x16x32_bf16 v[88:91], v[220:223], v[148:151], v[88:91]
    ds_read_b64_tr_b16 v[236:237], v23 offset:0
    v_mfma_f32_16x16x32_bf16 v[88:91], v[224:227], v[164:167], v[88:91]
    ds_read_b64_tr_b16 v[238:239], v23 offset:1024
    v_mfma_f32_16x16x32_bf16 v[96:99], v[224:227], v[172:175], v[96:99]
    ds_read_b64_tr_b16 v[240:241], v23 offset:8192
    v_mfma_f32_16x16x32_bf16 v[96:99], v[220:223], v[156:159], v[96:99]
    ds_read_b64_tr_b16 v[242:243], v23 offset:9216
    s_waitcnt lgkmcnt(4)
    v_mfma_f32_16x16x32_bf16 v[108:111], v[228:231], v[156:159], v[108:111]
    ds_read_b64_tr_b16 v[212:213], v24 offset:0
    v_mfma_f32_16x16x32_bf16 v[108:111], v[232:235], v[172:175], v[108:111]
    ds_read_b64_tr_b16 v[214:215], v24 offset:1024
    v_mfma_f32_16x16x32_bf16 v[100:103], v[232:235], v[164:167], v[100:103]
    ds_read_b64_tr_b16 v[216:217], v24 offset:8192
    v_mfma_f32_16x16x32_bf16 v[100:103], v[228:231], v[148:151], v[100:103]
    ds_read_b64_tr_b16 v[218:219], v24 offset:9216
    s_waitcnt lgkmcnt(4)
    v_mfma_f32_16x16x32_bf16 v[104:107], v[236:239], v[148:151], v[104:107]
    ds_read_b64_tr_b16 v[220:221], v25 offset:0
    v_mfma_f32_16x16x32_bf16 v[104:107], v[240:243], v[164:167], v[104:107]
    ds_read_b64_tr_b16 v[222:223], v25 offset:1024
    v_mfma_f32_16x16x32_bf16 v[112:115], v[240:243], v[172:175], v[112:115]
    ds_read_b64_tr_b16 v[224:225], v25 offset:8192
    v_mfma_f32_16x16x32_bf16 v[112:115], v[236:239], v[156:159], v[112:115]
    ds_read_b64_tr_b16 v[226:227], v25 offset:9216
    s_waitcnt lgkmcnt(4)
    v_mfma_f32_16x16x32_bf16 v[124:127], v[212:215], v[156:159], v[124:127]
    ds_read_b64_tr_b16 v[228:229], v26 offset:0
    v_mfma_f32_16x16x32_bf16 v[124:127], v[216:219], v[172:175], v[124:127]
    ds_read_b64_tr_b16 v[230:231], v26 offset:1024
    v_mfma_f32_16x16x32_bf16 v[116:119], v[216:219], v[164:167], v[116:119]
    ds_read_b64_tr_b16 v[232:233], v26 offset:8192
    v_mfma_f32_16x16x32_bf16 v[116:119], v[212:215], v[148:151], v[116:119]
    ds_read_b64_tr_b16 v[234:235], v26 offset:9216
    s_waitcnt lgkmcnt(4)
    v_mfma_f32_16x16x32_bf16 v[120:123], v[220:223], v[148:151], v[120:123]
    ds_read_b64_tr_b16 v[236:237], v27 offset:0
    v_mfma_f32_16x16x32_bf16 v[120:123], v[224:227], v[164:167], v[120:123]
    ds_read_b64_tr_b16 v[238:239], v27 offset:1024
    v_mfma_f32_16x16x32_bf16 v[128:131], v[224:227], v[172:175], v[128:131]
    ds_read_b64_tr_b16 v[240:241], v27 offset:8192
    v_mfma_f32_16x16x32_bf16 v[128:131], v[220:223], v[156:159], v[128:131]
    ds_read_b64_tr_b16 v[242:243], v27 offset:9216
    s_waitcnt lgkmcnt(4)
    v_mfma_f32_16x16x32_bf16 v[140:143], v[228:231], v[156:159], v[140:143]
    v_mfma_f32_16x16x32_bf16 v[140:143], v[232:235], v[172:175], v[140:143]
    s_waitcnt lgkmcnt(0)
    s_barrier
    v_mfma_f32_16x16x32_bf16 v[132:135], v[232:235], v[164:167], v[132:135]
    ds_read_b128 v[212:215], v16 offset:49152
    v_mfma_f32_16x16x32_bf16 v[132:135], v[228:231], v[148:151], v[132:135]
    ds_read_b128 v[216:219], v17 offset:49152
    v_mfma_f32_16x16x32_bf16 v[136:139], v[236:239], v[148:151], v[136:139]
    ds_read_b128 v[220:223], v18 offset:49152
    v_mfma_f32_16x16x32_bf16 v[136:139], v[240:243], v[164:167], v[136:139]
    ds_read_b128 v[224:227], v19 offset:49152
    v_mfma_f32_16x16x32_bf16 v[144:147], v[240:243], v[172:175], v[144:147]
    v_mfma_f32_16x16x32_bf16 v[144:147], v[236:239], v[156:159], v[144:147]
    s_waitcnt lgkmcnt(2)
    v_mfma_f32_16x16x32_bf16 v[148:151], v[212:215], v[52:55], v[36:39]
    v_exp_f32 v180, v180
    v_mfma_f32_16x16x32_bf16 v[148:151], v[216:219], v[60:63], v[148:151]
    ds_read_b128 v[228:231], v18 offset:50176
    v_exp_f32 v181, v181
    v_exp_f32 v182, v182
    v_exp_f32 v183, v183
    v_mfma_f32_16x16x32_bf16 v[156:159], v[216:219], v[64:67], v[40:43]
    v_exp_f32 v184, v184
    v_mfma_f32_16x16x32_bf16 v[156:159], v[212:215], v[56:59], v[156:159]
    ds_read_b128 v[232:235], v19 offset:50176
    s_waitcnt lgkmcnt(2)
    v_mfma_f32_16x16x32_bf16 v[156:159], v[220:223], v[72:75], v[156:159]
    v_exp_f32 v185, v185
    v_mfma_f32_16x16x32_bf16 v[156:159], v[224:227], v[80:83], v[156:159]
    ds_read_b128 v[236:239], v16 offset:50176
    v_cvt_pk_bf16_f32 v180, v180, v181
    v_cvt_pk_bf16_f32 v181, v182, v183
    v_cvt_pk_bf16_f32 v182, v184, v185
    v_exp_f32 v186, v186
    v_exp_f32 v187, v187
    v_mfma_f32_16x16x32_bf16 v[148:151], v[224:227], v[76:79], v[148:151]
    v_exp_f32 v188, v188
    v_mfma_f32_16x16x32_bf16 v[148:151], v[220:223], v[68:71], v[148:151]
    ds_read_b128 v[240:243], v17 offset:50176
    v_cvt_pk_bf16_f32 v183, v186, v187
    v_exp_f32 v189, v189
    v_exp_f32 v190, v190
    v_exp_f32 v191, v191
    s_waitcnt lgkmcnt(2)
    v_mfma_f32_16x16x32_bf16 v[152:155], v[228:231], v[68:71], v[36:39]
    v_exp_f32 v192, v192
    v_mfma_f32_16x16x32_bf16 v[152:155], v[232:235], v[76:79], v[152:155]
    ds_read_b128 v[212:215], v16 offset:57344
    v_cvt_pk_bf16_f32 v188, v188, v189
    v_cvt_pk_bf16_f32 v189, v190, v191
    v_exp_f32 v193, v193
    v_exp_f32 v194, v194
    v_mfma_f32_16x16x32_bf16 v[160:163], v[232:235], v[80:83], v[40:43]
    v_exp_f32 v195, v195
    v_mfma_f32_16x16x32_bf16 v[160:163], v[228:231], v[72:75], v[160:163]
    ds_read_b128 v[216:219], v17 offset:57344
    s_waitcnt lgkmcnt(2)
    v_mfma_f32_16x16x32_bf16 v[160:163], v[236:239], v[56:59], v[160:163]
    v_exp_f32 v196, v196
    v_mfma_f32_16x16x32_bf16 v[160:163], v[240:243], v[64:67], v[160:163]
    ds_read_b128 v[220:223], v18 offset:57344
    v_cvt_pk_bf16_f32 v190, v192, v193
    v_cvt_pk_bf16_f32 v191, v194, v195
    v_exp_f32 v197, v197
    v_exp_f32 v198, v198
    v_exp_f32 v199, v199
    v_mfma_f32_16x16x32_bf16 v[152:155], v[240:243], v[60:63], v[152:155]
    v_exp_f32 v200, v200
    v_mfma_f32_16x16x32_bf16 v[152:155], v[236:239], v[52:55], v[152:155]
    ds_read_b128 v[224:227], v19 offset:57344
    v_cvt_pk_bf16_f32 v196, v196, v197
    v_cvt_pk_bf16_f32 v197, v198, v199
    v_exp_f32 v201, v201
    v_exp_f32 v202, v202
    s_waitcnt lgkmcnt(2)
    v_mfma_f32_16x16x32_bf16 v[164:167], v[212:215], v[52:55], v[36:39]
    v_exp_f32 v203, v203
    v_mfma_f32_16x16x32_bf16 v[164:167], v[216:219], v[60:63], v[164:167]
    ds_read_b128 v[228:231], v18 offset:58368
    v_cvt_pk_bf16_f32 v198, v200, v201
    v_cvt_pk_bf16_f32 v199, v202, v203
    v_exp_f32 v204, v204
    v_exp_f32 v205, v205
    v_exp_f32 v206, v206
    v_mfma_f32_16x16x32_bf16 v[172:175], v[216:219], v[64:67], v[40:43]
    v_exp_f32 v207, v207
    v_mfma_f32_16x16x32_bf16 v[172:175], v[212:215], v[56:59], v[172:175]
    ds_read_b128 v[232:235], v19 offset:58368
    s_waitcnt lgkmcnt(2)
    v_mfma_f32_16x16x32_bf16 v[172:175], v[220:223], v[72:75], v[172:175]
    v_exp_f32 v208, v208
    v_mfma_f32_16x16x32_bf16 v[172:175], v[224:227], v[80:83], v[172:175]
    ds_read_b128 v[236:239], v16 offset:58368
    v_cvt_pk_bf16_f32 v204, v204, v205
    v_cvt_pk_bf16_f32 v205, v206, v207
    v_exp_f32 v209, v209
    v_exp_f32 v210, v210
    v_mfma_f32_16x16x32_bf16 v[164:167], v[224:227], v[76:79], v[164:167]
    v_exp_f32 v211, v211
    v_mfma_f32_16x16x32_bf16 v[164:167], v[220:223], v[68:71], v[164:167]
    ds_read_b128 v[240:243], v17 offset:58368
    v_mfma_f32_16x16x32_bf16 v[248:251], v[32:35], v[180:183], v[44:47]
    v_cvt_pk_bf16_f32 v206, v208, v209
    v_cvt_pk_bf16_f32 v207, v210, v211
    v_mfma_f32_16x16x32_bf16 v[248:251], v[32:35], v[196:199], v[248:251]
    v_mfma_f32_16x16x32_bf16 v[252:255], v[32:35], v[188:191], v[48:51]
    v_mfma_f32_16x16x32_bf16 v[252:255], v[32:35], v[204:207], v[252:255]
    s_waitcnt lgkmcnt(2)
    v_mfma_f32_16x16x32_bf16 v[168:171], v[228:231], v[68:71], v[36:39]
    v_mfma_f32_16x16x32_bf16 v[168:171], v[232:235], v[76:79], v[168:171]
    s_waitcnt lgkmcnt(0)
    s_barrier
    ds_read_b64_tr_b16 v[212:213], v20 offset:32768
    ds_read_b64_tr_b16 v[214:215], v20 offset:33792
    v_mfma_f32_16x16x32_bf16 v[176:179], v[232:235], v[80:83], v[40:43]
    ds_read_b64_tr_b16 v[216:217], v20 offset:40960
    v_mfma_f32_16x16x32_bf16 v[176:179], v[228:231], v[72:75], v[176:179]
    ds_read_b64_tr_b16 v[218:219], v20 offset:41984
    v_mfma_f32_16x16x32_bf16 v[176:179], v[236:239], v[56:59], v[176:179]
    ds_read_b64_tr_b16 v[220:221], v21 offset:32768
    v_max_f32 v1, v248, v252
    v_mfma_f32_16x16x32_bf16 v[176:179], v[240:243], v[64:67], v[176:179]
    ds_read_b64_tr_b16 v[222:223], v21 offset:33792
    v_cmp_lt_f32 vcc, s36, v1
    v_mfma_f32_16x16x32_bf16 v[168:171], v[240:243], v[60:63], v[168:171]
    ds_read_b64_tr_b16 v[224:225], v21 offset:40960
    v_mfma_f32_16x16x32_bf16 v[168:171], v[236:239], v[52:55], v[168:171]
    ds_read_b64_tr_b16 v[226:227], v21 offset:41984
    s_cbranch_vccnz L_rare9
L_back9:
    s_waitcnt lgkmcnt(4)
    v_mfma_f32_16x16x32_bf16 v[92:95], v[212:215], v[188:191], v[92:95]
    ds_read_b64_tr_b16 v[228:229], v22 offset:32768
    v_mfma_f32_16x16x32_bf16 v[92:95], v[216:219], v[204:207], v[92:95]
    ds_read_b64_tr_b16 v[230:231], v22 offset:33792
    v_mfma_f32_16x16x32_bf16 v[84:87], v[216:219], v[196:199], v[84:87]
    ds_read_b64_tr_b16 v[232:233], v22 offset:40960
    v_mfma_f32_16x16x32_bf16 v[84:87], v[212:215], v[180:183], v[84:87]
    ds_read_b64_tr_b16 v[234:235], v22 offset:41984
    s_waitcnt lgkmcnt(4)
    v_mfma_f32_16x16x32_bf16 v[88:91], v[220:223], v[180:183], v[88:91]
    ds_read_b64_tr_b16 v[236:237], v23 offset:32768
    v_mfma_f32_16x16x32_bf16 v[88:91], v[224:227], v[196:199], v[88:91]
    ds_read_b64_tr_b16 v[238:239], v23 offset:33792
    v_mfma_f32_16x16x32_bf16 v[96:99], v[224:227], v[204:207], v[96:99]
    ds_read_b64_tr_b16 v[240:241], v23 offset:40960
    v_mfma_f32_16x16x32_bf16 v[96:99], v[220:223], v[188:191], v[96:99]
    ds_read_b64_tr_b16 v[242:243], v23 offset:41984
    s_waitcnt lgkmcnt(4)
    v_mfma_f32_16x16x32_bf16 v[108:111], v[228:231], v[188:191], v[108:111]
    ds_read_b64_tr_b16 v[212:213], v24 offset:32768
    v_mfma_f32_16x16x32_bf16 v[108:111], v[232:235], v[204:207], v[108:111]
    ds_read_b64_tr_b16 v[214:215], v24 offset:33792
    v_mfma_f32_16x16x32_bf16 v[100:103], v[232:235], v[196:199], v[100:103]
    ds_read_b64_tr_b16 v[216:217], v24 offset:40960
    v_mfma_f32_16x16x32_bf16 v[100:103], v[228:231], v[180:183], v[100:103]
    ds_read_b64_tr_b16 v[218:219], v24 offset:41984
    s_waitcnt lgkmcnt(4)
    v_mfma_f32_16x16x32_bf16 v[104:107], v[236:239], v[180:183], v[104:107]
    ds_read_b64_tr_b16 v[220:221], v25 offset:32768
    v_mfma_f32_16x16x32_bf16 v[104:107], v[240:243], v[196:199], v[104:107]
    ds_read_b64_tr_b16 v[222:223], v25 offset:33792
    v_mfma_f32_16x16x32_bf16 v[112:115], v[240:243], v[204:207], v[112:115]
    ds_read_b64_tr_b16 v[224:225], v25 offset:40960
    v_mfma_f32_16x16x32_bf16 v[112:115], v[236:239], v[188:191], v[112:115]
    ds_read_b64_tr_b16 v[226:227], v25 offset:41984
    s_waitcnt lgkmcnt(4)
    v_mfma_f32_16x16x32_bf16 v[124:127], v[212:215], v[188:191], v[124:127]
    ds_read_b64_tr_b16 v[228:229], v26 offset:32768
    v_mfma_f32_16x16x32_bf16 v[124:127], v[216:219], v[204:207], v[124:127]
    ds_read_b64_tr_b16 v[230:231], v26 offset:33792
    v_mfma_f32_16x16x32_bf16 v[116:119], v[216:219], v[196:199], v[116:119]
    ds_read_b64_tr_b16 v[232:233], v26 offset:40960
    v_mfma_f32_16x16x32_bf16 v[116:119], v[212:215], v[180:183], v[116:119]
    ds_read_b64_tr_b16 v[234:235], v26 offset:41984
    s_waitcnt lgkmcnt(4)
    v_mfma_f32_16x16x32_bf16 v[120:123], v[220:223], v[180:183], v[120:123]
    ds_read_b64_tr_b16 v[236:237], v27 offset:32768
    v_mfma_f32_16x16x32_bf16 v[120:123], v[224:227], v[196:199], v[120:123]
    ds_read_b64_tr_b16 v[238:239], v27 offset:33792
    v_mfma_f32_16x16x32_bf16 v[128:131], v[224:227], v[204:207], v[128:131]
    ds_read_b64_tr_b16 v[240:241], v27 offset:40960
    v_mfma_f32_16x16x32_bf16 v[128:131], v[220:223], v[188:191], v[128:131]
    ds_read_b64_tr_b16 v[242:243], v27 offset:41984
    s_waitcnt lgkmcnt(4)
    v_mfma_f32_16x16x32_bf16 v[140:143], v[228:231], v[188:191], v[140:143]
    v_mfma_f32_16x16x32_bf16 v[140:143], v[232:235], v[204:207], v[140:143]
    s_waitcnt lgkmcnt(0)
    s_barrier
    v_mfma_f32_16x16x32_bf16 v[132:135], v[232:235], v[196:199], v[132:135]
    ds_read_b128 v[212:215], v16 offset:16384
    v_mfma_f32_16x16x32_bf16 v[132:135], v[228:231], v[180:183], v[132:135]
    ds_read_b128 v[216:219], v17 offset:16384
    v_mfma_f32_16x16x32_bf16 v[136:139], v[236:239], v[180:183], v[136:139]
    ds_read_b128 v[220:223], v18 offset:16384
    v_mfma_f32_16x16x32_bf16 v[136:139], v[240:243], v[196:199], v[136:139]
    ds_read_b128 v[224:227], v19 offset:16384
    v_mfma_f32_16x16x32_bf16 v[144:147], v[240:243], v[204:207], v[144:147]
    v_mfma_f32_16x16x32_bf16 v[144:147], v[236:239], v[188:191], v[144:147]
    s_waitcnt lgkmcnt(2)
    v_mfma_f32_16x16x32_bf16 v[180:183], v[212:215], v[52:55], v[36:39]
    v_exp_f32 v148, v148
    v_mfma_f32_16x16x32_bf16 v[180:183], v[216:219], v[60:63], v[180:183]
    ds_read_b128 v[228:231], v18 offset:17408
    v_exp_f32 v149, v149
    v_exp_f32 v150, v150
    v_exp_f32 v151, v151
    v_mfma_f32_16x16x32_bf16 v[188:191], v[216:219], v[64:67], v[40:43]
    v_exp_f32 v152, v152
    v_mfma_f32_16x16x32_bf16 v[188:191], v[212:215], v[56:59], v[188:191]
    ds_read_b128 v[232:235], v19 offset:17408
    s_waitcnt lgkmcnt(2)
    v_mfma_f32_16x16x32_bf16 v[188:191], v[220:223], v[72:75], v[188:191]
    v_exp_f32 v153, v153
    v_mfma_f32_16x16x32_bf16 v[188:191], v[224:227], v[80:83], v[188:191]
    ds_read_b128 v[236:239], v16 offset:17408
    v_cvt_pk_bf16_f32 v148, v148, v149
    v_cvt_pk_bf16_f32 v149, v150, v151
    v_cvt_pk_bf16_f32 v150, v152, v153
    v_exp_f32 v154, v154
    v_exp_f32 v155, v155
    v_mfma_f32_16x16x32_bf16 v[180:183], v[224:227], v[76:79], v[180:183]
    v_exp_f32 v156, v156
    v_mfma_f32_16x16x32_bf16 v[180:183], v[220:223], v[68:71], v[180:183]
    ds_read_b128 v[240:243], v17 offset:17408
    v_cvt_pk_bf16_f32 v151, v154, v155
    v_exp_f32 v157, v157
    v_exp_f32 v158, v158
    v_exp_f32 v159, v159
    s_waitcnt lgkmcnt(2)
    v_mfma_f32_16x16x32_bf16 v[184:187], v[228:231], v[68:71], v[36:39]
    v_exp_f32 v160, v160
    v_mfma_f32_16x16x32_bf16 v[184:187], v[232:235], v[76:79], v[184:187]
    ds_read_b128 v[212:215], v16 offset:24576
    v_cvt_pk_bf16_f32 v156, v156, v157
    v_cvt_pk_bf16_f32 v157, v158, v159
    v_exp_f32 v161, v161
    v_exp_f32 v162, v162
    v_mfma_f32_16x16x32_bf16 v[192:195], v[232:235], v[80:83], v[40:43]
    v_exp_f32 v163, v163
    v_mfma_f32_16x16x32_bf16 v[192:195], v[228:231], v[72:75], v[192:195]
    ds_read_b128 v[216:219], v17 offset:24576
    s_waitcnt lgkmcnt(2)
    v_mfma_f32_16x16x32_bf16 v[192:195], v[236:239], v[56:59], v[192:195]
    v_exp_f32 v164, v164
    v_mfma_f32_16x16x32_bf16 v[192:195], v[240:243], v[64:67], v[192:195]
    ds_read_b128 v[220:223], v18 offset:24576
    v_cvt_pk_bf16_f32 v158, v160, v161
    v_cvt_pk_bf16_f32 v159, v162, v163
    v_exp_f32 v165, v165
    v_exp_f32 v166, v166
    v_exp_f32 v167, v167
    v_mfma_f32_16x16x32_bf16 v[184:187], v[240:243], v[60:63], v[184:187]
    v_exp_f32 v168, v168
    v_mfma_f32_16x16x32_bf16 v[184:187], v[236:239], v[52:55], v[184:187]
    ds_read_b128 v[224:227], v19 offset:24576
    v_cvt_pk_bf16_f32 v164, v164, v165
    v_cvt_pk_bf16_f32 v165, v166, v167
    v_exp_f32 v169, v169
    v_exp_f32 v170, v170
    s_waitcnt lgkmcnt(2)
    v_mfma_f32_16x16x32_bf16 v[196:199], v[212:215], v[52:55], v[36:39]
    v_exp_f32 v171, v171
    v_mfma_f32_16x16x32_bf16 v[196:199], v[216:219], v[60:63], v[196:199]
    ds_read_b128 v[228:231], v18 offset:25600
    v_cvt_pk_bf16_f32 v166, v168, v169
    v_cvt_pk_bf16_f32 v167, v170, v171
    v_exp_f32 v172, v172
    v_exp_f32 v173, v173
    v_exp_f32 v174, v174
    v_mfma_f32_16x16x32_bf16 v[204:207], v[216:219], v[64:67], v[40:43]
    v_exp_f32 v175, v175
    v_mfma_f32_16x16x32_bf16 v[204:207], v[212:215], v[56:59], v[204:207]
    ds_read_b128 v[232:235], v19 offset:25600
    s_waitcnt lgkmcnt(2)
    v_mfma_f32_16x16x32_bf16 v[204:207], v[220:223], v[72:75], v[204:207]
    v_exp_f32 v176, v176
    v_mfma_f32_16x16x32_bf16 v[204:207], v[224:227], v[80:83], v[204:207]
    ds_read_b128 v[236:239], v16 offset:25600
    v_cvt_pk_bf16_f32 v172, v172, v173
    v_cvt_pk_bf16_f32 v173, v174, v175
    v_exp_f32 v177, v177
    v_exp_f32 v178, v178
    v_mfma_f32_16x16x32_bf16 v[196:199], v[224:227], v[76:79], v[196:199]
    v_exp_f32 v179, v179
    v_mfma_f32_16x16x32_bf16 v[196:199], v[220:223], v[68:71], v[196:199]
    ds_read_b128 v[240:243], v17 offset:25600
    v_mfma_f32_16x16x32_bf16 v[44:47], v[32:35], v[148:151], v[248:251]
    v_cvt_pk_bf16_f32 v174, v176, v177
    v_cvt_pk_bf16_f32 v175, v178, v179
    v_mfma_f32_16x16x32_bf16 v[44:47], v[32:35], v[164:167], v[44:47]
    v_mfma_f32_16x16x32_bf16 v[48:51], v[32:35], v[156:159], v[252:255]
    v_mfma_f32_16x16x32_bf16 v[48:51], v[32:35], v[172:175], v[48:51]
    s_waitcnt lgkmcnt(2)
    v_mfma_f32_16x16x32_bf16 v[200:203], v[228:231], v[68:71], v[36:39]
    v_mfma_f32_16x16x32_bf16 v[200:203], v[232:235], v[76:79], v[200:203]
    s_waitcnt lgkmcnt(0)
    s_barrier
    ds_read_b64_tr_b16 v[212:213], v20 offset:16384
    ds_read_b64_tr_b16 v[214:215], v20 offset:17408
    v_mfma_f32_16x16x32_bf16 v[208:211], v[232:235], v[80:83], v[40:43]
    ds_read_b64_tr_b16 v[216:217], v20 offset:24576
    v_mfma_f32_16x16x32_bf16 v[208:211], v[228:231], v[72:75], v[208:211]
    ds_read_b64_tr_b16 v[218:219], v20 offset:25600
    v_mfma_f32_16x16x32_bf16 v[208:211], v[236:239], v[56:59], v[208:211]
    ds_read_b64_tr_b16 v[220:221], v21 offset:16384
    v_max_f32 v1, v44, v48
    v_mfma_f32_16x16x32_bf16 v[208:211], v[240:243], v[64:67], v[208:211]
    ds_read_b64_tr_b16 v[222:223], v21 offset:17408
    v_cmp_lt_f32 vcc, s36, v1
    v_mfma_f32_16x16x32_bf16 v[200:203], v[240:243], v[60:63], v[200:203]
    ds_read_b64_tr_b16 v[224:225], v21 offset:24576
    v_mfma_f32_16x16x32_bf16 v[200:203], v[236:239], v[52:55], v[200:203]
    ds_read_b64_tr_b16 v[226:227], v21 offset:25600
    s_cbranch_vccnz L_rare10
L_back10:
    s_waitcnt lgkmcnt(4)
    v_mfma_f32_16x16x32_bf16 v[92:95], v[212:215], v[156:159], v[92:95]
    ds_read_b64_tr_b16 v[228:229], v22 offset:16384
    v_mfma_f32_16x16x32_bf16 v[92:95], v[216:219], v[172:175], v[92:95]
    ds_read_b64_tr_b16 v[230:231], v22 offset:17408
    v_mfma_f32_16x16x32_bf16 v[84:87], v[216:219], v[164:167], v[84:87]
    ds_read_b64_tr_b16 v[232:233], v22 offset:24576
    v_mfma_f32_16x16x32_bf16 v[84:87], v[212:215], v[148:151], v[84:87]
    ds_read_b64_tr_b16 v[234:235], v22 offset:25600
    s_waitcnt lgkmcnt(4)
    v_mfma_f32_16x16x32_bf16 v[88:91], v[220:223], v[148:151], v[88:91]
    ds_read_b64_tr_b16 v[236:237], v23 offset:16384
    v_mfma_f32_16x16x32_bf16 v[88:91], v[224:227], v[164:167], v[88:91]
    ds_read_b64_tr_b16 v[238:239], v23 offset:17408
    v_mfma_f32_16x16x32_bf16 v[96:99], v[224:227], v[172:175], v[96:99]
    ds_read_b64_tr_b16 v[240:241], v23 offset:24576
    v_mfma_f32_16x16x32_bf16 v[96:99], v[220:223], v[156:159], v[96:99]
    ds_read_b64_tr_b16 v[242:243], v23 offset:25600
    s_waitcnt lgkmcnt(4)
    v_mfma_f32_16x16x32_bf16 v[108:111], v[228:231], v[156:159], v[108:111]
    ds_read_b64_tr_b16 v[212:213], v24 offset:16384
    v_mfma_f32_16x16x32_bf16 v[108:111], v[232:235], v[172:175], v[108:111]
    ds_read_b64_tr_b16 v[214:215], v24 offset:17408
    v_mfma_f32_16x16x32_bf16 v[100:103], v[232:235], v[164:167], v[100:103]
    ds_read_b64_tr_b16 v[216:217], v24 offset:24576
    v_mfma_f32_16x16x32_bf16 v[100:103], v[228:231], v[148:151], v[100:103]
    ds_read_b64_tr_b16 v[218:219], v24 offset:25600
    s_waitcnt lgkmcnt(4)
    v_mfma_f32_16x16x32_bf16 v[104:107], v[236:239], v[148:151], v[104:107]
    ds_read_b64_tr_b16 v[220:221], v25 offset:16384
    v_mfma_f32_16x16x32_bf16 v[104:107], v[240:243], v[164:167], v[104:107]
    ds_read_b64_tr_b16 v[222:223], v25 offset:17408
    v_mfma_f32_16x16x32_bf16 v[112:115], v[240:243], v[172:175], v[112:115]
    ds_read_b64_tr_b16 v[224:225], v25 offset:24576
    v_mfma_f32_16x16x32_bf16 v[112:115], v[236:239], v[156:159], v[112:115]
    ds_read_b64_tr_b16 v[226:227], v25 offset:25600
    s_waitcnt lgkmcnt(4)
    v_mfma_f32_16x16x32_bf16 v[124:127], v[212:215], v[156:159], v[124:127]
    ds_read_b64_tr_b16 v[228:229], v26 offset:16384
    v_mfma_f32_16x16x32_bf16 v[124:127], v[216:219], v[172:175], v[124:127]
    ds_read_b64_tr_b16 v[230:231], v26 offset:17408
    v_mfma_f32_16x16x32_bf16 v[116:119], v[216:219], v[164:167], v[116:119]
    ds_read_b64_tr_b16 v[232:233], v26 offset:24576
    v_mfma_f32_16x16x32_bf16 v[116:119], v[212:215], v[148:151], v[116:119]
    ds_read_b64_tr_b16 v[234:235], v26 offset:25600
    s_waitcnt lgkmcnt(4)
    v_mfma_f32_16x16x32_bf16 v[120:123], v[220:223], v[148:151], v[120:123]
    ds_read_b64_tr_b16 v[236:237], v27 offset:16384
    v_mfma_f32_16x16x32_bf16 v[120:123], v[224:227], v[164:167], v[120:123]
    ds_read_b64_tr_b16 v[238:239], v27 offset:17408
    v_mfma_f32_16x16x32_bf16 v[128:131], v[224:227], v[172:175], v[128:131]
    ds_read_b64_tr_b16 v[240:241], v27 offset:24576
    v_mfma_f32_16x16x32_bf16 v[128:131], v[220:223], v[156:159], v[128:131]
    ds_read_b64_tr_b16 v[242:243], v27 offset:25600
    s_waitcnt lgkmcnt(4)
    v_mfma_f32_16x16x32_bf16 v[140:143], v[228:231], v[156:159], v[140:143]
    v_mfma_f32_16x16x32_bf16 v[140:143], v[232:235], v[172:175], v[140:143]
    s_waitcnt lgkmcnt(0)
    s_barrier
    v_mfma_f32_16x16x32_bf16 v[132:135], v[232:235], v[164:167], v[132:135]
    ds_read_b128 v[212:215], v16 offset:32768
    v_mfma_f32_16x16x32_bf16 v[132:135], v[228:231], v[148:151], v[132:135]
    ds_read_b128 v[216:219], v17 offset:32768
    v_mfma_f32_16x16x32_bf16 v[136:139], v[236:239], v[148:151], v[136:139]
    ds_read_b128 v[220:223], v18 offset:32768
    v_mfma_f32_16x16x32_bf16 v[136:139], v[240:243], v[164:167], v[136:139]
    ds_read_b128 v[224:227], v19 offset:32768
    v_mfma_f32_16x16x32_bf16 v[144:147], v[240:243], v[172:175], v[144:147]
    v_mfma_f32_16x16x32_bf16 v[144:147], v[236:239], v[156:159], v[144:147]
    s_waitcnt lgkmcnt(2)
    v_mfma_f32_16x16x32_bf16 v[148:151], v[212:215], v[52:55], v[36:39]
    v_exp_f32 v180, v180
    v_mfma_f32_16x16x32_bf16 v[148:151], v[216:219], v[60:63], v[148:151]
    ds_read_b128 v[228:231], v18 offset:33792
    v_exp_f32 v181, v181
    v_exp_f32 v182, v182
    v_exp_f32 v183, v183
    v_mfma_f32_16x16x32_bf16 v[156:159], v[216:219], v[64:67], v[40:43]
    v_exp_f32 v184, v184
    v_mfma_f32_16x16x32_bf16 v[156:159], v[212:215], v[56:59], v[156:159]
    ds_read_b128 v[232:235], v19 offset:33792
    s_waitcnt lgkmcnt(2)
    v_mfma_f32_16x16x32_bf16 v[156:159], v[220:223], v[72:75], v[156:159]
    v_exp_f32 v185, v185
    v_mfma_f32_16x16x32_bf16 v[156:159], v[224:227], v[80:83], v[156:159]
    ds_read_b128 v[236:239], v16 offset:33792
    v_cvt_pk_bf16_f32 v180, v180, v181
    v_cvt_pk_bf16_f32 v181, v182, v183
    v_cvt_pk_bf16_f32 v182, v184, v185
    v_exp_f32 v186, v186
    v_exp_f32 v187, v187
    v_mfma_f32_16x16x32_bf16 v[148:151], v[224:227], v[76:79], v[148:151]
    v_exp_f32 v188, v188
    v_mfma_f32_16x16x32_bf16 v[148:151], v[220:223], v[68:71], v[148:151]
    ds_read_b128 v[240:243], v17 offset:33792
    v_cvt_pk_bf16_f32 v183, v186, v187
    v_exp_f32 v189, v189
    v_exp_f32 v190, v190
    v_exp_f32 v191, v191
    s_waitcnt lgkmcnt(2)
    v_mfma_f32_16x16x32_bf16 v[152:155], v[228:231], v[68:71], v[36:39]
    v_exp_f32 v192, v192
    v_mfma_f32_16x16x32_bf16 v[152:155], v[232:235], v[76:79], v[152:155]
    ds_read_b128 v[212:215], v16 offset:40960
    v_cvt_pk_bf16_f32 v188, v188, v189
    v_cvt_pk_bf16_f32 v189, v190, v191
    v_exp_f32 v193, v193
    v_exp_f32 v194, v194
    v_mfma_f32_16x16x32_bf16 v[160:163], v[232:235], v[80:83], v[40:43]
    v_exp_f32 v195, v195
    v_mfma_f32_16x16x32_bf16 v[160:163], v[228:231], v[72:75], v[160:163]
    ds_read_b128 v[216:219], v17 offset:40960
    s_waitcnt lgkmcnt(2)
    v_mfma_f32_16x16x32_bf16 v[160:163], v[236:239], v[56:59], v[160:163]
    v_exp_f32 v196, v196
    v_mfma_f32_16x16x32_bf16 v[160:163], v[240:243], v[64:67], v[160:163]
    ds_read_b128 v[220:223], v18 offset:40960
    v_cvt_pk_bf16_f32 v190, v192, v193
    v_cvt_pk_bf16_f32 v191, v194, v195
    v_exp_f32 v197, v197
    v_exp_f32 v198, v198
    v_exp_f32 v199, v199
    v_mfma_f32_16x16x32_bf16 v[152:155], v[240:243], v[60:63], v[152:155]
    v_exp_f32 v200, v200
    v_mfma_f32_16x16x32_bf16 v[152:155], v[236:239], v[52:55], v[152:155]
    ds_read_b128 v[224:227], v19 offset:40960
    v_cvt_pk_bf16_f32 v196, v196, v197
    v_cvt_pk_bf16_f32 v197, v198, v199
    v_exp_f32 v201, v201
    v_exp_f32 v202, v202
    s_waitcnt lgkmcnt(2)
    v_mfma_f32_16x16x32_bf16 v[164:167], v[212:215], v[52:55], v[36:39]
    v_exp_f32 v203, v203
    v_mfma_f32_16x16x32_bf16 v[164:167], v[216:219], v[60:63], v[164:167]
    ds_read_b128 v[228:231], v18 offset:41984
    v_cvt_pk_bf16_f32 v198, v200, v201
    v_cvt_pk_bf16_f32 v199, v202, v203
    v_exp_f32 v204, v204
    v_exp_f32 v205, v205
    v_exp_f32 v206, v206
    v_mfma_f32_16x16x32_bf16 v[172:175], v[216:219], v[64:67], v[40:43]
    v_exp_f32 v207, v207
    v_mfma_f32_16x16x32_bf16 v[172:175], v[212:215], v[56:59], v[172:175]
    ds_read_b128 v[232:235], v19 offset:41984
    s_waitcnt lgkmcnt(2)
    v_mfma_f32_16x16x32_bf16 v[172:175], v[220:223], v[72:75], v[172:175]
    v_exp_f32 v208, v208
    v_mfma_f32_16x16x32_bf16 v[172:175], v[224:227], v[80:83], v[172:175]
    ds_read_b128 v[236:239], v16 offset:41984
    v_cvt_pk_bf16_f32 v204, v204, v205
    v_cvt_pk_bf16_f32 v205, v206, v207
    v_exp_f32 v209, v209
    v_exp_f32 v210, v210
    v_mfma_f32_16x16x32_bf16 v[164:167], v[224:227], v[76:79], v[164:167]
    v_exp_f32 v211, v211
    v_mfma_f32_16x16x32_bf16 v[164:167], v[220:223], v[68:71], v[164:167]
    ds_read_b128 v[240:243], v17 offset:41984
    v_mfma_f32_16x16x32_bf16 v[248:251], v[32:35], v[180:183], v[44:47]
    v_cvt_pk_bf16_f32 v206, v208, v209
    v_cvt_pk_bf16_f32 v207, v210, v211
    v_mfma_f32_16x16x32_bf16 v[248:251], v[32:35], v[196:199], v[248:251]
    v_mfma_f32_16x16x32_bf16 v[252:255], v[32:35], v[188:191], v[48:51]
    v_mfma_f32_16x16x32_bf16 v[252:255], v[32:35], v[204:207], v[252:255]
    s_waitcnt lgkmcnt(2)
    v_mfma_f32_16x16x32_bf16 v[168:171], v[228:231], v[68:71], v[36:39]
    v_mfma_f32_16x16x32_bf16 v[168:171], v[232:235], v[76:79], v[168:171]
    s_waitcnt lgkmcnt(0)
    s_barrier
    ds_read_b64_tr_b16 v[212:213], v20 offset:0
    ds_read_b64_tr_b16 v[214:215], v20 offset:1024
    v_mfma_f32_16x16x32_bf16 v[176:179], v[232:235], v[80:83], v[40:43]
    ds_read_b64_tr_b16 v[216:217], v20 offset:8192
    v_mfma_f32_16x16x32_bf16 v[176:179], v[228:231], v[72:75], v[176:179]
    ds_read_b64_tr_b16 v[218:219], v20 offset:9216
    v_mfma_f32_16x16x32_bf16 v[176:179], v[236:239], v[56:59], v[176:179]
    ds_read_b64_tr_b16 v[220:221], v21 offset:0
    v_max_f32 v1, v248, v252
    v_mfma_f32_16x16x32_bf16 v[176:179], v[240:243], v[64:67], v[176:179]
    ds_read_b64_tr_b16 v[222:223], v21 offset:1024
    v_cmp_lt_f32 vcc, s36, v1
    v_mfma_f32_16x16x32_bf16 v[168:171], v[240:243], v[60:63], v[168:171]
    ds_read_b64_tr_b16 v[224:225], v21 offset:8192
    v_mfma_f32_16x16x32_bf16 v[168:171], v[236:239], v[52:55], v[168:171]
    ds_read_b64_tr_b16 v[226:227], v21 offset:9216
    s_cbranch_vccnz L_rare11
L_back11:
    s_waitcnt lgkmcnt(4)
    v_mfma_f32_16x16x32_bf16 v[92:95], v[212:215], v[188:191], v[92:95]
    ds_read_b64_tr_b16 v[228:229], v22 offset:0
    v_mfma_f32_16x16x32_bf16 v[92:95], v[216:219], v[204:207], v[92:95]
    ds_read_b64_tr_b16 v[230:231], v22 offset:1024
    v_mfma_f32_16x16x32_bf16 v[84:87], v[216:219], v[196:199], v[84:87]
    ds_read_b64_tr_b16 v[232:233], v22 offset:8192
    v_mfma_f32_16x16x32_bf16 v[84:87], v[212:215], v[180:183], v[84:87]
    ds_read_b64_tr_b16 v[234:235], v22 offset:9216
    s_waitcnt lgkmcnt(4)
    v_mfma_f32_16x16x32_bf16 v[88:91], v[220:223], v[180:183], v[88:91]
    ds_read_b64_tr_b16 v[236:237], v23 offset:0
    v_mfma_f32_16x16x32_bf16 v[88:91], v[224:227], v[196:199], v[88:91]
    ds_read_b64_tr_b16 v[238:239], v23 offset:1024
    v_mfma_f32_16x16x32_bf16 v[96:99], v[224:227], v[204:207], v[96:99]
    ds_read_b64_tr_b16 v[240:241], v23 offset:8192
    v_mfma_f32_16x16x32_bf16 v[96:99], v[220:223], v[188:191], v[96:99]
    ds_read_b64_tr_b16 v[242:243], v23 offset:9216
    s_waitcnt lgkmcnt(4)
    v_mfma_f32_16x16x32_bf16 v[108:111], v[228:231], v[188:191], v[108:111]
    ds_read_b64_tr_b16 v[212:213], v24 offset:0
    v_mfma_f32_16x16x32_bf16 v[108:111], v[232:235], v[204:207], v[108:111]
    ds_read_b64_tr_b16 v[214:215], v24 offset:1024
    v_mfma_f32_16x16x32_bf16 v[100:103], v[232:235], v[196:199], v[100:103]
    ds_read_b64_tr_b16 v[216:217], v24 offset:8192
    v_mfma_f32_16x16x32_bf16 v[100:103], v[228:231], v[180:183], v[100:103]
    ds_read_b64_tr_b16 v[218:219], v24 offset:9216
    s_waitcnt lgkmcnt(4)
    v_mfma_f32_16x16x32_bf16 v[104:107], v[236:239], v[180:183], v[104:107]
    ds_read_b64_tr_b16 v[220:221], v25 offset:0
    v_mfma_f32_16x16x32_bf16 v[104:107], v[240:243], v[196:199], v[104:107]
    ds_read_b64_tr_b16 v[222:223], v25 offset:1024
    v_mfma_f32_16x16x32_bf16 v[112:115], v[240:243], v[204:207], v[112:115]
    ds_read_b64_tr_b16 v[224:225], v25 offset:8192
    v_mfma_f32_16x16x32_bf16 v[112:115], v[236:239], v[188:191], v[112:115]
    ds_read_b64_tr_b16 v[226:227], v25 offset:9216
    s_waitcnt lgkmcnt(4)
    v_mfma_f32_16x16x32_bf16 v[124:127], v[212:215], v[188:191], v[124:127]
    ds_read_b64_tr_b16 v[228:229], v26 offset:0
    v_mfma_f32_16x16x32_bf16 v[124:127], v[216:219], v[204:207], v[124:127]
    ds_read_b64_tr_b16 v[230:231], v26 offset:1024
    v_mfma_f32_16x16x32_bf16 v[116:119], v[216:219], v[196:199], v[116:119]
    ds_read_b64_tr_b16 v[232:233], v26 offset:8192
    v_mfma_f32_16x16x32_bf16 v[116:119], v[212:215], v[180:183], v[116:119]
    ds_read_b64_tr_b16 v[234:235], v26 offset:9216
    s_waitcnt lgkmcnt(4)
    v_mfma_f32_16x16x32_bf16 v[120:123], v[220:223], v[180:183], v[120:123]
    ds_read_b64_tr_b16 v[236:237], v27 offset:0
    v_mfma_f32_16x16x32_bf16 v[120:123], v[224:227], v[196:199], v[120:123]
    ds_read_b64_tr_b16 v[238:239], v27 offset:1024
    v_mfma_f32_16x16x32_bf16 v[128:131], v[224:227], v[204:207], v[128:131]
    ds_read_b64_tr_b16 v[240:241], v27 offset:8192
    v_mfma_f32_16x16x32_bf16 v[128:131], v[220:223], v[188:191], v[128:131]
    ds_read_b64_tr_b16 v[242:243], v27 offset:9216
    s_waitcnt lgkmcnt(4)
    v_mfma_f32_16x16x32_bf16 v[140:143], v[228:231], v[188:191], v[140:143]
    v_mfma_f32_16x16x32_bf16 v[140:143], v[232:235], v[204:207], v[140:143]
    s_waitcnt lgkmcnt(0)
    s_barrier
    v_mfma_f32_16x16x32_bf16 v[132:135], v[232:235], v[196:199], v[132:135]
    ds_read_b128 v[212:215], v16 offset:49152
    v_mfma_f32_16x16x32_bf16 v[132:135], v[228:231], v[180:183], v[132:135]
    ds_read_b128 v[216:219], v17 offset:49152
    v_mfma_f32_16x16x32_bf16 v[136:139], v[236:239], v[180:183], v[136:139]
    ds_read_b128 v[220:223], v18 offset:49152
    v_mfma_f32_16x16x32_bf16 v[136:139], v[240:243], v[196:199], v[136:139]
    ds_read_b128 v[224:227], v19 offset:49152
    v_mfma_f32_16x16x32_bf16 v[144:147], v[240:243], v[204:207], v[144:147]
    v_mfma_f32_16x16x32_bf16 v[144:147], v[236:239], v[188:191], v[144:147]
    s_waitcnt lgkmcnt(2)
    v_mfma_f32_16x16x32_bf16 v[180:183], v[212:215], v[52:55], v[36:39]
    v_exp_f32 v148, v148
    v_mfma_f32_16x16x32_bf16 v[180:183], v[216:219], v[60:63], v[180:183]
    ds_read_b128 v[228:231], v18 offset:50176
    v_exp_f32 v149, v149
    v_exp_f32 v150, v150
    v_exp_f32 v151, v151
    v_mfma_f32_16x16x32_bf16 v[188:191], v[216:219], v[64:67], v[40:43]
    v_exp_f32 v152, v152
    v_mfma_f32_16x16x32_bf16 v[188:191], v[212:215], v[56:59], v[188:191]
    ds_read_b128 v[232:235], v19 offset:50176
    s_waitcnt lgkmcnt(2)
    v_mfma_f32_16x16x32_bf16 v[188:191], v[220:223], v[72:75], v[188:191]
    v_exp_f32 v153, v153
    v_mfma_f32_16x16x32_bf16 v[188:191], v[224:227], v[80:83], v[188:191]
    ds_read_b128 v[236:239], v16 offset:50176
    v_cvt_pk_bf16_f32 v148, v148, v149
    v_cvt_pk_bf16_f32 v149, v150, v151
    v_cvt_pk_bf16_f32 v150, v152, v153
    v_exp_f32 v154, v154
    v_exp_f32 v155, v155
    v_mfma_f32_16x16x32_bf16 v[180:183], v[224:227], v[76:79], v[180:183]
    v_exp_f32 v156, v156
    v_mfma_f32_16x16x32_bf16 v[180:183], v[220:223], v[68:71], v[180:183]
    ds_read_b128 v[240:243], v17 offset:50176
    v_cvt_pk_bf16_f32 v151, v154, v155
    v_exp_f32 v157, v157
    v_exp_f32 v158, v158
    v_exp_f32 v159, v159
    s_waitcnt lgkmcnt(2)
    v_mfma_f32_16x16x32_bf16 v[184:187], v[228:231], v[68:71], v[36:39]
    v_exp_f32 v160, v160
    v_mfma_f32_16x16x32_bf16 v[184:187], v[232:235], v[76:79], v[184:187]
    ds_read_b128 v[212:215], v16 offset:57344
    v_cvt_pk_bf16_f32 v156, v156, v157
    v_cvt_pk_bf16_f32 v157, v158, v159
    v_exp_f32 v161, v161
    v_exp_f32 v162, v162
    v_mfma_f32_16x16x32_bf16 v[192:195], v[232:235], v[80:83], v[40:43]
    v_exp_f32 v163, v163
    v_mfma_f32_16x16x32_bf16 v[192:195], v[228:231], v[72:75], v[192:195]
    ds_read_b128 v[216:219], v17 offset:57344
    s_waitcnt lgkmcnt(2)
    v_mfma_f32_16x16x32_bf16 v[192:195], v[236:239], v[56:59], v[192:195]
    v_exp_f32 v164, v164
    v_mfma_f32_16x16x32_bf16 v[192:195], v[240:243], v[64:67], v[192:195]
    ds_read_b128 v[220:223], v18 offset:57344
    v_cvt_pk_bf16_f32 v158, v160, v161
    v_cvt_pk_bf16_f32 v159, v162, v163
    v_exp_f32 v165, v165
    v_exp_f32 v166, v166
    v_exp_f32 v167, v167
    v_mfma_f32_16x16x32_bf16 v[184:187], v[240:243], v[60:63], v[184:187]
    v_exp_f32 v168, v168
    v_mfma_f32_16x16x32_bf16 v[184:187], v[236:239], v[52:55], v[184:187]
    ds_read_b128 v[224:227], v19 offset:57344
    v_cvt_pk_bf16_f32 v164, v164, v165
    v_cvt_pk_bf16_f32 v165, v166, v167
    v_exp_f32 v169, v169
    v_exp_f32 v170, v170
    s_waitcnt lgkmcnt(2)
    v_mfma_f32_16x16x32_bf16 v[196:199], v[212:215], v[52:55], v[36:39]
    v_exp_f32 v171, v171
    v_mfma_f32_16x16x32_bf16 v[196:199], v[216:219], v[60:63], v[196:199]
    ds_read_b128 v[228:231], v18 offset:58368
    v_cvt_pk_bf16_f32 v166, v168, v169
    v_cvt_pk_bf16_f32 v167, v170, v171
    v_exp_f32 v172, v172
    v_exp_f32 v173, v173
    v_exp_f32 v174, v174
    v_mfma_f32_16x16x32_bf16 v[204:207], v[216:219], v[64:67], v[40:43]
    v_exp_f32 v175, v175
    v_mfma_f32_16x16x32_bf16 v[204:207], v[212:215], v[56:59], v[204:207]
    ds_read_b128 v[232:235], v19 offset:58368
    s_waitcnt lgkmcnt(2)
    v_mfma_f32_16x16x32_bf16 v[204:207], v[220:223], v[72:75], v[204:207]
    v_exp_f32 v176, v176
    v_mfma_f32_16x16x32_bf16 v[204:207], v[224:227], v[80:83], v[204:207]
    ds_read_b128 v[236:239], v16 offset:58368
    v_cvt_pk_bf16_f32 v172, v172, v173
    v_cvt_pk_bf16_f32 v173, v174, v175
    v_exp_f32 v177, v177
    v_exp_f32 v178, v178
    v_mfma_f32_16x16x32_bf16 v[196:199], v[224:227], v[76:79], v[196:199]
    v_exp_f32 v179, v179
    v_mfma_f32_16x16x32_bf16 v[196:199], v[220:223], v[68:71], v[196:199]
    ds_read_b128 v[240:243], v17 offset:58368
    v_mfma_f32_16x16x32_bf16 v[44:47], v[32:35], v[148:151], v[248:251]
    v_cvt_pk_bf16_f32 v174, v176, v177
    v_cvt_pk_bf16_f32 v175, v178, v179
    v_mfma_f32_16x16x32_bf16 v[44:47], v[32:35], v[164:167], v[44:47]
    v_mfma_f32_16x16x32_bf16 v[48:51], v[32:35], v[156:159], v[252:255]
    v_mfma_f32_16x16x32_bf16 v[48:51], v[32:35], v[172:175], v[48:51]
    s_waitcnt lgkmcnt(2)
    v_mfma_f32_16x16x32_bf16 v[200:203], v[228:231], v[68:71], v[36:39]
    v_mfma_f32_16x16x32_bf16 v[200:203], v[232:235], v[76:79], v[200:203]
    s_waitcnt lgkmcnt(0)
    s_barrier
    ds_read_b64_tr_b16 v[212:213], v20 offset:32768
    ds_read_b64_tr_b16 v[214:215], v20 offset:33792
    v_mfma_f32_16x16x32_bf16 v[208:211], v[232:235], v[80:83], v[40:43]
    ds_read_b64_tr_b16 v[216:217], v20 offset:40960
    v_mfma_f32_16x16x32_bf16 v[208:211], v[228:231], v[72:75], v[208:211]
    ds_read_b64_tr_b16 v[218:219], v20 offset:41984
    v_mfma_f32_16x16x32_bf16 v[208:211], v[236:239], v[56:59], v[208:211]
    ds_read_b64_tr_b16 v[220:221], v21 offset:32768
    v_max_f32 v1, v44, v48
    v_mfma_f32_16x16x32_bf16 v[208:211], v[240:243], v[64:67], v[208:211]
    ds_read_b64_tr_b16 v[222:223], v21 offset:33792
    v_cmp_lt_f32 vcc, s36, v1
    v_mfma_f32_16x16x32_bf16 v[200:203], v[240:243], v[60:63], v[200:203]
    ds_read_b64_tr_b16 v[224:225], v21 offset:40960
    v_mfma_f32_16x16x32_bf16 v[200:203], v[236:239], v[52:55], v[200:203]
    ds_read_b64_tr_b16 v[226:227], v21 offset:41984
    s_cbranch_vccnz L_rare12
L_back12:
    s_waitcnt lgkmcnt(4)
    v_mfma_f32_16x16x32_bf16 v[92:95], v[212:215], v[156:159], v[92:95]
    ds_read_b64_tr_b16 v[228:229], v22 offset:32768
    v_mfma_f32_16x16x32_bf16 v[92:95], v[216:219], v[172:175], v[92:95]
    ds_read_b64_tr_b16 v[230:231], v22 offset:33792
    v_mfma_f32_16x16x32_bf16 v[84:87], v[216:219], v[164:167], v[84:87]
    ds_read_b64_tr_b16 v[232:233], v22 offset:40960
    v_mfma_f32_16x16x32_bf16 v[84:87], v[212:215], v[148:151], v[84:87]
    ds_read_b64_tr_b16 v[234:235], v22 offset:41984
    s_waitcnt lgkmcnt(4)
    v_mfma_f32_16x16x32_bf16 v[88:91], v[220:223], v[148:151], v[88:91]
    ds_read_b64_tr_b16 v[236:237], v23 offset:32768
    v_mfma_f32_16x16x32_bf16 v[88:91], v[224:227], v[164:167], v[88:91]
    ds_read_b64_tr_b16 v[238:239], v23 offset:33792
    v_mfma_f32_16x16x32_bf16 v[96:99], v[224:227], v[172:175], v[96:99]
    ds_read_b64_tr_b16 v[240:241], v23 offset:40960
    v_mfma_f32_16x16x32_bf16 v[96:99], v[220:223], v[156:159], v[96:99]
    ds_read_b64_tr_b16 v[242:243], v23 offset:41984
    s_waitcnt lgkmcnt(4)
    v_mfma_f32_16x16x32_bf16 v[108:111], v[228:231], v[156:159], v[108:111]
    ds_read_b64_tr_b16 v[212:213], v24 offset:32768
    v_mfma_f32_16x16x32_bf16 v[108:111], v[232:235], v[172:175], v[108:111]
    ds_read_b64_tr_b16 v[214:215], v24 offset:33792
    v_mfma_f32_16x16x32_bf16 v[100:103], v[232:235], v[164:167], v[100:103]
    ds_read_b64_tr_b16 v[216:217], v24 offset:40960
    v_mfma_f32_16x16x32_bf16 v[100:103], v[228:231], v[148:151], v[100:103]
    ds_read_b64_tr_b16 v[218:219], v24 offset:41984
    s_waitcnt lgkmcnt(4)
    v_mfma_f32_16x16x32_bf16 v[104:107], v[236:239], v[148:151], v[104:107]
    ds_read_b64_tr_b16 v[220:221], v25 offset:32768
    v_mfma_f32_16x16x32_bf16 v[104:107], v[240:243], v[164:167], v[104:107]
    ds_read_b64_tr_b16 v[222:223], v25 offset:33792
    v_mfma_f32_16x16x32_bf16 v[112:115], v[240:243], v[172:175], v[112:115]
    ds_read_b64_tr_b16 v[224:225], v25 offset:40960
    v_mfma_f32_16x16x32_bf16 v[112:115], v[236:239], v[156:159], v[112:115]
    ds_read_b64_tr_b16 v[226:227], v25 offset:41984
    s_waitcnt lgkmcnt(4)
    v_mfma_f32_16x16x32_bf16 v[124:127], v[212:215], v[156:159], v[124:127]
    ds_read_b64_tr_b16 v[228:229], v26 offset:32768
    v_mfma_f32_16x16x32_bf16 v[124:127], v[216:219], v[172:175], v[124:127]
    ds_read_b64_tr_b16 v[230:231], v26 offset:33792
    v_mfma_f32_16x16x32_bf16 v[116:119], v[216:219], v[164:167], v[116:119]
    ds_read_b64_tr_b16 v[232:233], v26 offset:40960
    v_mfma_f32_16x16x32_bf16 v[116:119], v[212:215], v[148:151], v[116:119]
    ds_read_b64_tr_b16 v[234:235], v26 offset:41984
    s_waitcnt lgkmcnt(4)
    v_mfma_f32_16x16x32_bf16 v[120:123], v[220:223], v[148:151], v[120:123]
    ds_read_b64_tr_b16 v[236:237], v27 offset:32768
    v_mfma_f32_16x16x32_bf16 v[120:123], v[224:227], v[164:167], v[120:123]
    ds_read_b64_tr_b16 v[238:239], v27 offset:33792
    v_mfma_f32_16x16x32_bf16 v[128:131], v[224:227], v[172:175], v[128:131]
    ds_read_b64_tr_b16 v[240:241], v27 offset:40960
    v_mfma_f32_16x16x32_bf16 v[128:131], v[220:223], v[156:159], v[128:131]
    ds_read_b64_tr_b16 v[242:243], v27 offset:41984
    s_waitcnt lgkmcnt(4)
    v_mfma_f32_16x16x32_bf16 v[140:143], v[228:231], v[156:159], v[140:143]
    v_mfma_f32_16x16x32_bf16 v[140:143], v[232:235], v[172:175], v[140:143]
    s_waitcnt lgkmcnt(0)
    s_barrier
    v_mfma_f32_16x16x32_bf16 v[132:135], v[232:235], v[164:167], v[132:135]
    ds_read_b128 v[212:215], v16 offset:32768
    v_mfma_f32_16x16x32_bf16 v[132:135], v[228:231], v[148:151], v[132:135]
    ds_read_b128 v[216:219], v17 offset:32768
    v_mfma_f32_16x16x32_bf16 v[136:139], v[236:239], v[148:151], v[136:139]
    ds_read_b128 v[220:223], v18 offset:32768
    v_mfma_f32_16x16x32_bf16 v[136:139], v[240:243], v[164:167], v[136:139]
    ds_read_b128 v[224:227], v19 offset:32768
    v_mfma_f32_16x16x32_bf16 v[144:147], v[240:243], v[172:175], v[144:147]
    v_mfma_f32_16x16x32_bf16 v[144:147], v[236:239], v[156:159], v[144:147]
    s_waitcnt lgkmcnt(2)
    v_mfma_f32_16x16x32_bf16 v[148:151], v[212:215], v[52:55], v[36:39]
    v_exp_f32 v180, v180
    v_mfma_f32_16x16x32_bf16 v[148:151], v[216:219], v[60:63], v[148:151]
    ds_read_b128 v[228:231], v18 offset:33792
    v_exp_f32 v181, v181
    v_exp_f32 v182, v182
    v_exp_f32 v183, v183
    v_mfma_f32_16x16x32_bf16 v[156:159], v[216:219], v[64:67], v[40:43]
    v_exp_f32 v184, v184
    v_mfma_f32_16x16x32_bf16 v[156:159], v[212:215], v[56:59], v[156:159]
    ds_read_b128 v[232:235], v19 offset:33792
    s_waitcnt lgkmcnt(2)
    v_mfma_f32_16x16x32_bf16 v[156:159], v[220:223], v[72:75], v[156:159]
    v_exp_f32 v185, v185
    v_mfma_f32_16x16x32_bf16 v[156:159], v[224:227], v[80:83], v[156:159]
    ds_read_b128 v[236:239], v16 offset:33792
    v_cvt_pk_bf16_f32 v180, v180, v181
    v_cvt_pk_bf16_f32 v181, v182, v183
    v_cvt_pk_bf16_f32 v182, v184, v185
    v_exp_f32 v186, v186
    v_exp_f32 v187, v187
    v_mfma_f32_16x16x32_bf16 v[148:151], v[224:227], v[76:79], v[148:151]
    v_exp_f32 v188, v188
    v_mfma_f32_16x16x32_bf16 v[148:151], v[220:223], v[68:71], v[148:151]
    ds_read_b128 v[240:243], v17 offset:33792
    v_cvt_pk_bf16_f32 v183, v186, v187
    v_exp_f32 v189, v189
    v_exp_f32 v190, v190
    v_exp_f32 v191, v191
    s_waitcnt lgkmcnt(2)
    v_mfma_f32_16x16x32_bf16 v[152:155], v[228:231], v[68:71], v[36:39]
    v_exp_f32 v192, v192
    v_mfma_f32_16x16x32_bf16 v[152:155], v[232:235], v[76:79], v[152:155]
    ds_read_b128 v[212:215], v16 offset:40960
    v_cvt_pk_bf16_f32 v188, v188, v189
    v_cvt_pk_bf16_f32 v189, v190, v191
    v_exp_f32 v193, v193
    v_exp_f32 v194, v194
    v_mfma_f32_16x16x32_bf16 v[160:163], v[232:235], v[80:83], v[40:43]
    v_exp_f32 v195, v195
    v_mfma_f32_16x16x32_bf16 v[160:163], v[228:231], v[72:75], v[160:163]
    ds_read_b128 v[216:219], v17 offset:40960
    s_waitcnt lgkmcnt(2)
    v_mfma_f32_16x16x32_bf16 v[160:163], v[236:239], v[56:59], v[160:163]
    v_exp_f32 v196, v196
    v_mfma_f32_16x16x32_bf16 v[160:163], v[240:243], v[64:67], v[160:163]
    ds_read_b128 v[220:223], v18 offset:40960
    v_cvt_pk_bf16_f32 v190, v192, v193
    v_cvt_pk_bf16_f32 v191, v194, v195
    v_exp_f32 v197, v197
    v_exp_f32 v198, v198
    v_exp_f32 v199, v199
    v_mfma_f32_16x16x32_bf16 v[152:155], v[240:243], v[60:63], v[152:155]
    v_exp_f32 v200, v200
    v_mfma_f32_16x16x32_bf16 v[152:155], v[236:239], v[52:55], v[152:155]
    ds_read_b128 v[224:227], v19 offset:40960
    v_cvt_pk_bf16_f32 v196, v196, v197
    v_cvt_pk_bf16_f32 v197, v198, v199
    v_exp_f32 v201, v201
    v_exp_f32 v202, v202
    s_waitcnt lgkmcnt(2)
    v_mfma_f32_16x16x32_bf16 v[164:167], v[212:215], v[52:55], v[36:39]
    v_exp_f32 v203, v203
    v_mfma_f32_16x16x32_bf16 v[164:167], v[216:219], v[60:63], v[164:167]
    ds_read_b128 v[228:231], v18 offset:41984
    v_cvt_pk_bf16_f32 v198, v200, v201
    v_cvt_pk_bf16_f32 v199, v202, v203
    v_exp_f32 v204, v204
    v_exp_f32 v205, v205
    v_exp_f32 v206, v206
    v_mfma_f32_16x16x32_bf16 v[172:175], v[216:219], v[64:67], v[40:43]
    v_exp_f32 v207, v207
    v_mfma_f32_16x16x32_bf16 v[172:175], v[212:215], v[56:59], v[172:175]
    ds_read_b128 v[232:235], v19 offset:41984
    s_waitcnt lgkmcnt(2)
    v_mfma_f32_16x16x32_bf16 v[172:175], v[220:223], v[72:75], v[172:175]
    v_exp_f32 v208, v208
    v_mfma_f32_16x16x32_bf16 v[172:175], v[224:227], v[80:83], v[172:175]
    ds_read_b128 v[236:239], v16 offset:41984
    v_cvt_pk_bf16_f32 v204, v204, v205
    v_cvt_pk_bf16_f32 v205, v206, v207
    v_exp_f32 v209, v209
    v_exp_f32 v210, v210
    v_mfma_f32_16x16x32_bf16 v[164:167], v[224:227], v[76:79], v[164:167]
    v_exp_f32 v211, v211
    v_mfma_f32_16x16x32_bf16 v[164:167], v[220:223], v[68:71], v[164:167]
    ds_read_b128 v[240:243], v17 offset:41984
    v_mfma_f32_16x16x32_bf16 v[248:251], v[32:35], v[180:183], v[44:47]
    v_cvt_pk_bf16_f32 v206, v208, v209
    v_cvt_pk_bf16_f32 v207, v210, v211
    v_mfma_f32_16x16x32_bf16 v[248:251], v[32:35], v[196:199], v[248:251]
    v_mfma_f32_16x16x32_bf16 v[252:255], v[32:35], v[188:191], v[48:51]
    v_mfma_f32_16x16x32_bf16 v[252:255], v[32:35], v[204:207], v[252:255]
    s_waitcnt lgkmcnt(2)
    v_mfma_f32_16x16x32_bf16 v[168:171], v[228:231], v[68:71], v[36:39]
    v_mfma_f32_16x16x32_bf16 v[168:171], v[232:235], v[76:79], v[168:171]
    s_waitcnt lgkmcnt(0)
    s_barrier
    ds_read_b64_tr_b16 v[212:213], v20 offset:16384
    ds_read_b64_tr_b16 v[214:215], v20 offset:17408
    v_mfma_f32_16x16x32_bf16 v[176:179], v[232:235], v[80:83], v[40:43]
    ds_read_b64_tr_b16 v[216:217], v20 offset:24576
    v_mfma_f32_16x16x32_bf16 v[176:179], v[228:231], v[72:75], v[176:179]
    ds_read_b64_tr_b16 v[218:219], v20 offset:25600
    v_mfma_f32_16x16x32_bf16 v[176:179], v[236:239], v[56:59], v[176:179]
    ds_read_b64_tr_b16 v[220:221], v21 offset:16384
    v_max_f32 v1, v248, v252
    v_mfma_f32_16x16x32_bf16 v[176:179], v[240:243], v[64:67], v[176:179]
    ds_read_b64_tr_b16 v[222:223], v21 offset:17408
    v_cmp_lt_f32 vcc, s36, v1
    v_mfma_f32_16x16x32_bf16 v[168:171], v[240:243], v[60:63], v[168:171]
    ds_read_b64_tr_b16 v[224:225], v21 offset:24576
    v_mfma_f32_16x16x32_bf16 v[168:171], v[236:239], v[52:55], v[168:171]
    ds_read_b64_tr_b16 v[226:227], v21 offset:25600
    s_cbranch_vccnz L_rare13
L_back13:
    s_waitcnt lgkmcnt(4)
    v_mfma_f32_16x16x32_bf16 v[92:95], v[212:215], v[188:191], v[92:95]
    ds_read_b64_tr_b16 v[228:229], v22 offset:16384
    v_mfma_f32_16x16x32_bf16 v[92:95], v[216:219], v[204:207], v[92:95]
    ds_read_b64_tr_b16 v[230:231], v22 offset:17408
    v_mfma_f32_16x16x32_bf16 v[84:87], v[216:219], v[196:199], v[84:87]
    ds_read_b64_tr_b16 v[232:233], v22 offset:24576
    v_mfma_f32_16x16x32_bf16 v[84:87], v[212:215], v[180:183], v[84:87]
    ds_read_b64_tr_b16 v[234:235], v22 offset:25600
    s_waitcnt lgkmcnt(4)
    v_mfma_f32_16x16x32_bf16 v[88:91], v[220:223], v[180:183], v[88:91]
    ds_read_b64_tr_b16 v[236:237], v23 offset:16384
    v_mfma_f32_16x16x32_bf16 v[88:91], v[224:227], v[196:199], v[88:91]
    ds_read_b64_tr_b16 v[238:239], v23 offset:17408
    v_mfma_f32_16x16x32_bf16 v[96:99], v[224:227], v[204:207], v[96:99]
    ds_read_b64_tr_b16 v[240:241], v23 offset:24576
    v_mfma_f32_16x16x32_bf16 v[96:99], v[220:223], v[188:191], v[96:99]
    ds_read_b64_tr_b16 v[242:243], v23 offset:25600
    s_waitcnt lgkmcnt(4)
    v_mfma_f32_16x16x32_bf16 v[108:111], v[228:231], v[188:191], v[108:111]
    ds_read_b64_tr_b16 v[212:213], v24 offset:16384
    v_mfma_f32_16x16x32_bf16 v[108:111], v[232:235], v[204:207], v[108:111]
    ds_read_b64_tr_b16 v[214:215], v24 offset:17408
    v_mfma_f32_16x16x32_bf16 v[100:103], v[232:235], v[196:199], v[100:103]
    ds_read_b64_tr_b16 v[216:217], v24 offset:24576
    v_mfma_f32_16x16x32_bf16 v[100:103], v[228:231], v[180:183], v[100:103]
    ds_read_b64_tr_b16 v[218:219], v24 offset:25600
    s_waitcnt lgkmcnt(4)
    v_mfma_f32_16x16x32_bf16 v[104:107], v[236:239], v[180:183], v[104:107]
    ds_read_b64_tr_b16 v[220:221], v25 offset:16384
    v_mfma_f32_16x16x32_bf16 v[104:107], v[240:243], v[196:199], v[104:107]
    ds_read_b64_tr_b16 v[222:223], v25 offset:17408
    v_mfma_f32_16x16x32_bf16 v[112:115], v[240:243], v[204:207], v[112:115]
    ds_read_b64_tr_b16 v[224:225], v25 offset:24576
    v_mfma_f32_16x16x32_bf16 v[112:115], v[236:239], v[188:191], v[112:115]
    ds_read_b64_tr_b16 v[226:227], v25 offset:25600
    s_waitcnt lgkmcnt(4)
    v_mfma_f32_16x16x32_bf16 v[124:127], v[212:215], v[188:191], v[124:127]
    ds_read_b64_tr_b16 v[228:229], v26 offset:16384
    v_mfma_f32_16x16x32_bf16 v[124:127], v[216:219], v[204:207], v[124:127]
    ds_read_b64_tr_b16 v[230:231], v26 offset:17408
    v_mfma_f32_16x16x32_bf16 v[116:119], v[216:219], v[196:199], v[116:119]
    ds_read_b64_tr_b16 v[232:233], v26 offset:24576
    v_mfma_f32_16x16x32_bf16 v[116:119], v[212:215], v[180:183], v[116:119]
    ds_read_b64_tr_b16 v[234:235], v26 offset:25600
    s_waitcnt lgkmcnt(4)
    v_mfma_f32_16x16x32_bf16 v[120:123], v[220:223], v[180:183], v[120:123]
    ds_read_b64_tr_b16 v[236:237], v27 offset:16384
    v_mfma_f32_16x16x32_bf16 v[120:123], v[224:227], v[196:199], v[120:123]
    ds_read_b64_tr_b16 v[238:239], v27 offset:17408
    v_mfma_f32_16x16x32_bf16 v[128:131], v[224:227], v[204:207], v[128:131]
    ds_read_b64_tr_b16 v[240:241], v27 offset:24576
    v_mfma_f32_16x16x32_bf16 v[128:131], v[220:223], v[188:191], v[128:131]
    ds_read_b64_tr_b16 v[242:243], v27 offset:25600
    s_waitcnt lgkmcnt(4)
    v_mfma_f32_16x16x32_bf16 v[140:143], v[228:231], v[188:191], v[140:143]
    v_mfma_f32_16x16x32_bf16 v[140:143], v[232:235], v[204:207], v[140:143]
    s_waitcnt lgkmcnt(0)
    s_barrier
    v_mfma_f32_16x16x32_bf16 v[132:135], v[232:235], v[196:199], v[132:135]
    ds_read_b128 v[212:215], v16 offset:49152
    v_mfma_f32_16x16x32_bf16 v[132:135], v[228:231], v[180:183], v[132:135]
    ds_read_b128 v[216:219], v17 offset:49152
    v_mfma_f32_16x16x32_bf16 v[136:139], v[236:239], v[180:183], v[136:139]
    ds_read_b128 v[220:223], v18 offset:49152
    v_mfma_f32_16x16x32_bf16 v[136:139], v[240:243], v[196:199], v[136:139]
    ds_read_b128 v[224:227], v19 offset:49152
    v_mfma_f32_16x16x32_bf16 v[144:147], v[240:243], v[204:207], v[144:147]
    v_mfma_f32_16x16x32_bf16 v[144:147], v[236:239], v[188:191], v[144:147]
    s_waitcnt lgkmcnt(2)
    v_mfma_f32_16x16x32_bf16 v[180:183], v[212:215], v[52:55], v[36:39]
    v_exp_f32 v148, v148
    v_mfma_f32_16x16x32_bf16 v[180:183], v[216:219], v[60:63], v[180:183]
    ds_read_b128 v[228:231], v18 offset:50176
    v_exp_f32 v149, v149
    v_exp_f32 v150, v150
    v_exp_f32 v151, v151
    v_mfma_f32_16x16x32_bf16 v[188:191], v[216:219], v[64:67], v[40:43]
    v_exp_f32 v152, v152
    v_mfma_f32_16x16x32_bf16 v[188:191], v[212:215], v[56:59], v[188:191]
    ds_read_b128 v[232:235], v19 offset:50176
    s_waitcnt lgkmcnt(2)
    v_mfma_f32_16x16x32_bf16 v[188:191], v[220:223], v[72:75], v[188:191]
    v_exp_f32 v153, v153
    v_mfma_f32_16x16x32_bf16 v[188:191], v[224:227], v[80:83], v[188:191]
    ds_read_b128 v[236:239], v16 offset:50176
    v_cvt_pk_bf16_f32 v148, v148, v149
    v_cvt_pk_bf16_f32 v149, v150, v151
    v_cvt_pk_bf16_f32 v150, v152, v153
    v_exp_f32 v154, v154
    v_exp_f32 v155, v155
    v_mfma_f32_16x16x32_bf16 v[180:183], v[224:227], v[76:79], v[180:183]
    v_exp_f32 v156, v156
    v_mfma_f32_16x16x32_bf16 v[180:183], v[220:223], v[68:71], v[180:183]
    ds_read_b128 v[240:243], v17 offset:50176
    v_cvt_pk_bf16_f32 v151, v154, v155
    v_exp_f32 v157, v157
    v_exp_f32 v158, v158
    v_exp_f32 v159, v159
    s_waitcnt lgkmcnt(2)
    v_mfma_f32_16x16x32_bf16 v[184:187], v[228:231], v[68:71], v[36:39]
    v_exp_f32 v160, v160
    v_mfma_f32_16x16x32_bf16 v[184:187], v[232:235], v[76:79], v[184:187]
    ds_read_b128 v[212:215], v16 offset:57344
    v_cvt_pk_bf16_f32 v156, v156, v157
    v_cvt_pk_bf16_f32 v157, v158, v159
    v_exp_f32 v161, v161
    v_exp_f32 v162, v162
    v_mfma_f32_16x16x32_bf16 v[192:195], v[232:235], v[80:83], v[40:43]
    v_exp_f32 v163, v163
    v_mfma_f32_16x16x32_bf16 v[192:195], v[228:231], v[72:75], v[192:195]
    ds_read_b128 v[216:219], v17 offset:57344
    s_waitcnt lgkmcnt(2)
    v_mfma_f32_16x16x32_bf16 v[192:195], v[236:239], v[56:59], v[192:195]
    v_exp_f32 v164, v164
    v_mfma_f32_16x16x32_bf16 v[192:195], v[240:243], v[64:67], v[192:195]
    ds_read_b128 v[220:223], v18 offset:57344
    v_cvt_pk_bf16_f32 v158, v160, v161
    v_cvt_pk_bf16_f32 v159, v162, v163
    v_exp_f32 v165, v165
    v_exp_f32 v166, v166
    v_exp_f32 v167, v167
    v_mfma_f32_16x16x32_bf16 v[184:187], v[240:243], v[60:63], v[184:187]
    v_exp_f32 v168, v168
    v_mfma_f32_16x16x32_bf16 v[184:187], v[236:239], v[52:55], v[184:187]
    ds_read_b128 v[224:227], v19 offset:57344
    v_cvt_pk_bf16_f32 v164, v164, v165
    v_cvt_pk_bf16_f32 v165, v166, v167
    v_exp_f32 v169, v169
    v_exp_f32 v170, v170
    s_waitcnt lgkmcnt(2)
    v_mfma_f32_16x16x32_bf16 v[196:199], v[212:215], v[52:55], v[36:39]
    v_exp_f32 v171, v171
    v_mfma_f32_16x16x32_bf16 v[196:199], v[216:219], v[60:63], v[196:199]
    ds_read_b128 v[228:231], v18 offset:58368
    v_cvt_pk_bf16_f32 v166, v168, v169
    v_cvt_pk_bf16_f32 v167, v170, v171
    v_exp_f32 v172, v172
    v_exp_f32 v173, v173
    v_exp_f32 v174, v174
    v_mfma_f32_16x16x32_bf16 v[204:207], v[216:219], v[64:67], v[40:43]
    v_exp_f32 v175, v175
    v_mfma_f32_16x16x32_bf16 v[204:207], v[212:215], v[56:59], v[204:207]
    ds_read_b128 v[232:235], v19 offset:58368
    s_waitcnt lgkmcnt(2)
    v_mfma_f32_16x16x32_bf16 v[204:207], v[220:223], v[72:75], v[204:207]
    v_exp_f32 v176, v176
    v_mfma_f32_16x16x32_bf16 v[204:207], v[224:227], v[80:83], v[204:207]
    ds_read_b128 v[236:239], v16 offset:58368
    v_cvt_pk_bf16_f32 v172, v172, v173
    v_cvt_pk_bf16_f32 v173, v174, v175
    v_exp_f32 v177, v177
    v_exp_f32 v178, v178
    v_mfma_f32_16x16x32_bf16 v[196:199], v[224:227], v[76:79], v[196:199]
    v_exp_f32 v179, v179
    v_mfma_f32_16x16x32_bf16 v[196:199], v[220:223], v[68:71], v[196:199]
    ds_read_b128 v[240:243], v17 offset:58368
    v_mfma_f32_16x16x32_bf16 v[44:47], v[32:35], v[148:151], v[248:251]
    v_cvt_pk_bf16_f32 v174, v176, v177
    v_cvt_pk_bf16_f32 v175, v178, v179
    v_mfma_f32_16x16x32_bf16 v[44:47], v[32:35], v[164:167], v[44:47]
    v_mfma_f32_16x16x32_bf16 v[48:51], v[32:35], v[156:159], v[252:255]
    v_mfma_f32_16x16x32_bf16 v[48:51], v[32:35], v[172:175], v[48:51]
    s_waitcnt lgkmcnt(2)
    v_mfma_f32_16x16x32_bf16 v[200:203], v[228:231], v[68:71], v[36:39]
    v_mfma_f32_16x16x32_bf16 v[200:203], v[232:235], v[76:79], v[200:203]
    s_waitcnt lgkmcnt(0)
    s_barrier
    ds_read_b64_tr_b16 v[212:213], v20 offset:0
    ds_read_b64_tr_b16 v[214:215], v20 offset:1024
    v_mfma_f32_16x16x32_bf16 v[208:211], v[232:235], v[80:83], v[40:43]
    ds_read_b64_tr_b16 v[216:217], v20 offset:8192
    v_mfma_f32_16x16x32_bf16 v[208:211], v[228:231], v[72:75], v[208:211]
    ds_read_b64_tr_b16 v[218:219], v20 offset:9216
    v_mfma_f32_16x16x32_bf16 v[208:211], v[236:239], v[56:59], v[208:211]
    ds_read_b64_tr_b16 v[220:221], v21 offset:0
    v_max_f32 v1, v44, v48
    v_mfma_f32_16x16x32_bf16 v[208:211], v[240:243], v[64:67], v[208:211]
    ds_read_b64_tr_b16 v[222:223], v21 offset:1024
    v_cmp_lt_f32 vcc, s36, v1
    v_mfma_f32_16x16x32_bf16 v[200:203], v[240:243], v[60:63], v[200:203]
    ds_read_b64_tr_b16 v[224:225], v21 offset:8192
    v_mfma_f32_16x16x32_bf16 v[200:203], v[236:239], v[52:55], v[200:203]
    ds_read_b64_tr_b16 v[226:227], v21 offset:9216
    s_cbranch_vccnz L_rare14
L_back14:
    s_waitcnt lgkmcnt(4)
    v_mfma_f32_16x16x32_bf16 v[92:95], v[212:215], v[156:159], v[92:95]
    ds_read_b64_tr_b16 v[228:229], v22 offset:0
    v_mfma_f32_16x16x32_bf16 v[92:95], v[216:219], v[172:175], v[92:95]
    ds_read_b64_tr_b16 v[230:231], v22 offset:1024
    v_exp_f32 v180, v180
    v_mfma_f32_16x16x32_bf16 v[84:87], v[216:219], v[164:167], v[84:87]
    ds_read_b64_tr_b16 v[232:233], v22 offset:8192
    v_exp_f32 v181, v181
    v_mfma_f32_16x16x32_bf16 v[84:87], v[212:215], v[148:151], v[84:87]
    ds_read_b64_tr_b16 v[234:235], v22 offset:9216
    v_exp_f32 v182, v182
    s_waitcnt lgkmcnt(4)
    v_mfma_f32_16x16x32_bf16 v[88:91], v[220:223], v[148:151], v[88:91]
    ds_read_b64_tr_b16 v[236:237], v23 offset:0
    v_exp_f32 v183, v183
    v_mfma_f32_16x16x32_bf16 v[88:91], v[224:227], v[164:167], v[88:91]
    ds_read_b64_tr_b16 v[238:239], v23 offset:1024
    v_exp_f32 v184, v184
    v_mfma_f32_16x16x32_bf16 v[96:99], v[224:227], v[172:175], v[96:99]
    ds_read_b64_tr_b16 v[240:241], v23 offset:8192
    v_exp_f32 v185, v185
    v_mfma_f32_16x16x32_bf16 v[96:99], v[220:223], v[156:159], v[96:99]
    ds_read_b64_tr_b16 v[242:243], v23 offset:9216
    v_exp_f32 v186, v186
    s_waitcnt lgkmcnt(4)
    v_mfma_f32_16x16x32_bf16 v[108:111], v[228:231], v[156:159], v[108:111]
    ds_read_b64_tr_b16 v[212:213], v24 offset:0
    v_exp_f32 v187, v187
    v_mfma_f32_16x16x32_bf16 v[108:111], v[232:235], v[172:175], v[108:111]
    ds_read_b64_tr_b16 v[214:215], v24 offset:1024
    v_exp_f32 v188, v188
    v_mfma_f32_16x16x32_bf16 v[100:103], v[232:235], v[164:167], v[100:103]
    ds_read_b64_tr_b16 v[216:217], v24 offset:8192
    v_exp_f32 v189, v189
    v_mfma_f32_16x16x32_bf16 v[100:103], v[228:231], v[148:151], v[100:103]
    ds_read_b64_tr_b16 v[218:219], v24 offset:9216
    v_exp_f32 v190, v190
    s_waitcnt lgkmcnt(4)
    v_mfma_f32_16x16x32_bf16 v[104:107], v[236:239], v[148:151], v[104:107]
    ds_read_b64_tr_b16 v[220:221], v25 offset:0
    v_exp_f32 v191, v191
    v_mfma_f32_16x16x32_bf16 v[104:107], v[240:243], v[164:167], v[104:107]
    ds_read_b64_tr_b16 v[222:223], v25 offset:1024
    v_exp_f32 v192, v192
    v_mfma_f32_16x16x32_bf16 v[112:115], v[240:243], v[172:175], v[112:115]
    ds_read_b64_tr_b16 v[224:225], v25 offset:8192
    v_exp_f32 v193, v193
    v_mfma_f32_16x16x32_bf16 v[112:115], v[236:239], v[156:159], v[112:115]
    ds_read_b64_tr_b16 v[226:227], v25 offset:9216
    v_exp_f32 v194, v194
    s_waitcnt lgkmcnt(4)
    v_mfma_f32_16x16x32_bf16 v[124:127], v[212:215], v[156:159], v[124:127]
    ds_read_b64_tr_b16 v[228:229], v26 offset:0
    v_exp_f32 v195, v195
    v_mfma_f32_16x16x32_bf16 v[124:127], v[216:219], v[172:175], v[124:127]
    ds_read_b64_tr_b16 v[230:231], v26 offset:1024
    v_exp_f32 v196, v196
    v_mfma_f32_16x16x32_bf16 v[116:119], v[216:219], v[164:167], v[116:119]
    ds_read_b64_tr_b16 v[232:233], v26 offset:8192
    v_exp_f32 v197, v197
    v_mfma_f32_16x16x32_bf16 v[116:119], v[212:215], v[148:151], v[116:119]
    ds_read_b64_tr_b16 v[234:235], v26 offset:9216
    v_exp_f32 v198, v198
    s_waitcnt lgkmcnt(4)
    v_mfma_f32_16x16x32_bf16 v[120:123], v[220:223], v[148:151], v[120:123]
    ds_read_b64_tr_b16 v[236:237], v27 offset:0
    v_exp_f32 v199, v199
    v_mfma_f32_16x16x32_bf16 v[120:123], v[224:227], v[164:167], v[120:123]
    ds_read_b64_tr_b16 v[238:239], v27 offset:1024
    v_exp_f32 v200, v200
    v_mfma_f32_16x16x32_bf16 v[128:131], v[224:227], v[172:175], v[128:131]
    ds_read_b64_tr_b16 v[240:241], v27 offset:8192
    v_exp_f32 v201, v201
    v_mfma_f32_16x16x32_bf16 v[128:131], v[220:223], v[156:159], v[128:131]
    ds_read_b64_tr_b16 v[242:243], v27 offset:9216
    v_exp_f32 v202, v202
    s_waitcnt lgkmcnt(4)
    v_mfma_f32_16x16x32_bf16 v[140:143], v[228:231], v[156:159], v[140:143]
    v_exp_f32 v203, v203
    v_mfma_f32_16x16x32_bf16 v[140:143], v[232:235], v[172:175], v[140:143]
    v_exp_f32 v204, v204
    v_mfma_f32_16x16x32_bf16 v[132:135], v[232:235], v[164:167], v[132:135]
    v_exp_f32 v205, v205
    v_mfma_f32_16x16x32_bf16 v[132:135], v[228:231], v[148:151], v[132:135]
    v_exp_f32 v206, v206
    s_waitcnt lgkmcnt(0)
    v_mfma_f32_16x16x32_bf16 v[136:139], v[236:239], v[148:151], v[136:139]
    v_exp_f32 v207, v207
    v_mfma_f32_16x16x32_bf16 v[136:139], v[240:243], v[164:167], v[136:139]
    v_exp_f32 v208, v208
    v_mfma_f32_16x16x32_bf16 v[144:147], v[240:243], v[172:175], v[144:147]
    v_exp_f32 v209, v209
    v_mfma_f32_16x16x32_bf16 v[144:147], v[236:239], v[156:159], v[144:147]
    v_exp_f32 v210, v210
    v_exp_f32 v211, v211
    v_cvt_pk_bf16_f32 v148, v180, v181
    v_cvt_pk_bf16_f32 v149, v182, v183
    v_cvt_pk_bf16_f32 v150, v184, v185
    v_cvt_pk_bf16_f32 v151, v186, v187
    v_cvt_pk_bf16_f32 v156, v188, v189
    v_cvt_pk_bf16_f32 v157, v190, v191
    v_cvt_pk_bf16_f32 v158, v192, v193
    v_cvt_pk_bf16_f32 v159, v194, v195
    v_cvt_pk_bf16_f32 v164, v196, v197
    v_cvt_pk_bf16_f32 v165, v198, v199
    v_cvt_pk_bf16_f32 v166, v200, v201
    v_cvt_pk_bf16_f32 v167, v202, v203
    v_cvt_pk_bf16_f32 v172, v204, v205
    v_cvt_pk_bf16_f32 v173, v206, v207
    v_cvt_pk_bf16_f32 v174, v208, v209
    v_cvt_pk_bf16_f32 v175, v210, v211
    v_mfma_f32_16x16x32_bf16 v[248:251], v[32:35], v[148:151], v[44:47]
    v_mfma_f32_16x16x32_bf16 v[248:251], v[32:35], v[164:167], v[248:251]
    v_mfma_f32_16x16x32_bf16 v[252:255], v[32:35], v[156:159], v[48:51]
    v_mfma_f32_16x16x32_bf16 v[252:255], v[32:35], v[172:175], v[252:255]
    v_subrev_u32 v20, 65536, v20
    v_subrev_u32 v21, 65536, v21
    v_subrev_u32 v22, 65536, v22
    v_subrev_u32 v23, 65536, v23
    v_subrev_u32 v24, 65536, v24
    v_subrev_u32 v25, 65536, v25
    v_subrev_u32 v26, 65536, v26
    v_subrev_u32 v27, 65536, v27
    v_max_f32 v1, v248, v252
    v_cmp_lt_f32 vcc, s36, v1
    s_nop 1
    s_cbranch_vccnz L_rare15
L_back15:
    v_rcp_f32 v2, v248
    v_rcp_f32 v3, v252
    s_nop 0
    v_pk_mul_f32 v[84:85], v[84:85], v[2:3] op_sel_hi:[1,0]
    v_pk_mul_f32 v[86:87], v[86:87], v[2:3] op_sel_hi:[1,0]
    v_pk_mul_f32 v[88:89], v[88:89], v[2:3] op_sel_hi:[1,0]
    v_pk_mul_f32 v[90:91], v[90:91], v[2:3] op_sel_hi:[1,0]
    v_pk_mul_f32 v[92:93], v[92:93], v[2:3] op_sel:[0,1]
    v_pk_mul_f32 v[94:95], v[94:95], v[2:3] op_sel:[0,1]
    v_pk_mul_f32 v[96:97], v[96:97], v[2:3] op_sel:[0,1]
    v_pk_mul_f32 v[98:99], v[98:99], v[2:3] op_sel:[0,1]
    v_pk_mul_f32 v[100:101], v[100:101], v[2:3] op_sel_hi:[1,0]
    v_pk_mul_f32 v[102:103], v[102:103], v[2:3] op_sel_hi:[1,0]
    v_pk_mul_f32 v[104:105], v[104:105], v[2:3] op_sel_hi:[1,0]
    v_pk_mul_f32 v[106:107], v[106:107], v[2:3] op_sel_hi:[1,0]
    v_pk_mul_f32 v[108:109], v[108:109], v[2:3] op_sel:[0,1]
    v_pk_mul_f32 v[110:111], v[110:111], v[2:3] op_sel:[0,1]
    v_pk_mul_f32 v[112:113], v[112:113], v[2:3] op_sel:[0,1]
    v_pk_mul_f32 v[114:115], v[114:115], v[2:3] op_sel:[0,1]
    v_pk_mul_f32 v[116:117], v[116:117], v[2:3] op_sel_hi:[1,0]
    v_pk_mul_f32 v[118:119], v[118:119], v[2:3] op_sel_hi:[1,0]
    v_pk_mul_f32 v[120:121], v[120:121], v[2:3] op_sel_hi:[1,0]
    v_pk_mul_f32 v[122:123], v[122:123], v[2:3] op_sel_hi:[1,0]
    v_pk_mul_f32 v[124:125], v[124:125], v[2:3] op_sel:[0,1]
    v_pk_mul_f32 v[126:127], v[126:127], v[2:3] op_sel:[0,1]
    v_pk_mul_f32 v[128:129], v[128:129], v[2:3] op_sel:[0,1]
    v_pk_mul_f32 v[130:131], v[130:131], v[2:3] op_sel:[0,1]
    v_pk_mul_f32 v[132:133], v[132:133], v[2:3] op_sel_hi:[1,0]
    v_pk_mul_f32 v[134:135], v[134:135], v[2:3] op_sel_hi:[1,0]
    v_pk_mul_f32 v[136:137], v[136:137], v[2:3] op_sel_hi:[1,0]
    v_pk_mul_f32 v[138:139], v[138:139], v[2:3] op_sel_hi:[1,0]
    v_pk_mul_f32 v[140:141], v[140:141], v[2:3] op_sel:[0,1]
    v_pk_mul_f32 v[142:143], v[142:143], v[2:3] op_sel:[0,1]
    v_pk_mul_f32 v[144:145], v[144:145], v[2:3] op_sel:[0,1]
    v_pk_mul_f32 v[146:147], v[146:147], v[2:3] op_sel:[0,1]
    v_pk_mul_f32 v[180:181], v[180:181], v[2:3] op_sel_hi:[1,0]
    v_pk_mul_f32 v[182:183], v[182:183], v[2:3] op_sel_hi:[1,0]
    v_pk_mul_f32 v[184:185], v[184:185], v[2:3] op_sel_hi:[1,0]
    v_pk_mul_f32 v[186:187], v[186:187], v[2:3] op_sel_hi:[1,0]
    v_pk_mul_f32 v[188:189], v[188:189], v[2:3] op_sel:[0,1]
    v_pk_mul_f32 v[190:191], v[190:191], v[2:3] op_sel:[0,1]
    v_pk_mul_f32 v[192:193], v[192:193], v[2:3] op_sel:[0,1]
    v_pk_mul_f32 v[194:195], v[194:195], v[2:3] op_sel:[0,1]
    v_pk_mul_f32 v[196:197], v[196:197], v[2:3] op_sel_hi:[1,0]
    v_pk_mul_f32 v[198:199], v[198:199], v[2:3] op_sel_hi:[1,0]
    v_pk_mul_f32 v[200:201], v[200:201], v[2:3] op_sel_hi:[1,0]
    v_pk_mul_f32 v[202:203], v[202:203], v[2:3] op_sel_hi:[1,0]
    v_pk_mul_f32 v[204:205], v[204:205], v[2:3] op_sel:[0,1]
    v_pk_mul_f32 v[206:207], v[206:207], v[2:3] op_sel:[0,1]
    v_pk_mul_f32 v[208:209], v[208:209], v[2:3] op_sel:[0,1]
    v_pk_mul_f32 v[210:211], v[210:211], v[2:3] op_sel:[0,1]
    s_barrier
    ds_read_b64_tr_b16 v[212:213], v20 offset:32768
    ds_read_b64_tr_b16 v[214:215], v20 offset:33792
    ds_read_b64_tr_b16 v[216:217], v20 offset:40960
    ds_read_b64_tr_b16 v[218:219], v20 offset:41984
    ds_read_b64_tr_b16 v[220:221], v21 offset:32768
    ds_read_b64_tr_b16 v[222:223], v21 offset:33792
    ds_read_b64_tr_b16 v[224:225], v21 offset:40960
    ds_read_b64_tr_b16 v[226:227], v21 offset:41984
    v_cvt_pk_bf16_f32 v180, v180, v181
    v_cvt_pk_bf16_f32 v181, v182, v183
    v_cvt_pk_bf16_f32 v182, v184, v185
    v_cvt_pk_bf16_f32 v183, v186, v187
    v_cvt_pk_bf16_f32 v188, v188, v189
    v_cvt_pk_bf16_f32 v189, v190, v191
    v_cvt_pk_bf16_f32 v190, v192, v193
    v_cvt_pk_bf16_f32 v191, v194, v195
    v_cvt_pk_bf16_f32 v196, v196, v197
    v_cvt_pk_bf16_f32 v197, v198, v199
    v_cvt_pk_bf16_f32 v198, v200, v201
    v_cvt_pk_bf16_f32 v199, v202, v203
    v_cvt_pk_bf16_f32 v204, v204, v205
    v_cvt_pk_bf16_f32 v205, v206, v207
    v_cvt_pk_bf16_f32 v206, v208, v209
    v_cvt_pk_bf16_f32 v207, v210, v211
    s_waitcnt lgkmcnt(4)
    v_mfma_f32_16x16x32_bf16 v[92:95], v[212:215], v[188:191], v[92:95]
    ds_read_b64_tr_b16 v[228:229], v22 offset:32768
    v_mfma_f32_16x16x32_bf16 v[92:95], v[216:219], v[204:207], v[92:95]
    ds_read_b64_tr_b16 v[230:231], v22 offset:33792
    v_add_u32 v20, 98304, v20
    v_add_u32 v21, 98304, v21
    v_mfma_f32_16x16x32_bf16 v[84:87], v[216:219], v[196:199], v[84:87]
    ds_read_b64_tr_b16 v[232:233], v22 offset:40960
    v_mfma_f32_16x16x32_bf16 v[84:87], v[212:215], v[180:183], v[84:87]
    ds_read_b64_tr_b16 v[234:235], v22 offset:41984
    s_waitcnt lgkmcnt(4)
    v_mfma_f32_16x16x32_bf16 v[88:91], v[220:223], v[180:183], v[88:91]
    ds_read_b64_tr_b16 v[236:237], v23 offset:32768
    v_mfma_f32_16x16x32_bf16 v[88:91], v[224:227], v[196:199], v[88:91]
    ds_read_b64_tr_b16 v[238:239], v23 offset:33792
    v_add_u32 v22, 98304, v22
    v_mfma_f32_16x16x32_bf16 v[96:99], v[224:227], v[204:207], v[96:99]
    ds_read_b64_tr_b16 v[240:241], v23 offset:40960
    v_mfma_f32_16x16x32_bf16 v[96:99], v[220:223], v[188:191], v[96:99]
    ds_read_b64_tr_b16 v[242:243], v23 offset:41984
    s_waitcnt lgkmcnt(4)
    v_mfma_f32_16x16x32_bf16 v[108:111], v[228:231], v[188:191], v[108:111]
    ds_read_b64_tr_b16 v[212:213], v24 offset:32768
    v_mfma_f32_16x16x32_bf16 v[108:111], v[232:235], v[204:207], v[108:111]
    ds_read_b64_tr_b16 v[214:215], v24 offset:33792
    v_add_u32 v23, 98304, v23
    v_mfma_f32_16x16x32_bf16 v[100:103], v[232:235], v[196:199], v[100:103]
    ds_read_b64_tr_b16 v[216:217], v24 offset:40960
    v_mfma_f32_16x16x32_bf16 v[100:103], v[228:231], v[180:183], v[100:103]
    ds_read_b64_tr_b16 v[218:219], v24 offset:41984
    s_waitcnt lgkmcnt(4)
    v_mfma_f32_16x16x32_bf16 v[104:107], v[236:239], v[180:183], v[104:107]
    ds_read_b64_tr_b16 v[220:221], v25 offset:32768
    v_cvt_pk_bf16_f32 v84, v84, v85
    v_mfma_f32_16x16x32_bf16 v[104:107], v[240:243], v[196:199], v[104:107]
    ds_read_b64_tr_b16 v[222:223], v25 offset:33792
    v_add_u32 v24, 98304, v24
    v_cvt_pk_bf16_f32 v85, v86, v87
    v_cvt_pk_bf16_f32 v86, v88, v89
    v_mfma_f32_16x16x32_bf16 v[112:115], v[240:243], v[204:207], v[112:115]
    ds_read_b64_tr_b16 v[224:225], v25 offset:40960
    v_cvt_pk_bf16_f32 v87, v90, v91
    v_mfma_f32_16x16x32_bf16 v[112:115], v[236:239], v[188:191], v[112:115]
    ds_read_b64_tr_b16 v[226:227], v25 offset:41984
    buffer_store_dwordx4 v[84:87], v31, s[28:31], s68 offen offset:0 sc1
    v_cvt_pk_bf16_f32 v92, v92, v93
    s_waitcnt lgkmcnt(4)
    v_mfma_f32_16x16x32_bf16 v[124:127], v[212:215], v[188:191], v[124:127]
    ds_read_b64_tr_b16 v[228:229], v26 offset:32768
    v_cvt_pk_bf16_f32 v93, v94, v95
    v_mfma_f32_16x16x32_bf16 v[124:127], v[216:219], v[204:207], v[124:127]
    ds_read_b64_tr_b16 v[230:231], v26 offset:33792
    v_add_u32 v25, 98304, v25
    v_cvt_pk_bf16_f32 v94, v96, v97
    v_cvt_pk_bf16_f32 v95, v98, v99
    v_mfma_f32_16x16x32_bf16 v[116:119], v[216:219], v[196:199], v[116:119]
    ds_read_b64_tr_b16 v[232:233], v26 offset:40960
    buffer_store_dwordx4 v[92:95], v31, s[28:31], s68 offen offset:1024 sc1
    v_mfma_f32_16x16x32_bf16 v[116:119], v[212:215], v[180:183], v[116:119]
    ds_read_b64_tr_b16 v[234:235], v26 offset:41984
    s_waitcnt lgkmcnt(4)
    v_mfma_f32_16x16x32_bf16 v[120:123], v[220:223], v[180:183], v[120:123]
    ds_read_b64_tr_b16 v[236:237], v27 offset:32768
    v_cvt_pk_bf16_f32 v100, v100, v101
    v_mfma_f32_16x16x32_bf16 v[120:123], v[224:227], v[196:199], v[120:123]
    ds_read_b64_tr_b16 v[238:239], v27 offset:33792
    v_add_u32 v26, 98304, v26
    v_cvt_pk_bf16_f32 v101, v102, v103
    v_cvt_pk_bf16_f32 v102, v104, v105
    v_mfma_f32_16x16x32_bf16 v[128:131], v[224:227], v[204:207], v[128:131]
    ds_read_b64_tr_b16 v[240:241], v27 offset:40960
    v_cvt_pk_bf16_f32 v103, v106, v107
    v_mfma_f32_16x16x32_bf16 v[128:131], v[220:223], v[188:191], v[128:131]
    ds_read_b64_tr_b16 v[242:243], v27 offset:41984
    buffer_store_dwordx4 v[100:103], v31, s[28:31], s68 offen offset:2048 sc1
    v_cvt_pk_bf16_f32 v108, v108, v109
    s_waitcnt lgkmcnt(4)
    v_mfma_f32_16x16x32_bf16 v[140:143], v[228:231], v[188:191], v[140:143]
    ds_read_b64_tr_b16 v[212:213], v20 offset:32768
    v_cvt_pk_bf16_f32 v109, v110, v111
    v_mfma_f32_16x16x32_bf16 v[140:143], v[232:235], v[204:207], v[140:143]
    ds_read_b64_tr_b16 v[214:215], v20 offset:33792
    v_add_u32 v27, 98304, v27
    v_cvt_pk_bf16_f32 v110, v112, v113
    v_cvt_pk_bf16_f32 v111, v114, v115
    v_mfma_f32_16x16x32_bf16 v[132:135], v[232:235], v[196:199], v[132:135]
    ds_read_b64_tr_b16 v[216:217], v20 offset:40960
    buffer_store_dwordx4 v[108:111], v31, s[28:31], s68 offen offset:3072 sc1
    v_mfma_f32_16x16x32_bf16 v[132:135], v[228:231], v[180:183], v[132:135]
    ds_read_b64_tr_b16 v[218:219], v20 offset:41984
    s_waitcnt lgkmcnt(4)
    v_mfma_f32_16x16x32_bf16 v[136:139], v[236:239], v[180:183], v[136:139]
    ds_read_b64_tr_b16 v[220:221], v21 offset:32768
    v_cvt_pk_bf16_f32 v116, v116, v117
    v_mfma_f32_16x16x32_bf16 v[136:139], v[240:243], v[196:199], v[136:139]
    ds_read_b64_tr_b16 v[222:223], v21 offset:33792
    v_cvt_pk_bf16_f32 v117, v118, v119
    v_cvt_pk_bf16_f32 v118, v120, v121
    v_mfma_f32_16x16x32_bf16 v[144:147], v[240:243], v[204:207], v[144:147]
    ds_read_b64_tr_b16 v[224:225], v21 offset:40960
    v_cvt_pk_bf16_f32 v119, v122, v123
    v_mfma_f32_16x16x32_bf16 v[144:147], v[236:239], v[188:191], v[144:147]
    ds_read_b64_tr_b16 v[226:227], v21 offset:41984
    v_add_u32 v31, 4096, v31
    buffer_store_dwordx4 v[116:119], v31, s[28:31], s68 offen offset:0 sc1
    s_waitcnt lgkmcnt(4)
    v_mfma_f32_16x16x32_bf16 v[148:151], v[212:215], v[84:87], 0
    ds_read_b64_tr_b16 v[228:229], v22 offset:32768
    v_cvt_pk_bf16_f32 v124, v124, v125
    v_mfma_f32_16x16x32_bf16 v[148:151], v[216:219], v[100:103], v[148:151]
    ds_read_b64_tr_b16 v[230:231], v22 offset:33792
    v_cvt_pk_bf16_f32 v125, v126, v127
    v_cvt_pk_bf16_f32 v126, v128, v129
    v_mfma_f32_16x16x32_bf16 v[152:155], v[216:219], v[108:111], 0
    ds_read_b64_tr_b16 v[232:233], v22 offset:40960
    v_cvt_pk_bf16_f32 v127, v130, v131
    v_mfma_f32_16x16x32_bf16 v[152:155], v[212:215], v[92:95], v[152:155]
    ds_read_b64_tr_b16 v[234:235], v22 offset:41984
    buffer_store_dwordx4 v[124:127], v31, s[28:31], s68 offen offset:1024 sc1
    s_waitcnt lgkmcnt(4)
    v_mfma_f32_16x16x32_bf16 v[160:163], v[220:223], v[92:95], 0
    ds_read_b64_tr_b16 v[236:237], v23 offset:32768
    v_cvt_pk_bf16_f32 v132, v132, v133
    v_cvt_pk_bf16_f32 v133, v134, v135
    v_cvt_pk_bf16_f32 v134, v136, v137
    v_cvt_pk_bf16_f32 v135, v138, v139
    buffer_store_dwordx4 v[132:135], v31, s[28:31], s68 offen offset:2048 sc1
    v_mfma_f32_16x16x32_bf16 v[160:163], v[224:227], v[108:111], v[160:163]
    ds_read_b64_tr_b16 v[238:239], v23 offset:33792
    v_cvt_pk_bf16_f32 v140, v140, v141
    v_cvt_pk_bf16_f32 v141, v142, v143
    v_cvt_pk_bf16_f32 v142, v144, v145
    v_cvt_pk_bf16_f32 v143, v146, v147
    buffer_store_dwordx4 v[140:143], v31, s[28:31], s68 offen offset:3072 sc1
    v_mfma_f32_16x16x32_bf16 v[156:159], v[224:227], v[100:103], 0
    ds_read_b64_tr_b16 v[240:241], v23 offset:40960
    v_mfma_f32_16x16x32_bf16 v[156:159], v[220:223], v[84:87], v[156:159]
    ds_read_b64_tr_b16 v[242:243], v23 offset:41984
    s_waitcnt lgkmcnt(4)
    v_mfma_f32_16x16x32_bf16 v[164:167], v[228:231], v[84:87], 0
    ds_read_b64_tr_b16 v[212:213], v24 offset:32768
    v_mfma_f32_16x16x32_bf16 v[164:167], v[232:235], v[100:103], v[164:167]
    ds_read_b64_tr_b16 v[214:215], v24 offset:33792
    v_mfma_f32_16x16x32_bf16 v[168:171], v[232:235], v[108:111], 0
    ds_read_b64_tr_b16 v[216:217], v24 offset:40960
    v_mfma_f32_16x16x32_bf16 v[168:171], v[228:231], v[92:95], v[168:171]
    ds_read_b64_tr_b16 v[218:219], v24 offset:41984
    s_waitcnt lgkmcnt(4)
    v_mfma_f32_16x16x32_bf16 v[176:179], v[236:239], v[92:95], 0
    ds_read_b64_tr_b16 v[220:221], v25 offset:32768
    v_mfma_f32_16x16x32_bf16 v[176:179], v[240:243], v[108:111], v[176:179]
    ds_read_b64_tr_b16 v[222:223], v25 offset:33792
    v_mfma_f32_16x16x32_bf16 v[172:175], v[240:243], v[100:103], 0
    ds_read_b64_tr_b16 v[224:225], v25 offset:40960
    v_mfma_f32_16x16x32_bf16 v[172:175], v[236:239], v[84:87], v[172:175]
    ds_read_b64_tr_b16 v[226:227], v25 offset:41984
    s_waitcnt lgkmcnt(4)
    v_mfma_f32_16x16x32_bf16 v[180:183], v[212:215], v[84:87], 0
    ds_read_b64_tr_b16 v[228:229], v26 offset:32768
    v_mfma_f32_16x16x32_bf16 v[180:183], v[216:219], v[100:103], v[180:183]
    ds_read_b64_tr_b16 v[230:231], v26 offset:33792
    v_mfma_f32_16x16x32_bf16 v[184:187], v[216:219], v[108:111], 0
    ds_read_b64_tr_b16 v[232:233], v26 offset:40960
    v_mfma_f32_16x16x32_bf16 v[184:187], v[212:215], v[92:95], v[184:187]
    ds_read_b64_tr_b16 v[234:235], v26 offset:41984
    s_waitcnt lgkmcnt(4)
    v_mfma_f32_16x16x32_bf16 v[192:195], v[220:223], v[92:95], 0
    ds_read_b64_tr_b16 v[236:237], v27 offset:32768
    v_mfma_f32_16x16x32_bf16 v[192:195], v[224:227], v[108:111], v[192:195]
    ds_read_b64_tr_b16 v[238:239], v27 offset:33792
    v_mfma_f32_16x16x32_bf16 v[188:191], v[224:227], v[100:103], 0
    ds_read_b64_tr_b16 v[240:241], v27 offset:40960
    v_mfma_f32_16x16x32_bf16 v[188:191], v[220:223], v[84:87], v[188:191]
    ds_read_b64_tr_b16 v[242:243], v27 offset:41984
    s_waitcnt lgkmcnt(4)
    v_mfma_f32_16x16x32_bf16 v[196:199], v[228:231], v[84:87], 0
    ds_read_b64_tr_b16 v[212:213], v20 offset:49152
    v_mfma_f32_16x16x32_bf16 v[196:199], v[232:235], v[100:103], v[196:199]
    ds_read_b64_tr_b16 v[214:215], v20 offset:50176
    v_mfma_f32_16x16x32_bf16 v[200:203], v[232:235], v[108:111], 0
    ds_read_b64_tr_b16 v[216:217], v20 offset:57344
    v_mfma_f32_16x16x32_bf16 v[200:203], v[228:231], v[92:95], v[200:203]
    ds_read_b64_tr_b16 v[218:219], v20 offset:58368
    s_waitcnt lgkmcnt(4)
    v_mfma_f32_16x16x32_bf16 v[208:211], v[236:239], v[92:95], 0
    ds_read_b64_tr_b16 v[220:221], v21 offset:49152
    v_mfma_f32_16x16x32_bf16 v[208:211], v[240:243], v[108:111], v[208:211]
    ds_read_b64_tr_b16 v[222:223], v21 offset:50176
    v_mfma_f32_16x16x32_bf16 v[204:207], v[240:243], v[100:103], 0
    ds_read_b64_tr_b16 v[224:225], v21 offset:57344
    v_mfma_f32_16x16x32_bf16 v[204:207], v[236:239], v[84:87], v[204:207]
    ds_read_b64_tr_b16 v[226:227], v21 offset:58368
    s_waitcnt lgkmcnt(4)
    v_mfma_f32_16x16x32_bf16 v[148:151], v[212:215], v[116:119], v[148:151]
    ds_read_b64_tr_b16 v[228:229], v22 offset:49152
    v_mfma_f32_16x16x32_bf16 v[148:151], v[216:219], v[132:135], v[148:151]
    ds_read_b64_tr_b16 v[230:231], v22 offset:50176
    v_mfma_f32_16x16x32_bf16 v[152:155], v[216:219], v[140:143], v[152:155]
    ds_read_b64_tr_b16 v[232:233], v22 offset:57344
    v_mfma_f32_16x16x32_bf16 v[152:155], v[212:215], v[124:127], v[152:155]
    ds_read_b64_tr_b16 v[234:235], v22 offset:58368
    s_waitcnt lgkmcnt(4)
    v_mfma_f32_16x16x32_bf16 v[160:163], v[220:223], v[124:127], v[160:163]
    ds_read_b64_tr_b16 v[236:237], v23 offset:49152
    v_mfma_f32_16x16x32_bf16 v[160:163], v[224:227], v[140:143], v[160:163]
    ds_read_b64_tr_b16 v[238:239], v23 offset:50176
    v_mfma_f32_16x16x32_bf16 v[156:159], v[224:227], v[132:135], v[156:159]
    ds_read_b64_tr_b16 v[240:241], v23 offset:57344
    v_mfma_f32_16x16x32_bf16 v[156:159], v[220:223], v[116:119], v[156:159]
    ds_read_b64_tr_b16 v[242:243], v23 offset:58368
    s_waitcnt vmcnt(0)
    s_barrier
    s_waitcnt lgkmcnt(4)
    v_mfma_f32_16x16x32_bf16 v[164:167], v[228:231], v[116:119], v[164:167]
    ds_read_b64_tr_b16 v[212:213], v24 offset:49152
    v_mfma_f32_16x16x32_bf16 v[164:167], v[232:235], v[132:135], v[164:167]
    ds_read_b64_tr_b16 v[214:215], v24 offset:50176
    v_mfma_f32_16x16x32_bf16 v[168:171], v[232:235], v[140:143], v[168:171]
    ds_read_b64_tr_b16 v[216:217], v24 offset:57344
    v_mfma_f32_16x16x32_bf16 v[168:171], v[228:231], v[124:127], v[168:171]
    ds_read_b64_tr_b16 v[218:219], v24 offset:58368
    s_waitcnt lgkmcnt(4)
    v_mfma_f32_16x16x32_bf16 v[176:179], v[236:239], v[124:127], v[176:179]
    ds_read_b64_tr_b16 v[220:221], v25 offset:49152
    v_mfma_f32_16x16x32_bf16 v[176:179], v[240:243], v[140:143], v[176:179]
    ds_read_b64_tr_b16 v[222:223], v25 offset:50176
    v_mfma_f32_16x16x32_bf16 v[172:175], v[240:243], v[132:135], v[172:175]
    ds_read_b64_tr_b16 v[224:225], v25 offset:57344
    v_mfma_f32_16x16x32_bf16 v[172:175], v[236:239], v[116:119], v[172:175]
    ds_read_b64_tr_b16 v[226:227], v25 offset:58368
    s_waitcnt lgkmcnt(4)
    v_mfma_f32_16x16x32_bf16 v[180:183], v[212:215], v[116:119], v[180:183]
    ds_read_b64_tr_b16 v[228:229], v26 offset:49152
    v_mfma_f32_16x16x32_bf16 v[180:183], v[216:219], v[132:135], v[180:183]
    ds_read_b64_tr_b16 v[230:231], v26 offset:50176
    v_mfma_f32_16x16x32_bf16 v[184:187], v[216:219], v[140:143], v[184:187]
    ds_read_b64_tr_b16 v[232:233], v26 offset:57344
    v_mfma_f32_16x16x32_bf16 v[184:187], v[212:215], v[124:127], v[184:187]
    ds_read_b64_tr_b16 v[234:235], v26 offset:58368
    s_waitcnt lgkmcnt(4)
    v_mfma_f32_16x16x32_bf16 v[192:195], v[220:223], v[124:127], v[192:195]
    ds_read_b64_tr_b16 v[236:237], v27 offset:49152
    v_mfma_f32_16x16x32_bf16 v[192:195], v[224:227], v[140:143], v[192:195]
    ds_read_b64_tr_b16 v[238:239], v27 offset:50176
    v_mfma_f32_16x16x32_bf16 v[188:191], v[224:227], v[132:135], v[188:191]
    ds_read_b64_tr_b16 v[240:241], v27 offset:57344
    v_mfma_f32_16x16x32_bf16 v[188:191], v[220:223], v[116:119], v[188:191]
    ds_read_b64_tr_b16 v[242:243], v27 offset:58368
    s_waitcnt lgkmcnt(4)
    v_mfma_f32_16x16x32_bf16 v[196:199], v[228:231], v[116:119], v[196:199]
    v_mfma_f32_16x16x32_bf16 v[196:199], v[232:235], v[132:135], v[196:199]
    v_mfma_f32_16x16x32_bf16 v[200:203], v[232:235], v[140:143], v[200:203]
    v_mfma_f32_16x16x32_bf16 v[200:203], v[228:231], v[124:127], v[200:203]
    s_waitcnt lgkmcnt(0)
    v_mfma_f32_16x16x32_bf16 v[208:211], v[236:239], v[124:127], v[208:211]
    v_mfma_f32_16x16x32_bf16 v[208:211], v[240:243], v[140:143], v[208:211]
    v_mfma_f32_16x16x32_bf16 v[204:207], v[240:243], v[132:135], v[204:207]
    v_mfma_f32_16x16x32_bf16 v[204:207], v[236:239], v[116:119], v[204:207]
    s_barrier
    s_add_u32 s7, s69, 1
    s_and_b32 s7, s7, 3
    s_lshl_b32 s7, s7, 13
    buffer_load_dwordx4 v[52:55], v12, s[28:31], s7 offen offset:0 sc1
    buffer_load_dwordx4 v[56:59], v12, s[28:31], s7 offen offset:1024 sc1
    buffer_load_dwordx4 v[60:63], v12, s[28:31], s7 offen offset:2048 sc1
    buffer_load_dwordx4 v[64:67], v12, s[28:31], s7 offen offset:3072 sc1
    s_add_u32 s7, s7, 4096
    buffer_load_dwordx4 v[68:71], v12, s[28:31], s7 offen offset:0 sc1
    buffer_load_dwordx4 v[72:75], v12, s[28:31], s7 offen offset:1024 sc1
    buffer_load_dwordx4 v[76:79], v12, s[28:31], s7 offen offset:2048 sc1
    buffer_load_dwordx4 v[80:83], v12, s[28:31], s7 offen offset:3072 sc1
    s_add_u32 s7, s69, 2
    s_and_b32 s7, s7, 3
    s_lshl_b32 s7, s7, 13
    buffer_load_dwordx4 v[88:91], v12, s[28:31], s7 offen offset:0 sc1
    buffer_load_dwordx4 v[96:99], v12, s[28:31], s7 offen offset:1024 sc1
    buffer_load_dwordx4 v[104:107], v12, s[28:31], s7 offen offset:2048 sc1
    buffer_load_dwordx4 v[112:115], v12, s[28:31], s7 offen offset:3072 sc1
    ds_read_b64_tr_b16 v[212:213], v20 offset:16384
    ds_read_b64_tr_b16 v[214:215], v20 offset:17408
    ds_read_b64_tr_b16 v[216:217], v20 offset:24576
    ds_read_b64_tr_b16 v[218:219], v20 offset:25600
    ds_read_b64_tr_b16 v[220:221], v21 offset:16384
    ds_read_b64_tr_b16 v[222:223], v21 offset:17408
    ds_read_b64_tr_b16 v[224:225], v21 offset:24576
    ds_read_b64_tr_b16 v[226:227], v21 offset:25600
    s_waitcnt vmcnt(8)
    s_waitcnt lgkmcnt(4)
    v_mfma_f32_16x16x32_bf16 v[148:151], v[212:215], v[52:55], v[148:151]
    ds_read_b64_tr_b16 v[228:229], v22 offset:16384
    v_mfma_f32_16x16x32_bf16 v[148:151], v[216:219], v[60:63], v[148:151]
    ds_read_b64_tr_b16 v[230:231], v22 offset:17408
    s_add_u32 s7, s7, 4096
    buffer_load_dwordx4 v[120:123], v12, s[28:31], s7 offen offset:0 sc1
    v_mfma_f32_16x16x32_bf16 v[152:155], v[216:219], v[64:67], v[152:155]
    ds_read_b64_tr_b16 v[232:233], v22 offset:24576
    v_mfma_f32_16x16x32_bf16 v[152:155], v[212:215], v[56:59], v[152:155]
    ds_read_b64_tr_b16 v[234:235], v22 offset:25600
    s_waitcnt lgkmcnt(4)
    v_mfma_f32_16x16x32_bf16 v[160:163], v[220:223], v[56:59], v[160:163]
    ds_read_b64_tr_b16 v[236:237], v23 offset:16384
    v_mfma_f32_16x16x32_bf16 v[160:163], v[224:227], v[64:67], v[160:163]
    ds_read_b64_tr_b16 v[238:239], v23 offset:17408
    buffer_load_dwordx4 v[128:131], v12, s[28:31], s7 offen offset:1024 sc1
    v_mfma_f32_16x16x32_bf16 v[156:159], v[224:227], v[60:63], v[156:159]
    ds_read_b64_tr_b16 v[240:241], v23 offset:24576
    v_mfma_f32_16x16x32_bf16 v[156:159], v[220:223], v[52:55], v[156:159]
    ds_read_b64_tr_b16 v[242:243], v23 offset:25600
    s_waitcnt lgkmcnt(4)
    v_mfma_f32_16x16x32_bf16 v[164:167], v[228:231], v[52:55], v[164:167]
    ds_read_b64_tr_b16 v[212:213], v24 offset:16384
    v_mfma_f32_16x16x32_bf16 v[164:167], v[232:235], v[60:63], v[164:167]
    ds_read_b64_tr_b16 v[214:215], v24 offset:17408
    buffer_load_dwordx4 v[136:139], v12, s[28:31], s7 offen offset:2048 sc1
    v_mfma_f32_16x16x32_bf16 v[168:171], v[232:235], v[64:67], v[168:171]
    ds_read_b64_tr_b16 v[216:217], v24 offset:24576
    v_mfma_f32_16x16x32_bf16 v[168:171], v[228:231], v[56:59], v[168:171]
    ds_read_b64_tr_b16 v[218:219], v24 offset:25600
    s_waitcnt lgkmcnt(4)
    v_mfma_f32_16x16x32_bf16 v[176:179], v[236:239], v[56:59], v[176:179]
    ds_read_b64_tr_b16 v[220:221], v25 offset:16384
    v_mfma_f32_16x16x32_bf16 v[176:179], v[240:243], v[64:67], v[176:179]
    ds_read_b64_tr_b16 v[222:223], v25 offset:17408
    buffer_load_dwordx4 v[144:147], v12, s[28:31], s7 offen offset:3072 sc1
    v_mfma_f32_16x16x32_bf16 v[172:175], v[240:243], v[60:63], v[172:175]
    ds_read_b64_tr_b16 v[224:225], v25 offset:24576
    v_mfma_f32_16x16x32_bf16 v[172:175], v[236:239], v[52:55], v[172:175]
    ds_read_b64_tr_b16 v[226:227], v25 offset:25600
    s_waitcnt lgkmcnt(4)
    v_mfma_f32_16x16x32_bf16 v[180:183], v[212:215], v[52:55], v[180:183]
    ds_read_b64_tr_b16 v[228:229], v26 offset:16384
    v_mfma_f32_16x16x32_bf16 v[180:183], v[216:219], v[60:63], v[180:183]
    ds_read_b64_tr_b16 v[230:231], v26 offset:17408
    s_add_u32 s7, s69, 3
    s_and_b32 s7, s7, 3
    s_lshl_b32 s7, s7, 13
    buffer_load_dwordx4 v[32:35], v12, s[28:31], s7 offen offset:0 sc1
    v_mfma_f32_16x16x32_bf16 v[184:187], v[216:219], v[64:67], v[184:187]
    ds_read_b64_tr_b16 v[232:233], v26 offset:24576
    v_mfma_f32_16x16x32_bf16 v[184:187], v[212:215], v[56:59], v[184:187]
    ds_read_b64_tr_b16 v[234:235], v26 offset:25600
    s_waitcnt lgkmcnt(4)
    v_mfma_f32_16x16x32_bf16 v[192:195], v[220:223], v[56:59], v[192:195]
    ds_read_b64_tr_b16 v[236:237], v27 offset:16384
    v_mfma_f32_16x16x32_bf16 v[192:195], v[224:227], v[64:67], v[192:195]
    ds_read_b64_tr_b16 v[238:239], v27 offset:17408
    buffer_load_dwordx4 v[36:39], v12, s[28:31], s7 offen offset:1024 sc1
    v_mfma_f32_16x16x32_bf16 v[188:191], v[224:227], v[60:63], v[188:191]
    ds_read_b64_tr_b16 v[240:241], v27 offset:24576
    v_mfma_f32_16x16x32_bf16 v[188:191], v[220:223], v[52:55], v[188:191]
    ds_read_b64_tr_b16 v[242:243], v27 offset:25600
    s_waitcnt lgkmcnt(4)
    v_mfma_f32_16x16x32_bf16 v[196:199], v[228:231], v[52:55], v[196:199]
    ds_read_b64_tr_b16 v[212:213], v20 offset:0
    v_mfma_f32_16x16x32_bf16 v[196:199], v[232:235], v[60:63], v[196:199]
    ds_read_b64_tr_b16 v[214:215], v20 offset:1024
    v_mfma_f32_16x16x32_bf16 v[200:203], v[232:235], v[64:67], v[200:203]
    ds_read_b64_tr_b16 v[216:217], v20 offset:8192
    v_mfma_f32_16x16x32_bf16 v[200:203], v[228:231], v[56:59], v[200:203]
    ds_read_b64_tr_b16 v[218:219], v20 offset:9216
    buffer_load_dwordx4 v[40:43], v12, s[28:31], s7 offen offset:2048 sc1
    s_waitcnt lgkmcnt(4)
    v_mfma_f32_16x16x32_bf16 v[208:211], v[236:239], v[56:59], v[208:211]
    ds_read_b64_tr_b16 v[220:221], v21 offset:0
    v_mfma_f32_16x16x32_bf16 v[208:211], v[240:243], v[64:67], v[208:211]
    ds_read_b64_tr_b16 v[222:223], v21 offset:1024
    v_mfma_f32_16x16x32_bf16 v[204:207], v[240:243], v[60:63], v[204:207]
    ds_read_b64_tr_b16 v[224:225], v21 offset:8192
    v_mfma_f32_16x16x32_bf16 v[204:207], v[236:239], v[52:55], v[204:207]
    ds_read_b64_tr_b16 v[226:227], v21 offset:9216
    buffer_load_dwordx4 v[44:47], v12, s[28:31], s7 offen offset:3072 sc1
    s_waitcnt vmcnt(12)
    s_waitcnt lgkmcnt(4)
    v_mfma_f32_16x16x32_bf16 v[148:151], v[212:215], v[68:71], v[148:151]
    ds_read_b64_tr_b16 v[228:229], v22 offset:0
    v_mfma_f32_16x16x32_bf16 v[148:151], v[216:219], v[76:79], v[148:151]
    ds_read_b64_tr_b16 v[230:231], v22 offset:1024
    v_mfma_f32_16x16x32_bf16 v[152:155], v[216:219], v[80:83], v[152:155]
    ds_read_b64_tr_b16 v[232:233], v22 offset:8192
    v_mfma_f32_16x16x32_bf16 v[152:155], v[212:215], v[72:75], v[152:155]
    ds_read_b64_tr_b16 v[234:235], v22 offset:9216
    s_add_u32 s7, s7, 4096
    buffer_load_dwordx4 v[48:51], v12, s[28:31], s7 offen offset:0 sc1
    s_waitcnt lgkmcnt(4)
    v_mfma_f32_16x16x32_bf16 v[160:163], v[220:223], v[72:75], v[160:163]
    ds_read_b64_tr_b16 v[236:237], v23 offset:0
    v_mfma_f32_16x16x32_bf16 v[160:163], v[224:227], v[80:83], v[160:163]
    ds_read_b64_tr_b16 v[238:239], v23 offset:1024
    v_mfma_f32_16x16x32_bf16 v[156:159], v[224:227], v[76:79], v[156:159]
    ds_read_b64_tr_b16 v[240:241], v23 offset:8192
    v_mfma_f32_16x16x32_bf16 v[156:159], v[220:223], v[68:71], v[156:159]
    ds_read_b64_tr_b16 v[242:243], v23 offset:9216
    buffer_load_dwordx4 v[244:247], v12, s[28:31], s7 offen offset:1024 sc1
    s_waitcnt lgkmcnt(4)
    v_mfma_f32_16x16x32_bf16 v[164:167], v[228:231], v[68:71], v[164:167]
    ds_read_b64_tr_b16 v[212:213], v24 offset:0
    v_mfma_f32_16x16x32_bf16 v[164:167], v[232:235], v[76:79], v[164:167]
    ds_read_b64_tr_b16 v[214:215], v24 offset:1024
    v_mfma_f32_16x16x32_bf16 v[168:171], v[232:235], v[80:83], v[168:171]
    ds_read_b64_tr_b16 v[216:217], v24 offset:8192
    v_mfma_f32_16x16x32_bf16 v[168:171], v[228:231], v[72:75], v[168:171]
    ds_read_b64_tr_b16 v[218:219], v24 offset:9216
    buffer_load_dwordx4 v[248:251], v12, s[28:31], s7 offen offset:2048 sc1
    s_waitcnt lgkmcnt(4)
    v_mfma_f32_16x16x32_bf16 v[176:179], v[236:239], v[72:75], v[176:179]
    ds_read_b64_tr_b16 v[220:221], v25 offset:0
    v_mfma_f32_16x16x32_bf16 v[176:179], v[240:243], v[80:83], v[176:179]
    ds_read_b64_tr_b16 v[222:223], v25 offset:1024
    v_mfma_f32_16x16x32_bf16 v[172:175], v[240:243], v[76:79], v[172:175]
    ds_read_b64_tr_b16 v[224:225], v25 offset:8192
    v_mfma_f32_16x16x32_bf16 v[172:175], v[236:239], v[68:71], v[172:175]
    ds_read_b64_tr_b16 v[226:227], v25 offset:9216
    buffer_load_dwordx4 v[252:255], v12, s[28:31], s7 offen offset:3072 sc1
    s_waitcnt lgkmcnt(4)
    v_mfma_f32_16x16x32_bf16 v[180:183], v[212:215], v[68:71], v[180:183]
    ds_read_b64_tr_b16 v[228:229], v26 offset:0
    v_mfma_f32_16x16x32_bf16 v[180:183], v[216:219], v[76:79], v[180:183]
    ds_read_b64_tr_b16 v[230:231], v26 offset:1024
    v_mfma_f32_16x16x32_bf16 v[184:187], v[216:219], v[80:83], v[184:187]
    ds_read_b64_tr_b16 v[232:233], v26 offset:8192
    v_mfma_f32_16x16x32_bf16 v[184:187], v[212:215], v[72:75], v[184:187]
    ds_read_b64_tr_b16 v[234:235], v26 offset:9216
    s_waitcnt lgkmcnt(4)
    v_mfma_f32_16x16x32_bf16 v[192:195], v[220:223], v[72:75], v[192:195]
    ds_read_b64_tr_b16 v[236:237], v27 offset:0
    v_mfma_f32_16x16x32_bf16 v[192:195], v[224:227], v[80:83], v[192:195]
    ds_read_b64_tr_b16 v[238:239], v27 offset:1024
    v_subrev_u32 v4, 98304, v20
    v_subrev_u32 v5, 32768, v20
    v_mfma_f32_16x16x32_bf16 v[188:191], v[224:227], v[76:79], v[188:191]
    ds_read_b64_tr_b16 v[240:241], v27 offset:8192
    v_mfma_f32_16x16x32_bf16 v[188:191], v[220:223], v[68:71], v[188:191]
    ds_read_b64_tr_b16 v[242:243], v27 offset:9216
    s_waitcnt lgkmcnt(4)
    v_mfma_f32_16x16x32_bf16 v[196:199], v[228:231], v[68:71], v[196:199]
    ds_read_b64_tr_b16 v[212:213], v4 offset:0
    v_mfma_f32_16x16x32_bf16 v[196:199], v[232:235], v[76:79], v[196:199]
    ds_read_b64_tr_b16 v[214:215], v4 offset:1024
    v_add_u32 v13, 32768, v12
    s_lshl_b32 s87, s4, 1
    s_sub_u32 s87, s60, s87
    v_mfma_f32_16x16x32_bf16 v[200:203], v[232:235], v[80:83], v[200:203]
    ds_read_b64_tr_b16 v[216:217], v4 offset:8192
    v_mfma_f32_16x16x32_bf16 v[200:203], v[228:231], v[72:75], v[200:203]
    ds_read_b64_tr_b16 v[218:219], v4 offset:9216
    s_waitcnt lgkmcnt(4)
    v_mfma_f32_16x16x32_bf16 v[208:211], v[236:239], v[72:75], v[208:211]
    ds_read_b64_tr_b16 v[220:221], v4 offset:16384
    v_mfma_f32_16x16x32_bf16 v[208:211], v[240:243], v[80:83], v[208:211]
    ds_read_b64_tr_b16 v[222:223], v4 offset:17408
    v_mfma_f32_16x16x32_bf16 v[204:207], v[240:243], v[76:79], v[204:207]
    ds_read_b64_tr_b16 v[224:225], v4 offset:24576
    v_mfma_f32_16x16x32_bf16 v[204:207], v[236:239], v[68:71], v[204:207]
    ds_read_b64_tr_b16 v[226:227], v4 offset:25600
    s_waitcnt vmcnt(12)
    s_waitcnt lgkmcnt(4)
    v_mfma_f32_16x16x32_bf16 v[148:151], v[212:215], v[88:91], v[148:151]
    ds_read_b64_tr_b16 v[228:229], v5 offset:16384
    v_mfma_f32_16x16x32_bf16 v[148:151], v[216:219], v[104:107], v[148:151]
    ds_read_b64_tr_b16 v[230:231], v5 offset:17408
    v_mfma_f32_16x16x32_bf16 v[152:155], v[216:219], v[112:115], v[152:155]
    ds_read_b64_tr_b16 v[232:233], v5 offset:24576
    v_mfma_f32_16x16x32_bf16 v[152:155], v[212:215], v[96:99], v[152:155]
    ds_read_b64_tr_b16 v[234:235], v5 offset:25600
    s_waitcnt vmcnt(8)
    s_waitcnt lgkmcnt(4)
    v_mfma_f32_16x16x32_bf16 v[152:155], v[220:223], v[128:131], v[152:155]
    ds_read_b64_tr_b16 v[236:237], v4 offset:49152
    v_mfma_f32_16x16x32_bf16 v[152:155], v[224:227], v[144:147], v[152:155]
    ds_read_b64_tr_b16 v[238:239], v4 offset:50176
    v_subrev_u32 v6, 98304, v21
    v_subrev_u32 v7, 32768, v21
    v_mfma_f32_16x16x32_bf16 v[148:151], v[224:227], v[136:139], v[148:151]
    ds_read_b64_tr_b16 v[240:241], v4 offset:57344
    v_mfma_f32_16x16x32_bf16 v[148:151], v[220:223], v[120:123], v[148:151]
    ds_read_b64_tr_b16 v[242:243], v4 offset:58368
    s_waitcnt vmcnt(4)
    s_waitcnt lgkmcnt(4)
    v_mfma_f32_16x16x32_bf16 v[148:151], v[228:231], v[32:35], v[148:151]
    ds_read_b64_tr_b16 v[212:213], v6 offset:49152
    v_mfma_f32_16x16x32_bf16 v[148:151], v[232:235], v[40:43], v[148:151]
    ds_read_b64_tr_b16 v[214:215], v6 offset:50176
    v_mfma_f32_16x16x32_bf16 v[152:155], v[232:235], v[44:47], v[152:155]
    ds_read_b64_tr_b16 v[216:217], v6 offset:57344
    v_mfma_f32_16x16x32_bf16 v[152:155], v[228:231], v[36:39], v[152:155]
    ds_read_b64_tr_b16 v[218:219], v6 offset:58368
    s_waitcnt vmcnt(0)
    s_waitcnt lgkmcnt(4)
    v_mfma_f32_16x16x32_bf16 v[152:155], v[236:239], v[244:247], v[152:155]
    ds_read_b64_tr_b16 v[220:221], v7 offset:16384
    v_mfma_f32_16x16x32_bf16 v[152:155], v[240:243], v[252:255], v[152:155]
    ds_read_b64_tr_b16 v[222:223], v7 offset:17408
    v_mfma_f32_16x16x32_bf16 v[148:151], v[240:243], v[248:251], v[148:151]
    ds_read_b64_tr_b16 v[224:225], v7 offset:24576
    v_mfma_f32_16x16x32_bf16 v[148:151], v[236:239], v[48:51], v[148:151]
    ds_read_b64_tr_b16 v[226:227], v7 offset:25600
    s_waitcnt lgkmcnt(4)
    v_mfma_f32_16x16x32_bf16 v[156:159], v[212:215], v[48:51], v[156:159]
    ds_read_b64_tr_b16 v[228:229], v6 offset:16384
    v_mfma_f32_16x16x32_bf16 v[156:159], v[216:219], v[248:251], v[156:159]
    ds_read_b64_tr_b16 v[230:231], v6 offset:17408
    v_mfma_f32_16x16x32_bf16 v[160:163], v[216:219], v[252:255], v[160:163]
    ds_read_b64_tr_b16 v[232:233], v6 offset:24576
    v_mfma_f32_16x16x32_bf16 v[160:163], v[212:215], v[244:247], v[160:163]
    ds_read_b64_tr_b16 v[234:235], v6 offset:25600
    s_waitcnt lgkmcnt(4)
    v_mfma_f32_16x16x32_bf16 v[160:163], v[220:223], v[36:39], v[160:163]
    ds_read_b64_tr_b16 v[236:237], v6 offset:0
    v_mfma_f32_16x16x32_bf16 v[160:163], v[224:227], v[44:47], v[160:163]
    ds_read_b64_tr_b16 v[238:239], v6 offset:1024
    v_subrev_u32 v4, 98304, v22
    v_subrev_u32 v5, 32768, v22
    v_mfma_f32_16x16x32_bf16 v[156:159], v[224:227], v[40:43], v[156:159]
    ds_read_b64_tr_b16 v[240:241], v6 offset:8192
    v_mfma_f32_16x16x32_bf16 v[156:159], v[220:223], v[32:35], v[156:159]
    ds_read_b64_tr_b16 v[242:243], v6 offset:9216
    s_waitcnt lgkmcnt(4)
    v_mfma_f32_16x16x32_bf16 v[156:159], v[228:231], v[120:123], v[156:159]
    ds_read_b64_tr_b16 v[212:213], v4 offset:0
    v_mfma_f32_16x16x32_bf16 v[156:159], v[232:235], v[136:139], v[156:159]
    ds_read_b64_tr_b16 v[214:215], v4 offset:1024
    v_mfma_f32_16x16x32_bf16 v[160:163], v[232:235], v[144:147], v[160:163]
    ds_read_b64_tr_b16 v[216:217], v4 offset:8192
    v_mfma_f32_16x16x32_bf16 v[160:163], v[228:231], v[128:131], v[160:163]
    ds_read_b64_tr_b16 v[218:219], v4 offset:9216
    s_waitcnt lgkmcnt(4)
    v_mfma_f32_16x16x32_bf16 v[160:163], v[236:239], v[96:99], v[160:163]
    ds_read_b64_tr_b16 v[220:221], v4 offset:16384
    v_mfma_f32_16x16x32_bf16 v[160:163], v[240:243], v[112:115], v[160:163]
    ds_read_b64_tr_b16 v[222:223], v4 offset:17408
    v_mfma_f32_16x16x32_bf16 v[156:159], v[240:243], v[104:107], v[156:159]
    ds_read_b64_tr_b16 v[224:225], v4 offset:24576
    v_mfma_f32_16x16x32_bf16 v[156:159], v[236:239], v[88:91], v[156:159]
    ds_read_b64_tr_b16 v[226:227], v4 offset:25600
    s_waitcnt lgkmcnt(4)
    v_mfma_f32_16x16x32_bf16 v[164:167], v[212:215], v[88:91], v[164:167]
    ds_read_b64_tr_b16 v[228:229], v5 offset:16384
    v_mfma_f32_16x16x32_bf16 v[164:167], v[216:219], v[104:107], v[164:167]
    ds_read_b64_tr_b16 v[230:231], v5 offset:17408
    v_mfma_f32_16x16x32_bf16 v[168:171], v[216:219], v[112:115], v[168:171]
    ds_read_b64_tr_b16 v[232:233], v5 offset:24576
    v_mfma_f32_16x16x32_bf16 v[168:171], v[212:215], v[96:99], v[168:171]
    ds_read_b64_tr_b16 v[234:235], v5 offset:25600
    s_waitcnt lgkmcnt(4)
    v_mfma_f32_16x16x32_bf16 v[168:171], v[220:223], v[128:131], v[168:171]
    ds_read_b64_tr_b16 v[236:237], v4 offset:49152
    v_cvt_pk_bf16_f32 v84, v148, v149
    v_mfma_f32_16x16x32_bf16 v[168:171], v[224:227], v[144:147], v[168:171]
    ds_read_b64_tr_b16 v[238:239], v4 offset:50176
    v_subrev_u32 v6, 98304, v23
    v_subrev_u32 v7, 32768, v23
    v_cvt_pk_bf16_f32 v85, v150, v151
    v_mfma_f32_16x16x32_bf16 v[164:167], v[224:227], v[136:139], v[164:167]
    ds_read_b64_tr_b16 v[240:241], v4 offset:57344
    v_cvt_pk_bf16_f32 v86, v156, v157
    v_mfma_f32_16x16x32_bf16 v[164:167], v[220:223], v[120:123], v[164:167]
    ds_read_b64_tr_b16 v[242:243], v4 offset:58368
    s_waitcnt lgkmcnt(4)
    v_mfma_f32_16x16x32_bf16 v[164:167], v[228:231], v[32:35], v[164:167]
    ds_read_b64_tr_b16 v[212:213], v6 offset:49152
    v_cvt_pk_bf16_f32 v87, v158, v159
    v_mfma_f32_16x16x32_bf16 v[164:167], v[232:235], v[40:43], v[164:167]
    ds_read_b64_tr_b16 v[214:215], v6 offset:50176
    s_cmp_eq_u32 s87, 0
    s_cbranch_scc1 L_po00
    buffer_store_dwordx4 v[84:87], v12, s[44:47], s37 offen offset:0 sc1
L_pb00:
    v_mfma_f32_16x16x32_bf16 v[168:171], v[232:235], v[44:47], v[168:171]
    ds_read_b64_tr_b16 v[216:217], v6 offset:57344
    v_cvt_pk_bf16_f32 v92, v152, v153
    v_mfma_f32_16x16x32_bf16 v[168:171], v[228:231], v[36:39], v[168:171]
    ds_read_b64_tr_b16 v[218:219], v6 offset:58368
    s_waitcnt lgkmcnt(4)
    v_mfma_f32_16x16x32_bf16 v[168:171], v[236:239], v[244:247], v[168:171]
    ds_read_b64_tr_b16 v[220:221], v7 offset:16384
    v_cvt_pk_bf16_f32 v93, v154, v155
    v_mfma_f32_16x16x32_bf16 v[168:171], v[240:243], v[252:255], v[168:171]
    ds_read_b64_tr_b16 v[222:223], v7 offset:17408
    v_cvt_pk_bf16_f32 v94, v160, v161
    v_mfma_f32_16x16x32_bf16 v[164:167], v[240:243], v[248:251], v[164:167]
    ds_read_b64_tr_b16 v[224:225], v7 offset:24576
    v_cvt_pk_bf16_f32 v95, v162, v163
    v_mfma_f32_16x16x32_bf16 v[164:167], v[236:239], v[48:51], v[164:167]
    ds_read_b64_tr_b16 v[226:227], v7 offset:25600
    s_waitcnt lgkmcnt(4)
    v_mfma_f32_16x16x32_bf16 v[172:175], v[212:215], v[48:51], v[172:175]
    ds_read_b64_tr_b16 v[228:229], v6 offset:16384
    v_mfma_f32_16x16x32_bf16 v[172:175], v[216:219], v[248:251], v[172:175]
    ds_read_b64_tr_b16 v[230:231], v6 offset:17408
    s_cmp_eq_u32 s87, 1
    s_cbranch_scc1 L_po01
    buffer_store_dwordx4 v[92:95], v12, s[44:47], s64 offen offset:0 sc1
L_pb01:
    v_mfma_f32_16x16x32_bf16 v[176:179], v[216:219], v[252:255], v[176:179]
    ds_read_b64_tr_b16 v[232:233], v6 offset:24576
    v_mfma_f32_16x16x32_bf16 v[176:179], v[212:215], v[244:247], v[176:179]
    ds_read_b64_tr_b16 v[234:235], v6 offset:25600
    s_waitcnt lgkmcnt(4)
    v_mfma_f32_16x16x32_bf16 v[176:179], v[220:223], v[36:39], v[176:179]
    ds_read_b64_tr_b16 v[236:237], v6 offset:0
    v_mfma_f32_16x16x32_bf16 v[176:179], v[224:227], v[44:47], v[176:179]
    ds_read_b64_tr_b16 v[238:239], v6 offset:1024
    v_subrev_u32 v4, 98304, v24
    v_subrev_u32 v5, 32768, v24
    v_mfma_f32_16x16x32_bf16 v[172:175], v[224:227], v[40:43], v[172:175]
    ds_read_b64_tr_b16 v[240:241], v6 offset:8192
    v_mfma_f32_16x16x32_bf16 v[172:175], v[220:223], v[32:35], v[172:175]
    ds_read_b64_tr_b16 v[242:243], v6 offset:9216
    s_waitcnt lgkmcnt(4)
    v_mfma_f32_16x16x32_bf16 v[172:175], v[228:231], v[120:123], v[172:175]
    ds_read_b64_tr_b16 v[212:213], v4 offset:0
    v_mfma_f32_16x16x32_bf16 v[172:175], v[232:235], v[136:139], v[172:175]
    ds_read_b64_tr_b16 v[214:215], v4 offset:1024
    v_mfma_f32_16x16x32_bf16 v[176:179], v[232:235], v[144:147], v[176:179]
    ds_read_b64_tr_b16 v[216:217], v4 offset:8192
    v_mfma_f32_16x16x32_bf16 v[176:179], v[228:231], v[128:131], v[176:179]
    ds_read_b64_tr_b16 v[218:219], v4 offset:9216
    s_waitcnt lgkmcnt(4)
    v_mfma_f32_16x16x32_bf16 v[176:179], v[236:239], v[96:99], v[176:179]
    ds_read_b64_tr_b16 v[220:221], v4 offset:16384
    v_mfma_f32_16x16x32_bf16 v[176:179], v[240:243], v[112:115], v[176:179]
    ds_read_b64_tr_b16 v[222:223], v4 offset:17408
    v_mfma_f32_16x16x32_bf16 v[172:175], v[240:243], v[104:107], v[172:175]
    ds_read_b64_tr_b16 v[224:225], v4 offset:24576
    v_mfma_f32_16x16x32_bf16 v[172:175], v[236:239], v[88:91], v[172:175]
    ds_read_b64_tr_b16 v[226:227], v4 offset:25600
    s_waitcnt lgkmcnt(4)
    v_mfma_f32_16x16x32_bf16 v[180:183], v[212:215], v[88:91], v[180:183]
    ds_read_b64_tr_b16 v[228:229], v5 offset:16384
    v_mfma_f32_16x16x32_bf16 v[180:183], v[216:219], v[104:107], v[180:183]
    ds_read_b64_tr_b16 v[230:231], v5 offset:17408
    v_mfma_f32_16x16x32_bf16 v[184:187], v[216:219], v[112:115], v[184:187]
    ds_read_b64_tr_b16 v[232:233], v5 offset:24576
    v_mfma_f32_16x16x32_bf16 v[184:187], v[212:215], v[96:99], v[184:187]
    ds_read_b64_tr_b16 v[234:235], v5 offset:25600
    s_waitcnt lgkmcnt(4)
    v_mfma_f32_16x16x32_bf16 v[184:187], v[220:223], v[128:131], v[184:187]
    ds_read_b64_tr_b16 v[236:237], v4 offset:49152
    v_cvt_pk_bf16_f32 v100, v164, v165
    v_mfma_f32_16x16x32_bf16 v[184:187], v[224:227], v[144:147], v[184:187]
    ds_read_b64_tr_b16 v[238:239], v4 offset:50176
    v_subrev_u32 v6, 98304, v25
    v_subrev_u32 v7, 32768, v25
    v_cvt_pk_bf16_f32 v101, v166, v167
    v_mfma_f32_16x16x32_bf16 v[180:183], v[224:227], v[136:139], v[180:183]
    ds_read_b64_tr_b16 v[240:241], v4 offset:57344
    v_cvt_pk_bf16_f32 v102, v172, v173
    v_mfma_f32_16x16x32_bf16 v[180:183], v[220:223], v[120:123], v[180:183]
    ds_read_b64_tr_b16 v[242:243], v4 offset:58368
    s_waitcnt lgkmcnt(4)
    v_mfma_f32_16x16x32_bf16 v[180:183], v[228:231], v[32:35], v[180:183]
    ds_read_b64_tr_b16 v[212:213], v6 offset:49152
    v_cvt_pk_bf16_f32 v103, v174, v175
    v_mfma_f32_16x16x32_bf16 v[180:183], v[232:235], v[40:43], v[180:183]
    ds_read_b64_tr_b16 v[214:215], v6 offset:50176
    s_cmp_eq_u32 s87, 0
    s_cbranch_scc1 L_po10
    buffer_store_dwordx4 v[100:103], v12, s[44:47], s37 offen offset:1024 sc1
L_pb10:
    v_mfma_f32_16x16x32_bf16 v[184:187], v[232:235], v[44:47], v[184:187]
    ds_read_b64_tr_b16 v[216:217], v6 offset:57344
    v_cvt_pk_bf16_f32 v108, v168, v169
    v_mfma_f32_16x16x32_bf16 v[184:187], v[228:231], v[36:39], v[184:187]
    ds_read_b64_tr_b16 v[218:219], v6 offset:58368
    s_waitcnt lgkmcnt(4)
    v_mfma_f32_16x16x32_bf16 v[184:187], v[236:239], v[244:247], v[184:187]
    ds_read_b64_tr_b16 v[220:221], v7 offset:16384
    v_cvt_pk_bf16_f32 v109, v170, v171
    v_mfma_f32_16x16x32_bf16 v[184:187], v[240:243], v[252:255], v[184:187]
    ds_read_b64_tr_b16 v[222:223], v7 offset:17408
    v_cvt_pk_bf16_f32 v110, v176, v177
    v_mfma_f32_16x16x32_bf16 v[180:183], v[240:243], v[248:251], v[180:183]
    ds_read_b64_tr_b16 v[224:225], v7 offset:24576
    v_cvt_pk_bf16_f32 v111, v178, v179
    v_mfma_f32_16x16x32_bf16 v[180:183], v[236:239], v[48:51], v[180:183]
    ds_read_b64_tr_b16 v[226:227], v7 offset:25600
    s_waitcnt lgkmcnt(4)
    v_mfma_f32_16x16x32_bf16 v[188:191], v[212:215], v[48:51], v[188:191]
    ds_read_b64_tr_b16 v[228:229], v6 offset:16384
    v_mfma_f32_16x16x32_bf16 v[188:191], v[216:219], v[248:251], v[188:191]
    ds_read_b64_tr_b16 v[230:231], v6 offset:17408
    s_cmp_eq_u32 s87, 1
    s_cbranch_scc1 L_po11
    buffer_store_dwordx4 v[108:111], v12, s[44:47], s64 offen offset:1024 sc1
L_pb11:
    v_mfma_f32_16x16x32_bf16 v[192:195], v[216:219], v[252:255], v[192:195]
    ds_read_b64_tr_b16 v[232:233], v6 offset:24576
    v_mfma_f32_16x16x32_bf16 v[192:195], v[212:215], v[244:247], v[192:195]
    ds_read_b64_tr_b16 v[234:235], v6 offset:25600
    s_waitcnt lgkmcnt(4)
    v_mfma_f32_16x16x32_bf16 v[192:195], v[220:223], v[36:39], v[192:195]
    ds_read_b64_tr_b16 v[236:237], v6 offset:0
    v_mfma_f32_16x16x32_bf16 v[192:195], v[224:227], v[44:47], v[192:195]
    ds_read_b64_tr_b16 v[238:239], v6 offset:1024
    v_subrev_u32 v4, 98304, v26
    v_subrev_u32 v5, 32768, v26
    v_mfma_f32_16x16x32_bf16 v[188:191], v[224:227], v[40:43], v[188:191]
    ds_read_b64_tr_b16 v[240:241], v6 offset:8192
    v_mfma_f32_16x16x32_bf16 v[188:191], v[220:223], v[32:35], v[188:191]
    ds_read_b64_tr_b16 v[242:243], v6 offset:9216
    s_waitcnt lgkmcnt(4)
    v_mfma_f32_16x16x32_bf16 v[188:191], v[228:231], v[120:123], v[188:191]
    ds_read_b64_tr_b16 v[212:213], v4 offset:0
    v_mfma_f32_16x16x32_bf16 v[188:191], v[232:235], v[136:139], v[188:191]
    ds_read_b64_tr_b16 v[214:215], v4 offset:1024
    v_mfma_f32_16x16x32_bf16 v[192:195], v[232:235], v[144:147], v[192:195]
    ds_read_b64_tr_b16 v[216:217], v4 offset:8192
    v_mfma_f32_16x16x32_bf16 v[192:195], v[228:231], v[128:131], v[192:195]
    ds_read_b64_tr_b16 v[218:219], v4 offset:9216
    s_waitcnt lgkmcnt(4)
    v_mfma_f32_16x16x32_bf16 v[192:195], v[236:239], v[96:99], v[192:195]
    ds_read_b64_tr_b16 v[220:221], v4 offset:16384
    v_mfma_f32_16x16x32_bf16 v[192:195], v[240:243], v[112:115], v[192:195]
    ds_read_b64_tr_b16 v[222:223], v4 offset:17408
    v_mfma_f32_16x16x32_bf16 v[188:191], v[240:243], v[104:107], v[188:191]
    ds_read_b64_tr_b16 v[224:225], v4 offset:24576
    v_mfma_f32_16x16x32_bf16 v[188:191], v[236:239], v[88:91], v[188:191]
    ds_read_b64_tr_b16 v[226:227], v4 offset:25600
    s_waitcnt lgkmcnt(4)
    v_mfma_f32_16x16x32_bf16 v[196:199], v[212:215], v[88:91], v[196:199]
    ds_read_b64_tr_b16 v[228:229], v5 offset:16384
    v_mfma_f32_16x16x32_bf16 v[196:199], v[216:219], v[104:107], v[196:199]
    ds_read_b64_tr_b16 v[230:231], v5 offset:17408
    v_mfma_f32_16x16x32_bf16 v[200:203], v[216:219], v[112:115], v[200:203]
    ds_read_b64_tr_b16 v[232:233], v5 offset:24576
    v_mfma_f32_16x16x32_bf16 v[200:203], v[212:215], v[96:99], v[200:203]
    ds_read_b64_tr_b16 v[234:235], v5 offset:25600
    s_waitcnt lgkmcnt(4)
    v_mfma_f32_16x16x32_bf16 v[200:203], v[220:223], v[128:131], v[200:203]
    ds_read_b64_tr_b16 v[236:237], v4 offset:49152
    v_cvt_pk_bf16_f32 v84, v180, v181
    v_mfma_f32_16x16x32_bf16 v[200:203], v[224:227], v[144:147], v[200:203]
    ds_read_b64_tr_b16 v[238:239], v4 offset:50176
    v_subrev_u32 v6, 98304, v27
    v_subrev_u32 v7, 32768, v27
    v_cvt_pk_bf16_f32 v85, v182, v183
    v_mfma_f32_16x16x32_bf16 v[196:199], v[224:227], v[136:139], v[196:199]
    ds_read_b64_tr_b16 v[240:241], v4 offset:57344
    v_cvt_pk_bf16_f32 v86, v188, v189
    v_mfma_f32_16x16x32_bf16 v[196:199], v[220:223], v[120:123], v[196:199]
    ds_read_b64_tr_b16 v[242:243], v4 offset:58368
    s_waitcnt lgkmcnt(4)
    v_mfma_f32_16x16x32_bf16 v[196:199], v[228:231], v[32:35], v[196:199]
    ds_read_b64_tr_b16 v[212:213], v6 offset:49152
    v_cvt_pk_bf16_f32 v87, v190, v191
    v_mfma_f32_16x16x32_bf16 v[196:199], v[232:235], v[40:43], v[196:199]
    ds_read_b64_tr_b16 v[214:215], v6 offset:50176
    s_cmp_eq_u32 s87, 0
    s_cbranch_scc1 L_po20
    buffer_store_dwordx4 v[84:87], v12, s[44:47], s37 offen offset:2048 sc1
L_pb20:
    v_mfma_f32_16x16x32_bf16 v[200:203], v[232:235], v[44:47], v[200:203]
    ds_read_b64_tr_b16 v[216:217], v6 offset:57344
    v_cvt_pk_bf16_f32 v92, v184, v185
    v_mfma_f32_16x16x32_bf16 v[200:203], v[228:231], v[36:39], v[200:203]
    ds_read_b64_tr_b16 v[218:219], v6 offset:58368
    s_waitcnt lgkmcnt(4)
    v_mfma_f32_16x16x32_bf16 v[200:203], v[236:239], v[244:247], v[200:203]
    ds_read_b64_tr_b16 v[220:221], v7 offset:16384
    v_cvt_pk_bf16_f32 v93, v186, v187
    v_mfma_f32_16x16x32_bf16 v[200:203], v[240:243], v[252:255], v[200:203]
    ds_read_b64_tr_b16 v[222:223], v7 offset:17408
    v_cvt_pk_bf16_f32 v94, v192, v193
    v_mfma_f32_16x16x32_bf16 v[196:199], v[240:243], v[248:251], v[196:199]
    ds_read_b64_tr_b16 v[224:225], v7 offset:24576
    v_cvt_pk_bf16_f32 v95, v194, v195
    v_mfma_f32_16x16x32_bf16 v[196:199], v[236:239], v[48:51], v[196:199]
    ds_read_b64_tr_b16 v[226:227], v7 offset:25600
    s_waitcnt lgkmcnt(4)
    v_mfma_f32_16x16x32_bf16 v[204:207], v[212:215], v[48:51], v[204:207]
    ds_read_b64_tr_b16 v[228:229], v6 offset:16384
    v_mfma_f32_16x16x32_bf16 v[204:207], v[216:219], v[248:251], v[204:207]
    ds_read_b64_tr_b16 v[230:231], v6 offset:17408
    s_cmp_eq_u32 s87, 1
    s_cbranch_scc1 L_po21
    buffer_store_dwordx4 v[92:95], v12, s[44:47], s64 offen offset:2048 sc1
L_pb21:
    v_mfma_f32_16x16x32_bf16 v[208:211], v[216:219], v[252:255], v[208:211]
    ds_read_b64_tr_b16 v[232:233], v6 offset:24576
    v_mfma_f32_16x16x32_bf16 v[208:211], v[212:215], v[244:247], v[208:211]
    ds_read_b64_tr_b16 v[234:235], v6 offset:25600
    s_waitcnt lgkmcnt(4)
    v_mfma_f32_16x16x32_bf16 v[208:211], v[220:223], v[36:39], v[208:211]
    ds_read_b64_tr_b16 v[236:237], v6 offset:0
    v_mfma_f32_16x16x32_bf16 v[208:211], v[224:227], v[44:47], v[208:211]
    ds_read_b64_tr_b16 v[238:239], v6 offset:1024
    v_mfma_f32_16x16x32_bf16 v[204:207], v[224:227], v[40:43], v[204:207]
    ds_read_b64_tr_b16 v[240:241], v6 offset:8192
    v_mfma_f32_16x16x32_bf16 v[204:207], v[220:223], v[32:35], v[204:207]
    ds_read_b64_tr_b16 v[242:243], v6 offset:9216
    s_waitcnt lgkmcnt(4)
    v_mfma_f32_16x16x32_bf16 v[204:207], v[228:231], v[120:123], v[204:207]
    v_mfma_f32_16x16x32_bf16 v[204:207], v[232:235], v[136:139], v[204:207]
    v_mfma_f32_16x16x32_bf16 v[208:211], v[232:235], v[144:147], v[208:211]
    v_mfma_f32_16x16x32_bf16 v[208:211], v[228:231], v[128:131], v[208:211]
    s_waitcnt lgkmcnt(0)
    v_mfma_f32_16x16x32_bf16 v[208:211], v[236:239], v[96:99], v[208:211]
    v_mfma_f32_16x16x32_bf16 v[208:211], v[240:243], v[112:115], v[208:211]
    v_mfma_f32_16x16x32_bf16 v[204:207], v[240:243], v[104:107], v[204:207]
    v_mfma_f32_16x16x32_bf16 v[204:207], v[236:239], v[88:91], v[204:207]
    s_lshl_b32 s3, 1, s60
    v_mov_b32 v4, s3
    s_nop 5
    v_cvt_pk_bf16_f32 v100, v196, v197
    v_cvt_pk_bf16_f32 v101, v198, v199
    v_cvt_pk_bf16_f32 v102, v204, v205
    v_cvt_pk_bf16_f32 v103, v206, v207
    s_cmp_eq_u32 s87, 0
    s_cbranch_scc1 L_po30
    buffer_store_dwordx4 v[100:103], v12, s[44:47], s37 offen offset:3072 sc1
L_pb30:
    v_cvt_pk_bf16_f32 v108, v200, v201
    v_cvt_pk_bf16_f32 v109, v202, v203
    v_cvt_pk_bf16_f32 v110, v208, v209
    v_cvt_pk_bf16_f32 v111, v210, v211
    s_cmp_eq_u32 s87, 1
    s_cbranch_scc1 L_po31
    buffer_store_dwordx4 v[108:111], v12, s[44:47], s64 offen offset:3072 sc1
L_pb31:
    s_waitcnt lgkmcnt(0)
    s_barrier
    s_waitcnt vmcnt(0)
    s_mov_b64 exec, 3
    buffer_store_dword v4, v11, s[40:43], s67 offen sc1
    s_endpgm
L_po00:
    ds_write_b128 v13, v[84:87] offset:0
    s_branch L_pb00
L_po01:
    ds_write_b128 v13, v[92:95] offset:0
    s_branch L_pb01
L_po10:
    ds_write_b128 v13, v[100:103] offset:1024
    s_branch L_pb10
L_po11:
    ds_write_b128 v13, v[108:111] offset:1024
    s_branch L_pb11
L_po20:
    ds_write_b128 v13, v[84:87] offset:2048
    s_branch L_pb20
L_po21:
    ds_write_b128 v13, v[92:95] offset:2048
    s_branch L_pb21
L_po30:
    ds_write_b128 v13, v[100:103] offset:3072
    s_branch L_pb30
L_po31:
    ds_write_b128 v13, v[108:111] offset:3072
    s_branch L_pb31
L_clear:
    v_mov_b32 v248, 0
    v_mov_b32 v249, 0
    v_mov_b32 v250, 0
    v_mov_b32 v251, 0
    v_lshrrev_b32 v244, 3, v0
    v_mul_u32_u24 v244, 256, v244
    v_and_b32 v245, 7, v0
    v_lshlrev_b32 v245, 4, v245
    v_add_u32 v244, v244, v245
    s_add_u32 s3, s66, 2048
    buffer_store_dwordx4 v[248:251], v244, s[40:43], s66 offen sc1
    buffer_store_dwordx4 v[248:251], v244, s[40:43], s3 offen sc1
    s_branch L_cleared
L_mark:
    v_mov_b32 v244, s82
    v_mov_b32 v245, 1
    s_mov_b64 exec, 1
    s_waitcnt vmcnt(0)
    global_store_dword v244, v245, s[78:79] sc1
    s_mov_b64 exec, -1
    s_branch L_marked
L_rare1:
    s_mov_b32 s16, 65536
    s_call_b64 s[38:39], L_redo1
    s_branch L_back1
L_rare2:
    s_mov_b32 s16, 32768
    s_call_b64 s[38:39], L_redo0
    s_branch L_back2
L_rare3:
    s_mov_b32 s16, 98304
    s_call_b64 s[38:39], L_redo1
    s_branch L_back3
L_rare4:
    s_mov_b32 s16, 131072
    s_call_b64 s[38:39], L_redo0
    s_branch L_back4
L_rare5:
    s_mov_b32 s16, 196608
    s_call_b64 s[38:39], L_redo1
    s_branch L_back5
L_rare6:
    s_mov_b32 s16, 163840
    s_call_b64 s[38:39], L_redo0
    s_branch L_back6
L_rare7:
    s_mov_b32 s16, 229376
    s_call_b64 s[38:39], L_redo1
    s_branch L_back7
L_rare8:
    s_mov_b32 s16, 16384
    s_call_b64 s[38:39], L_redo0
    s_branch L_back8
L_rare9:
    s_mov_b32 s16, 81920
    s_call_b64 s[38:39], L_redo1
    s_branch L_back9
L_rare10:
    s_mov_b32 s16, 49152
    s_call_b64 s[38:39], L_redo0
    s_branch L_back10
L_rare11:
    s_mov_b32 s16, 114688
    s_call_b64 s[38:39], L_redo1
    s_branch L_back11
L_rare12:
    s_mov_b32 s16, 147456
    s_call_b64 s[38:39], L_redo0
    s_branch L_back12
L_rare13:
    s_mov_b32 s16, 212992
    s_call_b64 s[38:39], L_redo1
    s_branch L_back13
L_rare14:
    s_mov_b32 s16, 180224
    s_call_b64 s[38:39], L_redo0
    s_branch L_back14
L_rare15:
    s_mov_b32 s16, 245760
    s_call_b64 s[38:39], L_redo2
    s_branch L_back15
L_redo0:
    s_add_u32 s17, s16, 8192
    buffer_load_dwordx4 v[228:231], v10, s[8:11], s16 offen offset:0
    buffer_load_dwordx4 v[232:235], v10, s[8:11], s16 offen offset:64
    buffer_load_dwordx4 v[236:239], v10, s[8:11], s16 offen offset:128
    buffer_load_dwordx4 v[240:243], v10, s[8:11], s16 offen offset:192
    s_waitcnt vmcnt(0)
    v_mfma_f32_16x16x32_bf16 v[148:151], v[228:231], v[52:55], v[36:39]
    v_mfma_f32_16x16x32_bf16 v[148:151], v[232:235], v[60:63], v[148:151]
    v_mfma_f32_16x16x32_bf16 v[148:151], v[236:239], v[68:71], v[148:151]
    v_mfma_f32_16x16x32_bf16 v[148:151], v[240:243], v[76:79], v[148:151]
    v_mfma_f32_16x16x32_bf16 v[156:159], v[228:231], v[56:59], v[40:43]
    v_mfma_f32_16x16x32_bf16 v[156:159], v[232:235], v[64:67], v[156:159]
    v_mfma_f32_16x16x32_bf16 v[156:159], v[236:239], v[72:75], v[156:159]
    v_mfma_f32_16x16x32_bf16 v[156:159], v[240:243], v[80:83], v[156:159]
    buffer_load_dwordx4 v[228:231], v10, s[8:11], s16 offen offset:1024
    buffer_load_dwordx4 v[232:235], v10, s[8:11], s16 offen offset:1088
    buffer_load_dwordx4 v[236:239], v10, s[8:11], s16 offen offset:1152
    buffer_load_dwordx4 v[240:243], v10, s[8:11], s16 offen offset:1216
    s_waitcnt vmcnt(0)
    v_mfma_f32_16x16x32_bf16 v[152:155], v[228:231], v[52:55], v[36:39]
    v_mfma_f32_16x16x32_bf16 v[152:155], v[232:235], v[60:63], v[152:155]
    v_mfma_f32_16x16x32_bf16 v[152:155], v[236:239], v[68:71], v[152:155]
    v_mfma_f32_16x16x32_bf16 v[152:155], v[240:243], v[76:79], v[152:155]
    v_mfma_f32_16x16x32_bf16 v[160:163], v[228:231], v[56:59], v[40:43]
    v_mfma_f32_16x16x32_bf16 v[160:163], v[232:235], v[64:67], v[160:163]
    v_mfma_f32_16x16x32_bf16 v[160:163], v[236:239], v[72:75], v[160:163]
    v_mfma_f32_16x16x32_bf16 v[160:163], v[240:243], v[80:83], v[160:163]
    buffer_load_dwordx4 v[228:231], v10, s[8:11], s17 offen offset:0
    buffer_load_dwordx4 v[232:235], v10, s[8:11], s17 offen offset:64
    buffer_load_dwordx4 v[236:239], v10, s[8:11], s17 offen offset:128
    buffer_load_dwordx4 v[240:243], v10, s[8:11], s17 offen offset:192
    s_waitcnt vmcnt(0)
    v_mfma_f32_16x16x32_bf16 v[164:167], v[228:231], v[52:55], v[36:39]
    v_mfma_f32_16x16x32_bf16 v[164:167], v[232:235], v[60:63], v[164:167]
    v_mfma_f32_16x16x32_bf16 v[164:167], v[236:239], v[68:71], v[164:167]
    v_mfma_f32_16x16x32_bf16 v[164:167], v[240:243], v[76:79], v[164:167]
    v_mfma_f32_16x16x32_bf16 v[172:175], v[228:231], v[56:59], v[40:43]
    v_mfma_f32_16x16x32_bf16 v[172:175], v[232:235], v[64:67], v[172:175]
    v_mfma_f32_16x16x32_bf16 v[172:175], v[236:239], v[72:75], v[172:175]
    v_mfma_f32_16x16x32_bf16 v[172:175], v[240:243], v[80:83], v[172:175]
    buffer_load_dwordx4 v[228:231], v10, s[8:11], s17 offen offset:1024
    buffer_load_dwordx4 v[232:235], v10, s[8:11], s17 offen offset:1088
    buffer_load_dwordx4 v[236:239], v10, s[8:11], s17 offen offset:1152
    buffer_load_dwordx4 v[240:243], v10, s[8:11], s17 offen offset:1216
    s_waitcnt vmcnt(0)
    v_mfma_f32_16x16x32_bf16 v[168:171], v[228:231], v[52:55], v[36:39]
    v_mfma_f32_16x16x32_bf16 v[168:171], v[232:235], v[60:63], v[168:171]
    v_mfma_f32_16x16x32_bf16 v[168:171], v[236:239], v[68:71], v[168:171]
    v_mfma_f32_16x16x32_bf16 v[168:171], v[240:243], v[76:79], v[168:171]
    v_mfma_f32_16x16x32_bf16 v[176:179], v[228:231], v[56:59], v[40:43]
    v_mfma_f32_16x16x32_bf16 v[176:179], v[232:235], v[64:67], v[176:179]
    v_mfma_f32_16x16x32_bf16 v[176:179], v[236:239], v[72:75], v[176:179]
    v_mfma_f32_16x16x32_bf16 v[176:179], v[240:243], v[80:83], v[176:179]
    s_nop 7
    v_max3_f32 v1, v148, v149, v150
    v_max3_f32 v2, v156, v157, v158
    v_max3_f32 v1, v1, v151, v152
    v_max3_f32 v2, v2, v159, v160
    v_max3_f32 v1, v1, v153, v154
    v_max3_f32 v2, v2, v161, v162
    v_max3_f32 v1, v1, v155, v164
    v_max3_f32 v2, v2, v163, v172
    v_max3_f32 v1, v1, v165, v166
    v_max3_f32 v2, v2, v173, v174
    v_max3_f32 v1, v1, v167, v168
    v_max3_f32 v2, v2, v175, v176
    v_max3_f32 v1, v1, v169, v170
    v_max3_f32 v2, v2, v177, v178
    v_max_f32 v1, v1, v171
    v_max_f32 v2, v2, v179
    v_mov_b32 v3, v1
    v_mov_b32 v30, v2
    s_nop 1
    v_permlane32_swap_b32 v1, v3
    v_permlane32_swap_b32 v2, v30
    v_max_f32 v1, v1, v3
    v_max_f32 v2, v2, v30
    v_mov_b32 v3, v1
    v_mov_b32 v30, v2
    s_nop 1
    v_permlane16_swap_b32 v1, v3
    v_permlane16_swap_b32 v2, v30
    v_max3_f32 v1, v1, v3, 0
    v_max3_f32 v2, v2, v30, 0
    v_exp_f32 v3, -v1
    v_exp_f32 v30, -v2
    v_sub_f32 v36, v36, v1
    v_sub_f32 v37, v37, v1
    v_sub_f32 v38, v38, v1
    v_sub_f32 v39, v39, v1
    v_sub_f32 v40, v40, v2
    v_sub_f32 v41, v41, v2
    v_sub_f32 v42, v42, v2
    v_sub_f32 v43, v43, v2
    v_sub_f32 v148, v148, v1
    v_sub_f32 v149, v149, v1
    v_sub_f32 v150, v150, v1
    v_sub_f32 v151, v151, v1
    v_sub_f32 v152, v152, v1
    v_sub_f32 v153, v153, v1
    v_sub_f32 v154, v154, v1
    v_sub_f32 v155, v155, v1
    v_sub_f32 v156, v156, v2
    v_sub_f32 v157, v157, v2
    v_sub_f32 v158, v158, v2
    v_sub_f32 v159, v159, v2
    v_sub_f32 v160, v160, v2
    v_sub_f32 v161, v161, v2
    v_sub_f32 v162, v162, v2
    v_sub_f32 v163, v163, v2
    v_sub_f32 v164, v164, v1
    v_sub_f32 v165, v165, v1
    v_sub_f32 v166, v166, v1
    v_sub_f32 v167, v167, v1
    v_sub_f32 v168, v168, v1
    v_sub_f32 v169, v169, v1
    v_sub_f32 v170, v170, v1
    v_sub_f32 v171, v171, v1
    v_sub_f32 v172, v172, v2
    v_sub_f32 v173, v173, v2
    v_sub_f32 v174, v174, v2
    v_sub_f32 v175, v175, v2
    v_sub_f32 v176, v176, v2
    v_sub_f32 v177, v177, v2
    v_sub_f32 v178, v178, v2
    v_sub_f32 v179, v179, v2
    v_sub_f32 v180, v180, v1
    v_sub_f32 v181, v181, v1
    v_sub_f32 v182, v182, v1
    v_sub_f32 v183, v183, v1
    v_sub_f32 v184, v184, v1
    v_sub_f32 v185, v185, v1
    v_sub_f32 v186, v186, v1
    v_sub_f32 v187, v187, v1
    v_sub_f32 v188, v188, v2
    v_sub_f32 v189, v189, v2
    v_sub_f32 v190, v190, v2
    v_sub_f32 v191, v191, v2
    v_sub_f32 v192, v192, v2
    v_sub_f32 v193, v193, v2
    v_sub_f32 v194, v194, v2
    v_sub_f32 v195, v195, v2
    v_sub_f32 v196, v196, v1
    v_sub_f32 v197, v197, v1
    v_sub_f32 v198, v198, v1
    v_sub_f32 v199, v199, v1
    v_sub_f32 v200, v200, v1
    v_sub_f32 v201, v201, v1
    v_sub_f32 v202, v202, v1
    v_sub_f32 v203, v203, v1
    v_sub_f32 v204, v204, v2
    v_sub_f32 v205, v205, v2
    v_sub_f32 v206, v206, v2
    v_sub_f32 v207, v207, v2
    v_sub_f32 v208, v208, v2
    v_sub_f32 v209, v209, v2
    v_sub_f32 v210, v210, v2
    v_sub_f32 v211, v211, v2
    v_mul_f32 v248, v3, v248
    v_mul_f32 v249, v3, v249
    v_mul_f32 v250, v3, v250
    v_mul_f32 v251, v3, v251
    v_mul_f32 v84, v3, v84
    v_mul_f32 v85, v3, v85
    v_mul_f32 v86, v3, v86
    v_mul_f32 v87, v3, v87
    v_mul_f32 v88, v3, v88
    v_mul_f32 v89, v3, v89
    v_mul_f32 v90, v3, v90
    v_mul_f32 v91, v3, v91
    v_mul_f32 v100, v3, v100
    v_mul_f32 v101, v3, v101
    v_mul_f32 v102, v3, v102
    v_mul_f32 v103, v3, v103
    v_mul_f32 v104, v3, v104
    v_mul_f32 v105, v3, v105
    v_mul_f32 v106, v3, v106
    v_mul_f32 v107, v3, v107
    v_mul_f32 v116, v3, v116
    v_mul_f32 v117, v3, v117
    v_mul_f32 v118, v3, v118
    v_mul_f32 v119, v3, v119
    v_mul_f32 v120, v3, v120
    v_mul_f32 v121, v3, v121
    v_mul_f32 v122, v3, v122
    v_mul_f32 v123, v3, v123
    v_mul_f32 v132, v3, v132
    v_mul_f32 v133, v3, v133
    v_mul_f32 v134, v3, v134
    v_mul_f32 v135, v3, v135
    v_mul_f32 v136, v3, v136
    v_mul_f32 v137, v3, v137
    v_mul_f32 v138, v3, v138
    v_mul_f32 v139, v3, v139
    v_mul_f32 v252, v30, v252
    v_mul_f32 v253, v30, v253
    v_mul_f32 v254, v30, v254
    v_mul_f32 v255, v30, v255
    v_mul_f32 v92, v30, v92
    v_mul_f32 v93, v30, v93
    v_mul_f32 v94, v30, v94
    v_mul_f32 v95, v30, v95
    v_mul_f32 v96, v30, v96
    v_mul_f32 v97, v30, v97
    v_mul_f32 v98, v30, v98
    v_mul_f32 v99, v30, v99
    v_mul_f32 v108, v30, v108
    v_mul_f32 v109, v30, v109
    v_mul_f32 v110, v30, v110
    v_mul_f32 v111, v30, v111
    v_mul_f32 v112, v30, v112
    v_mul_f32 v113, v30, v113
    v_mul_f32 v114, v30, v114
    v_mul_f32 v115, v30, v115
    v_mul_f32 v124, v30, v124
    v_mul_f32 v125, v30, v125
    v_mul_f32 v126, v30, v126
    v_mul_f32 v127, v30, v127
    v_mul_f32 v128, v30, v128
    v_mul_f32 v129, v30, v129
    v_mul_f32 v130, v30, v130
    v_mul_f32 v131, v30, v131
    v_mul_f32 v140, v30, v140
    v_mul_f32 v141, v30, v141
    v_mul_f32 v142, v30, v142
    v_mul_f32 v143, v30, v143
    v_mul_f32 v144, v30, v144
    v_mul_f32 v145, v30, v145
    v_mul_f32 v146, v30, v146
    v_mul_f32 v147, v30, v147
    v_exp_f32 v148, v148
    v_exp_f32 v149, v149
    v_exp_f32 v150, v150
    v_exp_f32 v151, v151
    v_exp_f32 v152, v152
    v_exp_f32 v153, v153
    v_exp_f32 v154, v154
    v_exp_f32 v155, v155
    v_exp_f32 v156, v156
    v_exp_f32 v157, v157
    v_exp_f32 v158, v158
    v_exp_f32 v159, v159
    v_exp_f32 v160, v160
    v_exp_f32 v161, v161
    v_exp_f32 v162, v162
    v_exp_f32 v163, v163
    v_exp_f32 v164, v164
    v_exp_f32 v165, v165
    v_exp_f32 v166, v166
    v_exp_f32 v167, v167
    v_exp_f32 v168, v168
    v_exp_f32 v169, v169
    v_exp_f32 v170, v170
    v_exp_f32 v171, v171
    v_exp_f32 v172, v172
    v_exp_f32 v173, v173
    v_exp_f32 v174, v174
    v_exp_f32 v175, v175
    v_exp_f32 v176, v176
    v_exp_f32 v177, v177
    v_exp_f32 v178, v178
    v_exp_f32 v179, v179
    v_cvt_pk_bf16_f32 v148, v148, v149
    v_cvt_pk_bf16_f32 v149, v150, v151
    v_cvt_pk_bf16_f32 v150, v152, v153
    v_cvt_pk_bf16_f32 v151, v154, v155
    v_cvt_pk_bf16_f32 v156, v156, v157
    v_cvt_pk_bf16_f32 v157, v158, v159
    v_cvt_pk_bf16_f32 v158, v160, v161
    v_cvt_pk_bf16_f32 v159, v162, v163
    v_cvt_pk_bf16_f32 v164, v164, v165
    v_cvt_pk_bf16_f32 v165, v166, v167
    v_cvt_pk_bf16_f32 v166, v168, v169
    v_cvt_pk_bf16_f32 v167, v170, v171
    v_cvt_pk_bf16_f32 v172, v172, v173
    v_cvt_pk_bf16_f32 v173, v174, v175
    v_cvt_pk_bf16_f32 v174, v176, v177
    v_cvt_pk_bf16_f32 v175, v178, v179
    v_mfma_f32_16x16x32_bf16 v[44:47], v[32:35], v[148:151], v[248:251]
    v_mfma_f32_16x16x32_bf16 v[44:47], v[32:35], v[164:167], v[44:47]
    v_mfma_f32_16x16x32_bf16 v[48:51], v[32:35], v[156:159], v[252:255]
    v_mfma_f32_16x16x32_bf16 v[48:51], v[32:35], v[172:175], v[48:51]
    s_nop 7
    s_setpc_b64 s[38:39]
L_redo1:
    s_add_u32 s17, s16, 8192
    buffer_load_dwordx4 v[228:231], v10, s[8:11], s16 offen offset:0
    buffer_load_dwordx4 v[232:235], v10, s[8:11], s16 offen offset:64
    buffer_load_dwordx4 v[236:239], v10, s[8:11], s16 offen offset:128
    buffer_load_dwordx4 v[240:243], v10, s[8:11], s16 offen offset:192
    s_waitcnt vmcnt(0)
    v_mfma_f32_16x16x32_bf16 v[180:183], v[228:231], v[52:55], v[36:39]
    v_mfma_f32_16x16x32_bf16 v[180:183], v[232:235], v[60:63], v[180:183]
    v_mfma_f32_16x16x32_bf16 v[180:183], v[236:239], v[68:71], v[180:183]
    v_mfma_f32_16x16x32_bf16 v[180:183], v[240:243], v[76:79], v[180:183]
    v_mfma_f32_16x16x32_bf16 v[188:191], v[228:231], v[56:59], v[40:43]
    v_mfma_f32_16x16x32_bf16 v[188:191], v[232:235], v[64:67], v[188:191]
    v_mfma_f32_16x16x32_bf16 v[188:191], v[236:239], v[72:75], v[188:191]
    v_mfma_f32_16x16x32_bf16 v[188:191], v[240:243], v[80:83], v[188:191]
    buffer_load_dwordx4 v[228:231], v10, s[8:11], s16 offen offset:1024
    buffer_load_dwordx4 v[232:235], v10, s[8:11], s16 offen offset:1088
    buffer_load_dwordx4 v[236:239], v10, s[8:11], s16 offen offset:1152
    buffer_load_dwordx4 v[240:243], v10, s[8:11], s16 offen offset:1216
    s_waitcnt vmcnt(0)
    v_mfma_f32_16x16x32_bf16 v[184:187], v[228:231], v[52:55], v[36:39]
    v_mfma_f32_16x16x32_bf16 v[184:187], v[232:235], v[60:63], v[184:187]
    v_mfma_f32_16x16x32_bf16 v[184:187], v[236:239], v[68:71], v[184:187]
    v_mfma_f32_16x16x32_bf16 v[184:187], v[240:243], v[76:79], v[184:187]
    v_mfma_f32_16x16x32_bf16 v[192:195], v[228:231], v[56:59], v[40:43]
    v_mfma_f32_16x16x32_bf16 v[192:195], v[232:235], v[64:67], v[192:195]
    v_mfma_f32_16x16x32_bf16 v[192:195], v[236:239], v[72:75], v[192:195]
    v_mfma_f32_16x16x32_bf16 v[192:195], v[240:243], v[80:83], v[192:195]
    buffer_load_dwordx4 v[228:231], v10, s[8:11], s17 offen offset:0
    buffer_load_dwordx4 v[232:235], v10, s[8:11], s17 offen offset:64
    buffer_load_dwordx4 v[236:239], v10, s[8:11], s17 offen offset:128
    buffer_load_dwordx4 v[240:243], v10, s[8:11], s17 offen offset:192
    s_waitcnt vmcnt(0)
    v_mfma_f32_16x16x32_bf16 v[196:199], v[228:231], v[52:55], v[36:39]
    v_mfma_f32_16x16x32_bf16 v[196:199], v[232:235], v[60:63], v[196:199]
    v_mfma_f32_16x16x32_bf16 v[196:199], v[236:239], v[68:71], v[196:199]
    v_mfma_f32_16x16x32_bf16 v[196:199], v[240:243], v[76:79], v[196:199]
    v_mfma_f32_16x16x32_bf16 v[204:207], v[228:231], v[56:59], v[40:43]
    v_mfma_f32_16x16x32_bf16 v[204:207], v[232:235], v[64:67], v[204:207]
    v_mfma_f32_16x16x32_bf16 v[204:207], v[236:239], v[72:75], v[204:207]
    v_mfma_f32_16x16x32_bf16 v[204:207], v[240:243], v[80:83], v[204:207]
    buffer_load_dwordx4 v[228:231], v10, s[8:11], s17 offen offset:1024
    buffer_load_dwordx4 v[232:235], v10, s[8:11], s17 offen offset:1088
    buffer_load_dwordx4 v[236:239], v10, s[8:11], s17 offen offset:1152
    buffer_load_dwordx4 v[240:243], v10, s[8:11], s17 offen offset:1216
    s_waitcnt vmcnt(0)
    v_mfma_f32_16x16x32_bf16 v[200:203], v[228:231], v[52:55], v[36:39]
    v_mfma_f32_16x16x32_bf16 v[200:203], v[232:235], v[60:63], v[200:203]
    v_mfma_f32_16x16x32_bf16 v[200:203], v[236:239], v[68:71], v[200:203]
    v_mfma_f32_16x16x32_bf16 v[200:203], v[240:243], v[76:79], v[200:203]
    v_mfma_f32_16x16x32_bf16 v[208:211], v[228:231], v[56:59], v[40:43]
    v_mfma_f32_16x16x32_bf16 v[208:211], v[232:235], v[64:67], v[208:211]
    v_mfma_f32_16x16x32_bf16 v[208:211], v[236:239], v[72:75], v[208:211]
    v_mfma_f32_16x16x32_bf16 v[208:211], v[240:243], v[80:83], v[208:211]
    s_nop 7
    v_max3_f32 v1, v180, v181, v182
    v_max3_f32 v2, v188, v189, v190
    v_max3_f32 v1, v1, v183, v184
    v_max3_f32 v2, v2, v191, v192
    v_max3_f32 v1, v1, v185, v186
    v_max3_f32 v2, v2, v193, v194
    v_max3_f32 v1, v1, v187, v196
    v_max3_f32 v2, v2, v195, v204
    v_max3_f32 v1, v1, v197, v198
    v_max3_f32 v2, v2, v205, v206
    v_max3_f32 v1, v1, v199, v200
    v_max3_f32 v2, v2, v207, v208
    v_max3_f32 v1, v1, v201, v202
    v_max3_f32 v2, v2, v209, v210
    v_max_f32 v1, v1, v203
    v_max_f32 v2, v2, v211
    v_mov_b32 v3, v1
    v_mov_b32 v30, v2
    s_nop 1
    v_permlane32_swap_b32 v1, v3
    v_permlane32_swap_b32 v2, v30
    v_max_f32 v1, v1, v3
    v_max_f32 v2, v2, v30
    v_mov_b32 v3, v1
    v_mov_b32 v30, v2
    s_nop 1
    v_permlane16_swap_b32 v1, v3
    v_permlane16_swap_b32 v2, v30
    v_max3_f32 v1, v1, v3, 0
    v_max3_f32 v2, v2, v30, 0
    v_exp_f32 v3, -v1
    v_exp_f32 v30, -v2
    v_sub_f32 v36, v36, v1
    v_sub_f32 v37, v37, v1
    v_sub_f32 v38, v38, v1
    v_sub_f32 v39, v39, v1
    v_sub_f32 v40, v40, v2
    v_sub_f32 v41, v41, v2
    v_sub_f32 v42, v42, v2
    v_sub_f32 v43, v43, v2
    v_sub_f32 v180, v180, v1
    v_sub_f32 v181, v181, v1
    v_sub_f32 v182, v182, v1
    v_sub_f32 v183, v183, v1
    v_sub_f32 v184, v184, v1
    v_sub_f32 v185, v185, v1
    v_sub_f32 v186, v186, v1
    v_sub_f32 v187, v187, v1
    v_sub_f32 v188, v188, v2
    v_sub_f32 v189, v189, v2
    v_sub_f32 v190, v190, v2
    v_sub_f32 v191, v191, v2
    v_sub_f32 v192, v192, v2
    v_sub_f32 v193, v193, v2
    v_sub_f32 v194, v194, v2
    v_sub_f32 v195, v195, v2
    v_sub_f32 v196, v196, v1
    v_sub_f32 v197, v197, v1
    v_sub_f32 v198, v198, v1
    v_sub_f32 v199, v199, v1
    v_sub_f32 v200, v200, v1
    v_sub_f32 v201, v201, v1
    v_sub_f32 v202, v202, v1
    v_sub_f32 v203, v203, v1
    v_sub_f32 v204, v204, v2
    v_sub_f32 v205, v205, v2
    v_sub_f32 v206, v206, v2
    v_sub_f32 v207, v207, v2
    v_sub_f32 v208, v208, v2
    v_sub_f32 v209, v209, v2
    v_sub_f32 v210, v210, v2
    v_sub_f32 v211, v211, v2
    v_sub_f32 v148, v148, v1
    v_sub_f32 v149, v149, v1
    v_sub_f32 v150, v150, v1
    v_sub_f32 v151, v151, v1
    v_sub_f32 v152, v152, v1
    v_sub_f32 v153, v153, v1
    v_sub_f32 v154, v154, v1
    v_sub_f32 v155, v155, v1
    v_sub_f32 v156, v156, v2
    v_sub_f32 v157, v157, v2
    v_sub_f32 v158, v158, v2
    v_sub_f32 v159, v159, v2
    v_sub_f32 v160, v160, v2
    v_sub_f32 v161, v161, v2
    v_sub_f32 v162, v162, v2
    v_sub_f32 v163, v163, v2
    v_sub_f32 v164, v164, v1
    v_sub_f32 v165, v165, v1
    v_sub_f32 v166, v166, v1
    v_sub_f32 v167, v167, v1
    v_sub_f32 v168, v168, v1
    v_sub_f32 v169, v169, v1
    v_sub_f32 v170, v170, v1
    v_sub_f32 v171, v171, v1
    v_sub_f32 v172, v172, v2
    v_sub_f32 v173, v173, v2
    v_sub_f32 v174, v174, v2
    v_sub_f32 v175, v175, v2
    v_sub_f32 v176, v176, v2
    v_sub_f32 v177, v177, v2
    v_sub_f32 v178, v178, v2
    v_sub_f32 v179, v179, v2
    v_mul_f32 v44, v3, v44
    v_mul_f32 v45, v3, v45
    v_mul_f32 v46, v3, v46
    v_mul_f32 v47, v3, v47
    v_mul_f32 v84, v3, v84
    v_mul_f32 v85, v3, v85
    v_mul_f32 v86, v3, v86
    v_mul_f32 v87, v3, v87
    v_mul_f32 v88, v3, v88
    v_mul_f32 v89, v3, v89
    v_mul_f32 v90, v3, v90
    v_mul_f32 v91, v3, v91
    v_mul_f32 v100, v3, v100
    v_mul_f32 v101, v3, v101
    v_mul_f32 v102, v3, v102
    v_mul_f32 v103, v3, v103
    v_mul_f32 v104, v3, v104
    v_mul_f32 v105, v3, v105
    v_mul_f32 v106, v3, v106
    v_mul_f32 v107, v3, v107
    v_mul_f32 v116, v3, v116
    v_mul_f32 v117, v3, v117
    v_mul_f32 v118, v3, v118
    v_mul_f32 v119, v3, v119
    v_mul_f32 v120, v3, v120
    v_mul_f32 v121, v3, v121
    v_mul_f32 v122, v3, v122
    v_mul_f32 v123, v3, v123
    v_mul_f32 v132, v3, v132
    v_mul_f32 v133, v3, v133
    v_mul_f32 v134, v3, v134
    v_mul_f32 v135, v3, v135
    v_mul_f32 v136, v3, v136
    v_mul_f32 v137, v3, v137
    v_mul_f32 v138, v3, v138
    v_mul_f32 v139, v3, v139
    v_mul_f32 v48, v30, v48
    v_mul_f32 v49, v30, v49
    v_mul_f32 v50, v30, v50
    v_mul_f32 v51, v30, v51
    v_mul_f32 v92, v30, v92
    v_mul_f32 v93, v30, v93
    v_mul_f32 v94, v30, v94
    v_mul_f32 v95, v30, v95
    v_mul_f32 v96, v30, v96
    v_mul_f32 v97, v30, v97
    v_mul_f32 v98, v30, v98
    v_mul_f32 v99, v30, v99
    v_mul_f32 v108, v30, v108
    v_mul_f32 v109, v30, v109
    v_mul_f32 v110, v30, v110
    v_mul_f32 v111, v30, v111
    v_mul_f32 v112, v30, v112
    v_mul_f32 v113, v30, v113
    v_mul_f32 v114, v30, v114
    v_mul_f32 v115, v30, v115
    v_mul_f32 v124, v30, v124
    v_mul_f32 v125, v30, v125
    v_mul_f32 v126, v30, v126
    v_mul_f32 v127, v30, v127
    v_mul_f32 v128, v30, v128
    v_mul_f32 v129, v30, v129
    v_mul_f32 v130, v30, v130
    v_mul_f32 v131, v30, v131
    v_mul_f32 v140, v30, v140
    v_mul_f32 v141, v30, v141
    v_mul_f32 v142, v30, v142
    v_mul_f32 v143, v30, v143
    v_mul_f32 v144, v30, v144
    v_mul_f32 v145, v30, v145
    v_mul_f32 v146, v30, v146
    v_mul_f32 v147, v30, v147
    v_exp_f32 v180, v180
    v_exp_f32 v181, v181
    v_exp_f32 v182, v182
    v_exp_f32 v183, v183
    v_exp_f32 v184, v184
    v_exp_f32 v185, v185
    v_exp_f32 v186, v186
    v_exp_f32 v187, v187
    v_exp_f32 v188, v188
    v_exp_f32 v189, v189
    v_exp_f32 v190, v190
    v_exp_f32 v191, v191
    v_exp_f32 v192, v192
    v_exp_f32 v193, v193
    v_exp_f32 v194, v194
    v_exp_f32 v195, v195
    v_exp_f32 v196, v196
    v_exp_f32 v197, v197
    v_exp_f32 v198, v198
    v_exp_f32 v199, v199
    v_exp_f32 v200, v200
    v_exp_f32 v201, v201
    v_exp_f32 v202, v202
    v_exp_f32 v203, v203
    v_exp_f32 v204, v204
    v_exp_f32 v205, v205
    v_exp_f32 v206, v206
    v_exp_f32 v207, v207
    v_exp_f32 v208, v208
    v_exp_f32 v209, v209
    v_exp_f32 v210, v210
    v_exp_f32 v211, v211
    v_cvt_pk_bf16_f32 v180, v180, v181
    v_cvt_pk_bf16_f32 v181, v182, v183
    v_cvt_pk_bf16_f32 v182, v184, v185
    v_cvt_pk_bf16_f32 v183, v186, v187
    v_cvt_pk_bf16_f32 v188, v188, v189
    v_cvt_pk_bf16_f32 v189, v190, v191
    v_cvt_pk_bf16_f32 v190, v192, v193
    v_cvt_pk_bf16_f32 v191, v194, v195
    v_cvt_pk_bf16_f32 v196, v196, v197
    v_cvt_pk_bf16_f32 v197, v198, v199
    v_cvt_pk_bf16_f32 v198, v200, v201
    v_cvt_pk_bf16_f32 v199, v202, v203
    v_cvt_pk_bf16_f32 v204, v204, v205
    v_cvt_pk_bf16_f32 v205, v206, v207
    v_cvt_pk_bf16_f32 v206, v208, v209
    v_cvt_pk_bf16_f32 v207, v210, v211
    v_mfma_f32_16x16x32_bf16 v[248:251], v[32:35], v[180:183], v[44:47]
    v_mfma_f32_16x16x32_bf16 v[248:251], v[32:35], v[196:199], v[248:251]
    v_mfma_f32_16x16x32_bf16 v[252:255], v[32:35], v[188:191], v[48:51]
    v_mfma_f32_16x16x32_bf16 v[252:255], v[32:35], v[204:207], v[252:255]
    s_nop 7
    s_setpc_b64 s[38:39]
L_redo2:
    s_add_u32 s17, s16, 8192
    buffer_load_dwordx4 v[228:231], v10, s[8:11], s16 offen offset:0
    buffer_load_dwordx4 v[232:235], v10, s[8:11], s16 offen offset:64
    buffer_load_dwordx4 v[236:239], v10, s[8:11], s16 offen offset:128
    buffer_load_dwordx4 v[240:243], v10, s[8:11], s16 offen offset:192
    s_waitcnt vmcnt(0)
    v_mfma_f32_16x16x32_bf16 v[180:183], v[228:231], v[52:55], v[36:39]
    v_mfma_f32_16x16x32_bf16 v[180:183], v[232:235], v[60:63], v[180:183]
    v_mfma_f32_16x16x32_bf16 v[180:183], v[236:239], v[68:71], v[180:183]
    v_mfma_f32_16x16x32_bf16 v[180:183], v[240:243], v[76:79], v[180:183]
    v_mfma_f32_16x16x32_bf16 v[188:191], v[228:231], v[56:59], v[40:43]
    v_mfma_f32_16x16x32_bf16 v[188:191], v[232:235], v[64:67], v[188:191]
    v_mfma_f32_16x16x32_bf16 v[188:191], v[236:239], v[72:75], v[188:191]
    v_mfma_f32_16x16x32_bf16 v[188:191], v[240:243], v[80:83], v[188:191]
    buffer_load_dwordx4 v[228:231], v10, s[8:11], s16 offen offset:1024
    buffer_load_dwordx4 v[232:235], v10, s[8:11], s16 offen offset:1088
    buffer_load_dwordx4 v[236:239], v10, s[8:11], s16 offen offset:1152
    buffer_load_dwordx4 v[240:243], v10, s[8:11], s16 offen offset:1216
    s_waitcnt vmcnt(0)
    v_mfma_f32_16x16x32_bf16 v[184:187], v[228:231], v[52:55], v[36:39]
    v_mfma_f32_16x16x32_bf16 v[184:187], v[232:235], v[60:63], v[184:187]
    v_mfma_f32_16x16x32_bf16 v[184:187], v[236:239], v[68:71], v[184:187]
    v_mfma_f32_16x16x32_bf16 v[184:187], v[240:243], v[76:79], v[184:187]
    v_mfma_f32_16x16x32_bf16 v[192:195], v[228:231], v[56:59], v[40:43]
    v_mfma_f32_16x16x32_bf16 v[192:195], v[232:235], v[64:67], v[192:195]
    v_mfma_f32_16x16x32_bf16 v[192:195], v[236:239], v[72:75], v[192:195]
    v_mfma_f32_16x16x32_bf16 v[192:195], v[240:243], v[80:83], v[192:195]
    buffer_load_dwordx4 v[228:231], v10, s[8:11], s17 offen offset:0
    buffer_load_dwordx4 v[232:235], v10, s[8:11], s17 offen offset:64
    buffer_load_dwordx4 v[236:239], v10, s[8:11], s17 offen offset:128
    buffer_load_dwordx4 v[240:243], v10, s[8:11], s17 offen offset:192
    s_waitcnt vmcnt(0)
    v_mfma_f32_16x16x32_bf16 v[196:199], v[228:231], v[52:55], v[36:39]
    v_mfma_f32_16x16x32_bf16 v[196:199], v[232:235], v[60:63], v[196:199]
    v_mfma_f32_16x16x32_bf16 v[196:199], v[236:239], v[68:71], v[196:199]
    v_mfma_f32_16x16x32_bf16 v[196:199], v[240:243], v[76:79], v[196:199]
    v_mfma_f32_16x16x32_bf16 v[204:207], v[228:231], v[56:59], v[40:43]
    v_mfma_f32_16x16x32_bf16 v[204:207], v[232:235], v[64:67], v[204:207]
    v_mfma_f32_16x16x32_bf16 v[204:207], v[236:239], v[72:75], v[204:207]
    v_mfma_f32_16x16x32_bf16 v[204:207], v[240:243], v[80:83], v[204:207]
    buffer_load_dwordx4 v[228:231], v10, s[8:11], s17 offen offset:1024
    buffer_load_dwordx4 v[232:235], v10, s[8:11], s17 offen offset:1088
    buffer_load_dwordx4 v[236:239], v10, s[8:11], s17 offen offset:1152
    buffer_load_dwordx4 v[240:243], v10, s[8:11], s17 offen offset:1216
    s_waitcnt vmcnt(0)
    v_mfma_f32_16x16x32_bf16 v[200:203], v[228:231], v[52:55], v[36:39]
    v_mfma_f32_16x16x32_bf16 v[200:203], v[232:235], v[60:63], v[200:203]
    v_mfma_f32_16x16x32_bf16 v[200:203], v[236:239], v[68:71], v[200:203]
    v_mfma_f32_16x16x32_bf16 v[200:203], v[240:243], v[76:79], v[200:203]
    v_mfma_f32_16x16x32_bf16 v[208:211], v[228:231], v[56:59], v[40:43]
    v_mfma_f32_16x16x32_bf16 v[208:211], v[232:235], v[64:67], v[208:211]
    v_mfma_f32_16x16x32_bf16 v[208:211], v[236:239], v[72:75], v[208:211]
    v_mfma_f32_16x16x32_bf16 v[208:211], v[240:243], v[80:83], v[208:211]
    s_nop 7
    v_max3_f32 v1, v180, v181, v182
    v_max3_f32 v2, v188, v189, v190
    v_max3_f32 v1, v1, v183, v184
    v_max3_f32 v2, v2, v191, v192
    v_max3_f32 v1, v1, v185, v186
    v_max3_f32 v2, v2, v193, v194
    v_max3_f32 v1, v1, v187, v196
    v_max3_f32 v2, v2, v195, v204
    v_max3_f32 v1, v1, v197, v198
    v_max3_f32 v2, v2, v205, v206
    v_max3_f32 v1, v1, v199, v200
    v_max3_f32 v2, v2, v207, v208
    v_max3_f32 v1, v1, v201, v202
    v_max3_f32 v2, v2, v209, v210
    v_max_f32 v1, v1, v203
    v_max_f32 v2, v2, v211
    v_mov_b32 v3, v1
    v_mov_b32 v30, v2
    s_nop 1
    v_permlane32_swap_b32 v1, v3
    v_permlane32_swap_b32 v2, v30
    v_max_f32 v1, v1, v3
    v_max_f32 v2, v2, v30
    v_mov_b32 v3, v1
    v_mov_b32 v30, v2
    s_nop 1
    v_permlane16_swap_b32 v1, v3
    v_permlane16_swap_b32 v2, v30
    v_max3_f32 v1, v1, v3, 0
    v_max3_f32 v2, v2, v30, 0
    v_exp_f32 v3, -v1
    v_exp_f32 v30, -v2
    v_sub_f32 v36, v36, v1
    v_sub_f32 v37, v37, v1
    v_sub_f32 v38, v38, v1
    v_sub_f32 v39, v39, v1
    v_sub_f32 v40, v40, v2
    v_sub_f32 v41, v41, v2
    v_sub_f32 v42, v42, v2
    v_sub_f32 v43, v43, v2
    v_sub_f32 v180, v180, v1
    v_sub_f32 v181, v181, v1
    v_sub_f32 v182, v182, v1
    v_sub_f32 v183, v183, v1
    v_sub_f32 v184, v184, v1
    v_sub_f32 v185, v185, v1
    v_sub_f32 v186, v186, v1
    v_sub_f32 v187, v187, v1
    v_sub_f32 v188, v188, v2
    v_sub_f32 v189, v189, v2
    v_sub_f32 v190, v190, v2
    v_sub_f32 v191, v191, v2
    v_sub_f32 v192, v192, v2
    v_sub_f32 v193, v193, v2
    v_sub_f32 v194, v194, v2
    v_sub_f32 v195, v195, v2
    v_sub_f32 v196, v196, v1
    v_sub_f32 v197, v197, v1
    v_sub_f32 v198, v198, v1
    v_sub_f32 v199, v199, v1
    v_sub_f32 v200, v200, v1
    v_sub_f32 v201, v201, v1
    v_sub_f32 v202, v202, v1
    v_sub_f32 v203, v203, v1
    v_sub_f32 v204, v204, v2
    v_sub_f32 v205, v205, v2
    v_sub_f32 v206, v206, v2
    v_sub_f32 v207, v207, v2
    v_sub_f32 v208, v208, v2
    v_sub_f32 v209, v209, v2
    v_sub_f32 v210, v210, v2
    v_sub_f32 v211, v211, v2
    v_mul_f32 v44, v3, v44
    v_mul_f32 v45, v3, v45
    v_mul_f32 v46, v3, v46
    v_mul_f32 v47, v3, v47
    v_mul_f32 v84, v3, v84
    v_mul_f32 v85, v3, v85
    v_mul_f32 v86, v3, v86
    v_mul_f32 v87, v3, v87
    v_mul_f32 v88, v3, v88
    v_mul_f32 v89, v3, v89
    v_mul_f32 v90, v3, v90
    v_mul_f32 v91, v3, v91
    v_mul_f32 v100, v3, v100
    v_mul_f32 v101, v3, v101
    v_mul_f32 v102, v3, v102
    v_mul_f32 v103, v3, v103
    v_mul_f32 v104, v3, v104
    v_mul_f32 v105, v3, v105
    v_mul_f32 v106, v3, v106
    v_mul_f32 v107, v3, v107
    v_mul_f32 v116, v3, v116
    v_mul_f32 v117, v3, v117
    v_mul_f32 v118, v3, v118
    v_mul_f32 v119, v3, v119
    v_mul_f32 v120, v3, v120
    v_mul_f32 v121, v3, v121
    v_mul_f32 v122, v3, v122
    v_mul_f32 v123, v3, v123
    v_mul_f32 v132, v3, v132
    v_mul_f32 v133, v3, v133
    v_mul_f32 v134, v3, v134
    v_mul_f32 v135, v3, v135
    v_mul_f32 v136, v3, v136
    v_mul_f32 v137, v3, v137
    v_mul_f32 v138, v3, v138
    v_mul_f32 v139, v3, v139
    v_mul_f32 v48, v30, v48
    v_mul_f32 v49, v30, v49
    v_mul_f32 v50, v30, v50
    v_mul_f32 v51, v30, v51
    v_mul_f32 v92, v30, v92
    v_mul_f32 v93, v30, v93
    v_mul_f32 v94, v30, v94
    v_mul_f32 v95, v30, v95
    v_mul_f32 v96, v30, v96
    v_mul_f32 v97, v30, v97
    v_mul_f32 v98, v30, v98
    v_mul_f32 v99, v30, v99
    v_mul_f32 v108, v30, v108
    v_mul_f32 v109, v30, v109
    v_mul_f32 v110, v30, v110
    v_mul_f32 v111, v30, v111
    v_mul_f32 v112, v30, v112
    v_mul_f32 v113, v30, v113
    v_mul_f32 v114, v30, v114
    v_mul_f32 v115, v30, v115
    v_mul_f32 v124, v30, v124
    v_mul_f32 v125, v30, v125
    v_mul_f32 v126, v30, v126
    v_mul_f32 v127, v30, v127
    v_mul_f32 v128, v30, v128
    v_mul_f32 v129, v30, v129
    v_mul_f32 v130, v30, v130
    v_mul_f32 v131, v30, v131
    v_mul_f32 v140, v30, v140
    v_mul_f32 v141, v30, v141
    v_mul_f32 v142, v30, v142
    v_mul_f32 v143, v30, v143
    v_mul_f32 v144, v30, v144
    v_mul_f32 v145, v30, v145
    v_mul_f32 v146, v30, v146
    v_mul_f32 v147, v30, v147
    v_exp_f32 v180, v180
    v_exp_f32 v181, v181
    v_exp_f32 v182, v182
    v_exp_f32 v183, v183
    v_exp_f32 v184, v184
    v_exp_f32 v185, v185
    v_exp_f32 v186, v186
    v_exp_f32 v187, v187
    v_exp_f32 v188, v188
    v_exp_f32 v189, v189
    v_exp_f32 v190, v190
    v_exp_f32 v191, v191
    v_exp_f32 v192, v192
    v_exp_f32 v193, v193
    v_exp_f32 v194, v194
    v_exp_f32 v195, v195
    v_exp_f32 v196, v196
    v_exp_f32 v197, v197
    v_exp_f32 v198, v198
    v_exp_f32 v199, v199
    v_exp_f32 v200, v200
    v_exp_f32 v201, v201
    v_exp_f32 v202, v202
    v_exp_f32 v203, v203
    v_exp_f32 v204, v204
    v_exp_f32 v205, v205
    v_exp_f32 v206, v206
    v_exp_f32 v207, v207
    v_exp_f32 v208, v208
    v_exp_f32 v209, v209
    v_exp_f32 v210, v210
    v_exp_f32 v211, v211
    v_cvt_pk_bf16_f32 v148, v180, v181
    v_cvt_pk_bf16_f32 v149, v182, v183
    v_cvt_pk_bf16_f32 v150, v184, v185
    v_cvt_pk_bf16_f32 v151, v186, v187
    v_cvt_pk_bf16_f32 v156, v188, v189
    v_cvt_pk_bf16_f32 v157, v190, v191
    v_cvt_pk_bf16_f32 v158, v192, v193
    v_cvt_pk_bf16_f32 v159, v194, v195
    v_cvt_pk_bf16_f32 v164, v196, v197
    v_cvt_pk_bf16_f32 v165, v198, v199
    v_cvt_pk_bf16_f32 v166, v200, v201
    v_cvt_pk_bf16_f32 v167, v202, v203
    v_cvt_pk_bf16_f32 v172, v204, v205
    v_cvt_pk_bf16_f32 v173, v206, v207
    v_cvt_pk_bf16_f32 v174, v208, v209
    v_cvt_pk_bf16_f32 v175, v210, v211
    v_mfma_f32_16x16x32_bf16 v[248:251], v[32:35], v[148:151], v[44:47]
    v_mfma_f32_16x16x32_bf16 v[248:251], v[32:35], v[164:167], v[248:251]
    v_mfma_f32_16x16x32_bf16 v[252:255], v[32:35], v[156:159], v[48:51]
    v_mfma_f32_16x16x32_bf16 v[252:255], v[32:35], v[172:175], v[252:255]
    s_nop 7
    s_setpc_b64 s[38:39]
L_end:
    s_endpgm
.section .rodata,"a"
.p2align 6
.amdhsa_kernel standalone__mha_block_cached__near_ridge_kernel
  .amdhsa_next_free_vgpr 256
  .amdhsa_next_free_sgpr 102
  .amdhsa_accum_offset 256
  .amdhsa_group_segment_fixed_size 0
  .amdhsa_kernarg_size 64
  .amdhsa_user_sgpr_count 2
  .amdhsa_user_sgpr_kernarg_segment_ptr 1
  .amdhsa_system_sgpr_workgroup_id_x 1
.end_amdhsa_kernel
```
